```python
import torch

def _softmax(x, axis=-1):
    return torch.softmax(x, dim=axis)
def _gelu(x):
    return torch.nn.functional.gelu(x, approximate="tanh")
def _silu(x):
    return torch.nn.functional.silu(x)
def _sigmoid(x):
    return torch.sigmoid(x)
def _layernorm(x, axis=-1, eps=1e-5):
    m = x.mean(dim=axis, keepdim=True)
    v = x.var(dim=axis, keepdim=True, unbiased=False)
    return (x - m) / torch.sqrt(v + eps)
def _scatter_add(tgt, idx, src, axis=0):
    return tgt.clone().index_add_(axis, idx, src)
def _segment_sum(src, seg, n):
    out = torch.zeros((n,) + src.shape[1:], dtype=src.dtype)
    return out.index_add_(0, seg, src)
def _pad(x, pw):
    flat = tuple(v for pair in reversed(pw) for v in pair)
    return torch.nn.functional.pad(x, flat)

kernel_name = 'concat_heads__gqa_block_cached__mha_block_cached__near_ridge'

def setup_inputs():

    _w = (lambda a: (lambda t: t.to(torch.bfloat16) if t.is_floating_point() else t)(torch.as_tensor(a)))
    def _A_setup():
        B, Sq, D = 8, 160, 512
        Hq, Hkv, Sk, Dh = 32, 32, 512, 128
        assert Hq % Hkv == 0, (Hq, Hkv)
        return {
            "x": _w((lambda *s: torch.randn(*s, dtype=torch.bfloat16) * 0.8)(B, Sq, D)),
            "k_cache": _w((lambda *s: torch.randn(*s, dtype=torch.bfloat16) * 0.8)(B, Hkv, Sk, Dh)),
            "v_cache": _w((lambda *s: torch.randn(*s, dtype=torch.bfloat16) * 0.05)(B, Hkv, Sk, Dh)),
            "wq": _w((lambda *s: torch.randn(*s, dtype=torch.bfloat16) * 0.8)(D, Hq * Dh) * (D ** -0.5)),
            "wo": _w((lambda *s: torch.randn(*s, dtype=torch.bfloat16) * 0.05)(Hq * Dh, D) * ((Hq * Dh) ** -0.5)),
        }
    _A_in = _A_setup()

    def _B_setup():
        B, Sq, D = 8, 160, 512
        H, Sk, Dh = 32, 512, 128
        return {
            "x": _w((lambda *s: torch.randn(*s, dtype=torch.bfloat16) * 0.8)(B, Sq, D)),
            "k_cache": _w((lambda *s: torch.randn(*s, dtype=torch.bfloat16) * 0.8)(B, H, Sk, Dh)),
            "v_cache": _w((lambda *s: torch.randn(*s, dtype=torch.bfloat16) * 0.05)(B, H, Sk, Dh)),
            "wq": _w((lambda *s: torch.randn(*s, dtype=torch.bfloat16) * 0.8)(D, H * Dh) * (D ** -0.5)),
            "wo": _w((lambda *s: torch.randn(*s, dtype=torch.bfloat16) * 0.05)(H * Dh, D) * ((H * Dh) ** -0.5)),
        }
    _B_in = _B_setup()

    return {
        "A_x": _A_in["x"],
        "A_k_cache": _A_in["k_cache"],
        "A_v_cache": _A_in["v_cache"],
        "A_wq": _A_in["wq"],
        "A_wo": _A_in["wo"],
        "B_x": _B_in["x"],
        "B_k_cache": _B_in["k_cache"],
        "B_v_cache": _B_in["v_cache"],
        "B_wq": _B_in["wq"],
        "B_wo": _B_in["wo"],
    }

def reference(A_x, A_k_cache, A_v_cache, A_wq, A_wo, B_x, B_k_cache, B_v_cache, B_wq, B_wo):
    def _A_ref(x, k_cache, v_cache, wq, wo):
        B, Sq, D = x.shape
        Hq, Dh = 32, 128
        Hkv = k_cache.shape[1]
        rep = Hq // Hkv
        q = (lambda x, *d: x.permute(*d))((x @ wq).reshape(B, Sq, Hq, Dh), 0, 2, 1, 3)
        k = (lambda x, n, axis: torch.repeat_interleave(x, n, dim=axis))(k_cache, rep, axis=1)
        v = (lambda x, n, axis: torch.repeat_interleave(x, n, dim=axis))(v_cache, rep, axis=1)
        scores = torch.einsum("bhqd,bhkd->bhqk", q, k) * (Dh ** -0.5)
        p = _softmax(scores, axis=-1)
        o = torch.einsum("bhqk,bhkd->bhqd", p, v)
        return (lambda x, *d: x.permute(*d))(o, 0, 2, 1, 3).reshape(B, Sq, Hq * Dh) @ wo

    def _B_ref(x, k_cache, v_cache, wq, wo):
        B, Sq, D = x.shape
        H, Dh = 32, 128
        q = (lambda x, *d: x.permute(*d))((x @ wq).reshape(B, Sq, H, Dh), 0, 2, 1, 3)
        scores = torch.einsum("bhqd,bhkd->bhqk", q, k_cache) * (Dh ** -0.5)
        p = _softmax(scores, axis=-1)
        o = torch.einsum("bhqk,bhkd->bhqd", p, v_cache)
        return (lambda x, *d: x.permute(*d))(o, 0, 2, 1, 3).reshape(B, Sq, H * Dh) @ wo

    a = _A_ref(A_x, A_k_cache, A_v_cache, A_wq, A_wo)
    b = _B_ref(B_x, B_k_cache, B_v_cache, B_wq, B_wo)
    return torch.concatenate([a, b], axis=-1)
```

```asm
; @launch grid=(256,1,1) block=(256,1,1) lds=163840
.amdgcn_target "amdgcn-amd-amdhsa--gfx950"
.text
.globl concat_heads__gqa_block_cached__mha_block_cached__near_ridge_kernel
.p2align 8
.type concat_heads__gqa_block_cached__mha_block_cached__near_ridge_kernel,@function
concat_heads__gqa_block_cached__mha_block_cached__near_ridge_kernel:
  s_cmp_ge_u32 s2, 256
  s_cbranch_scc1 L_end
  s_load_dwordx16 s[64:79], s[0:1], 0
  s_load_dwordx4 s[80:83], s[0:1], 64
  s_load_dwordx2 s[24:25], s[0:1], 96
  s_load_dwordx2 s[100:101], s[0:1], 80
  v_lshrrev_b32 v1, 6, v0
  v_and_b32 v251, 63, v0
  v_readfirstlane_b32 s3, v1
  s_and_b32 s46, s2, 7
  s_lshr_b32 s47, s2, 3
  s_lshr_b32 s48, s47, 2
  s_and_b32 s49, s47, 3
  s_and_b32 s39, s46, 3
  s_lshl_b32 s50, s39, 2
  s_add_u32 s50, s50, s49
  s_lshl_b32 s51, s50, 1
  s_lshr_b32 s52, s46, 2
  s_and_b32 s28, s3, 1
  s_lshr_b32 s29, s3, 1
  v_and_b32 v2, 3, v251
  v_lshlrev_b32 v2, 4, v2
  v_lshrrev_b32 v3, 4, v251
  v_bfe_u32 v4, v251, 2, 2
  v_lshl_add_u32 v5, v3, 6, v2
  v_lshl_add_u32 v249, v4, 8, v5
  v_xor_b32 v250, 32, v249
  v_lshl_add_u32 v200, v4, 13, v5
  v_xor_b32 v201, 16, v200
  v_lshrrev_b32 v6, 5, v251
  v_bfe_u32 v7, v251, 2, 3
  v_lshl_add_u32 v8, v6, 6, v2
  v_lshl_add_u32 v8, v7, 10, v8
  s_lshl_b32 s42, s28, 5
  v_xor_b32 v202, s42, v8
  v_xor_b32 v203, 32, v202
  s_lshl_b32 s42, s29, 12
  s_lshl_b32 s31, s28, 13
  s_add_u32 s31, s31, s42
  s_lshl_b32 s30, s28, 17
  s_add_u32 s30, s30, s42
  s_add_u32 s43, s51, s28
  s_lshl_b32 s32, s43, 8
  s_lshl_b32 s42, s29, 17
  s_add_u32 s32, s32, s42
  s_mul_i32 s33, s3, 40960
  s_mul_i32 s34, s3, 5120
  s_lshl_b32 s89, s49, 1
  s_add_u32 s89, s89, s48
  s_cmp_ge_u32 s89, 7
  s_cselect_b32 s88, 7, 0
  s_sub_u32 s89, s89, s88
  s_add_u32 s89, s89, 1
  s_lshl_b32 s88, s89, 19
  s_lshl_b32 s89, s89, 7
  s_mul_i32 s53, s48, 163840
  s_lshl_b32 s54, s48, 5
  s_add_u32 s54, s54, s51
  s_lshl_b32 s54, s54, 17
  s_mov_b32 s6, 163840
  s_mov_b32 s7, 0x20000
  s_mov_b32 s10, 0x400000
  s_mov_b32 s11, 0x20000
  s_mov_b32 s14, 0x40000
  s_mov_b32 s15, 0x20000
  s_mov_b32 s18, 0x40000
  s_mov_b32 s19, 0x20000
  s_cmp_eq_u32 s52, 0
  s_waitcnt lgkmcnt(0)
  s_cselect_b64 s[4:5], s[64:65], s[74:75]
  s_cselect_b64 s[8:9], s[70:71], s[80:81]
  s_cselect_b64 s[12:13], s[66:67], s[76:77]
  s_cselect_b64 s[16:17], s[68:69], s[78:79]
  s_cselect_b64 s[20:21], s[72:73], s[82:83]
  s_add_u32 s4, s4, s53
  s_addc_u32 s5, s5, 0
  s_add_u32 s91, s33, 0
  s_add_u32 m0, s34, 81920
  s_add_u32 s42, s91, 0
  buffer_load_dwordx4 v202, s[4:7], s42 offen offset:0 lds
  s_add_u32 s42, s91, 7168
  buffer_load_dwordx4 v203, s[4:7], s42 offen offset:1024 lds
  s_add_u32 s42, s91, 14336
  buffer_load_dwordx4 v202, s[4:7], s42 offen offset:2048 lds
  s_add_u32 s42, s91, 21504
  buffer_load_dwordx4 v203, s[4:7], s42 offen offset:3072 lds
  s_add_u32 m0, s34, 86016
  s_add_u32 s42, s91, 32768
  buffer_load_dwordx4 v202, s[4:7], s42 offen offset:0 lds
  s_add_u32 s91, s89, s33
  s_add_u32 s89, s89, 128
  s_cmp_eq_u32 s89, 1024
  s_cselect_b32 s89, 128, s89
  s_add_u32 s90, s32, 0
  s_add_u32 m0, s31, 147456
  s_add_u32 s42, s90, 0
  buffer_load_dwordx4 v200, s[8:11], s42 offen offset:0 lds
  s_add_u32 s42, s90, 31744
  buffer_load_dwordx4 v200, s[8:11], s42 offen offset:1024 lds
  s_add_u32 s42, s90, 63488
  buffer_load_dwordx4 v201, s[8:11], s42 offen offset:2048 lds
  s_add_u32 s42, s90, 95232
  buffer_load_dwordx4 v201, s[8:11], s42 offen offset:3072 lds
  s_add_u32 s90, s32, 262144
  s_add_u32 m0, s31, 65536
  s_add_u32 s42, s90, 0
  buffer_load_dwordx4 v200, s[8:11], s42 offen offset:0 lds
  s_add_u32 s42, s90, 31744
  buffer_load_dwordx4 v200, s[8:11], s42 offen offset:1024 lds
  s_add_u32 s42, s90, 63488
  buffer_load_dwordx4 v201, s[8:11], s42 offen offset:2048 lds
  s_add_u32 s42, s90, 95232
  buffer_load_dwordx4 v201, s[8:11], s42 offen offset:3072 lds
  s_add_u32 s90, s88, s32
  s_add_u32 s88, s88, 262144
  s_cmp_eq_u32 s88, 0x400000
  s_cselect_b32 s88, 0x80000, s88
  s_add_u32 s12, s12, s54
  s_addc_u32 s13, s13, 0
  s_add_u32 s16, s16, s54
  s_addc_u32 s17, s17, 0
  s_getpc_b64 s[84:85]
L_pc0:
  s_mov_b32 s86, L_codeend-L_pc0
  s_mov_b32 s87, 0x20000
  v_and_b32 v22, 15, v251
  v_lshlrev_b32 v22, 7, v22
  s_and_b32 s42, s47, 7
  s_lshl_b32 s42, s42, 2
  s_add_u32 s42, s42, s3
  s_lshl_b32 s42, s42, 11
  buffer_load_dword a136, v22, s[84:87], s42 offen
  s_mul_i32 s38, s3, 10240
  s_lshl_b32 s96, s3, 12
  s_mul_i32 s97, s3, 5120
  s_mov_b32 s40, 0x3e0293ee
  s_mov_b32 s41, 0x41000000
  s_lshl_b32 s55, s52, 3
  s_add_u32 s55, s55, s48
  s_lshl_b32 s92, s55, 2
  s_add_u32 s44, s92, s49
  s_mov_b32 s58, s44
  s_add_u32 s92, s92, s39
  s_lshl_b32 s44, s44, 2
  s_add_u32 s44, s44, s39
  s_mul_i32 s44, s44, 40960
  s_add_u32 s44, s44, 33554432
  s_mul_i32 s55, s92, 327680
  s_mov_b32 s22, 0x400000
  s_mov_b32 s23, 0x20000
  s_mov_b64 s[56:57], s[24:25]
  s_add_u32 s76, s24, s55
  s_addc_u32 s77, s25, 0
  s_mov_b32 s78, 327680
  s_mov_b32 s79, 0x20000
  s_add_u32 s24, s24, s44
  s_addc_u32 s25, s25, 0
  s_mov_b32 s26, 40960
  s_mov_b32 s27, 0x20000
  s_lshl_b32 s92, s92, 7
  s_add_u32 s92, s92, 50331648
  s_add_u32 s80, s56, s92
  s_addc_u32 s81, s57, 0
  s_mov_b32 s82, 16
  s_mov_b32 s83, 0x20000
  v_add_u32 v24, s49, v251
  v_and_b32 v24, 3, v24
  v_lshlrev_b32 v24, 2, v24
  buffer_load_dword v215, v24, s[80:83], 0 offen sc0 sc1
  s_lshl_b32 s92, s49, 2
  s_mov_b32 s99, 0
  s_lshl_b32 s44, s58, 7
  s_add_u32 s44, s44, 50339840
  s_add_u32 s84, s56, s44
  s_addc_u32 s85, s57, 0
  s_mov_b32 s86, 64
  s_mov_b32 s87, 0x20000
  s_lshl_b32 s44, s3, 2
  v_lshlrev_b32 v24, 4, v251
  buffer_load_dword v214, v24, s[84:87], s44 offen sc0 sc1
  s_lshl_b32 s59, s39, 2
  s_add_u32 s59, s59, s3
  s_mul_i32 s95, s49, 81920
  s_mul_i32 s44, s28, 40960
  s_add_u32 s95, s95, s44
  s_mul_i32 s44, s29, 10240
  s_add_u32 s95, s95, s44
  s_lshl_b32 s45, s39, 20
  s_lshl_b32 s44, s49, 8
  s_add_u32 s45, s45, s44
  s_lshl_b32 s44, s3, 14
  s_add_u32 s45, s45, s44
  s_add_u32 s44, s49, 0
  s_and_b32 s44, s44, 3
  s_mul_i32 s64, s44, 81920
  s_add_u32 s64, s64, s97
  s_lshl_b32 s68, s44, 18
  s_add_u32 s68, s68, s45
  s_add_u32 s44, s49, 1
  s_and_b32 s44, s44, 3
  s_mul_i32 s65, s44, 81920
  s_add_u32 s65, s65, s97
  s_lshl_b32 s69, s44, 18
  s_add_u32 s69, s69, s45
  s_add_u32 s44, s49, 2
  s_and_b32 s44, s44, 3
  s_mul_i32 s66, s44, 81920
  s_add_u32 s66, s66, s97
  s_lshl_b32 s70, s44, 18
  s_add_u32 s70, s70, s45
  s_add_u32 s44, s49, 3
  s_and_b32 s44, s44, 3
  s_mul_i32 s67, s44, 81920
  s_add_u32 s67, s67, s97
  s_lshl_b32 s71, s44, 18
  s_add_u32 s71, s71, s45
  v_and_b32 v9, 1, v3
  v_lshlrev_b32 v9, 5, v9
  v_lshl_add_u32 v252, v4, 10, v5
  v_and_b32 v10, 15, v251
  v_and_b32 v11, 3, v251
  v_lshrrev_b32 v12, 2, v10
  v_and_b32 v13, 1, v12
  v_lshlrev_b32 v13, 5, v13
  v_lshlrev_b32 v14, 4, v3
  v_xor_b32 v13, v13, v14
  v_lshl_add_u32 v13, v11, 6, v13
  v_lshl_add_u32 v13, v12, 10, v13
  s_lshl_b32 s43, s28, 13
  v_add_u32 v247, s43, v13
  v_lshl_add_u32 v15, v11, 3, v9
  v_lshl_add_u32 v15, v4, 6, v15
  v_lshl_add_u32 v16, v3, 10, v15
  v_add_u32 v248, s43, v16
  v_lshrrev_b32 v16, 1, v9
  v_lshlrev_b32 v22, 4, v11
  v_xor_b32 v16, v16, v22
  v_and_b32 v22, 1, v11
  v_lshl_add_u32 v16, v22, 3, v16
  v_lshl_add_u32 v16, v4, 6, v16
  v_lshl_add_u32 v16, v3, 11, v16
  v_add_u32 v16, s43, v16
  v_add_u32 v204, 147456, v16
  v_add_u32 v205, 65536, v16
  v_add_u32 v206, 102400, v16
  v_xor_b32 v207, 8, v204
  v_xor_b32 v208, 8, v205
  v_xor_b32 v209, 8, v206
  s_mov_b32 vcc_lo, 0xffff0000
  s_mov_b32 vcc_hi, 0xffff0000
  v_lshrrev_b32 v17, 3, v10
  v_lshlrev_b32 v18, 5, v17
  v_xor_b32 v18, v18, v14
  v_and_b32 v19, 7, v251
  v_lshl_add_u32 v18, v19, 6, v18
  v_lshl_add_u32 v18, v17, 10, v18
  s_mul_i32 s44, s29, 10240
  v_add_u32 v18, s44, v18
  v_add_u32 v210, 81920, v18
  v_add_u32 v211, 126976, v18
  v_lshl_add_u32 v20, v3, 10, v15
  s_lshl_b32 s44, s28, 9
  v_add_u32 v253, s44, v20
  v_lshlrev_b32 v254, 4, v251
  v_add_u32 v254, s31, v254
  v_add_u32 v212, 65536, v254
  v_add_u32 v213, 131072, v254
  v_add_u32 v254, 32768, v254
  v_mov_b32 v21, 0x3f803f80
  v_accvgpr_write_b32 a156, v21
  v_accvgpr_write_b32 a157, v21
  v_accvgpr_write_b32 a158, v21
  v_accvgpr_write_b32 a159, v21
  s_waitcnt vmcnt(7)
  s_barrier
  ds_read_b64_tr_b16 a[0:1], v204 offset:0
  s_add_u32 m0, s34, 126976
  s_add_u32 s42, s91, 0
  buffer_load_dwordx4 v202, s[4:7], s42 offen offset:0 lds
  ds_read_b64_tr_b16 a[2:3], v204 offset:1024
  s_add_u32 s42, s91, 7168
  buffer_load_dwordx4 v203, s[4:7], s42 offen offset:1024 lds
  ds_read_b128 a[32:35], v210 offset:0
  s_add_u32 s42, s91, 14336
  buffer_load_dwordx4 v202, s[4:7], s42 offen offset:2048 lds
  ds_read_b128 a[36:39], v210 offset:2048
  s_add_u32 s42, s91, 21504
  buffer_load_dwordx4 v203, s[4:7], s42 offen offset:3072 lds
  ds_read_b128 a[40:43], v210 offset:4096
  s_add_u32 m0, s34, 131072
  s_add_u32 s42, s91, 32768
  buffer_load_dwordx4 v202, s[4:7], s42 offen offset:0 lds
  s_add_u32 s91, s89, s33
  s_add_u32 s89, s89, 128
  s_cmp_eq_u32 s89, 1024
  s_cselect_b32 s89, 128, s89
  ds_read_b128 a[44:47], v210 offset:6144
  s_add_u32 m0, s31, 102400
  s_add_u32 s42, s90, 0
  buffer_load_dwordx4 v200, s[8:11], s42 offen offset:0 lds
  ds_read_b128 a[48:51], v210 offset:8192
  s_add_u32 s42, s90, 31744
  buffer_load_dwordx4 v200, s[8:11], s42 offen offset:1024 lds
  ds_read_b64_tr_b16 a[4:5], v207 offset:0
  s_add_u32 s42, s90, 63488
  buffer_load_dwordx4 v201, s[8:11], s42 offen offset:2048 lds
  ds_read_b64_tr_b16 a[6:7], v207 offset:1024
  s_add_u32 s42, s90, 95232
  buffer_load_dwordx4 v201, s[8:11], s42 offen offset:3072 lds
  s_add_u32 s90, s88, s32
  s_add_u32 s88, s88, 262144
  s_cmp_eq_u32 s88, 0x400000
  s_cselect_b32 s88, 0x80000, s88
  ds_read_b64_tr_b16 a[8:9], v204 offset:256
  ds_read_b64_tr_b16 a[10:11], v204 offset:1280
  ds_read_b64_tr_b16 a[12:13], v207 offset:256
  ds_read_b64_tr_b16 a[14:15], v207 offset:1280
  ds_read_b64_tr_b16 a[16:17], v204 offset:512
  ds_read_b64_tr_b16 a[18:19], v204 offset:1536
  s_waitcnt lgkmcnt(11)
  ds_read_b64_tr_b16 a[20:21], v207 offset:512
  ds_read_b64_tr_b16 a[22:23], v207 offset:1536
  ds_read_b64_tr_b16 a[24:25], v204 offset:768
  ds_read_b64_tr_b16 a[26:27], v204 offset:1792
  s_waitcnt lgkmcnt(11)
  ds_read_b64_tr_b16 a[28:29], v207 offset:768
  ds_read_b64_tr_b16 a[30:31], v207 offset:1792
  s_waitcnt vmcnt(12)
  s_waitcnt lgkmcnt(0)
  s_barrier
  v_mfma_f32_16x16x32_bf16 v[0:3], a[0:3], a[32:35], 0
  s_add_u32 m0, s31, 147456
  s_add_u32 s42, s90, 0
  v_mfma_f32_16x16x32_bf16 v[32:35], a[0:3], a[36:39], 0
  buffer_load_dwordx4 v200, s[8:11], s42 offen offset:0 lds
  s_add_u32 s42, s90, 31744
  v_mfma_f32_16x16x32_bf16 v[64:67], a[0:3], a[40:43], 0
  ds_read_b64_tr_b16 a[52:53], v205 offset:0
  ds_read_b64_tr_b16 a[54:55], v205 offset:1024
  v_mfma_f32_16x16x32_bf16 v[96:99], a[0:3], a[44:47], 0
  ds_read_b128 a[84:87], v210 offset:512
  ds_read_b128 a[88:91], v210 offset:2560
  v_mfma_f32_16x16x32_bf16 v[128:131], a[0:3], a[48:51], 0
  buffer_load_dwordx4 v200, s[8:11], s42 offen offset:1024 lds
  ds_read_b128 a[92:95], v210 offset:4608
  v_mfma_f32_16x16x32_bf16 v[4:7], a[4:7], a[32:35], 0
  s_add_u32 s42, s90, 63488
  ds_read_b128 a[96:99], v210 offset:6656
  v_mfma_f32_16x16x32_bf16 v[36:39], a[4:7], a[36:39], 0
  ds_read_b128 a[100:103], v210 offset:8704
  ds_read_b64_tr_b16 a[56:57], v208 offset:0
  v_mfma_f32_16x16x32_bf16 v[68:71], a[4:7], a[40:43], 0
  ds_read_b64_tr_b16 a[58:59], v208 offset:1024
  ds_read_b64_tr_b16 a[60:61], v205 offset:256
  v_mfma_f32_16x16x32_bf16 v[100:103], a[4:7], a[44:47], 0
  buffer_load_dwordx4 v201, s[8:11], s42 offen offset:2048 lds
  ds_read_b64_tr_b16 a[62:63], v205 offset:1280
  v_mfma_f32_16x16x32_bf16 v[132:135], a[4:7], a[48:51], 0
  s_add_u32 s42, s90, 95232
  ds_read_b64_tr_b16 a[64:65], v208 offset:256
  v_mfma_f32_16x16x32_bf16 v[8:11], a[8:11], a[32:35], 0
  ds_read_b64_tr_b16 a[66:67], v208 offset:1280
  ds_read_b64_tr_b16 a[68:69], v205 offset:512
  v_mfma_f32_16x16x32_bf16 v[40:43], a[8:11], a[36:39], 0
  ds_read_b64_tr_b16 a[70:71], v205 offset:1536
  s_waitcnt lgkmcnt(11)
  ds_read_b64_tr_b16 a[72:73], v208 offset:512
  v_mfma_f32_16x16x32_bf16 v[72:75], a[8:11], a[40:43], 0
  buffer_load_dwordx4 v201, s[8:11], s42 offen offset:3072 lds
  s_add_u32 s90, s88, s32
  v_mfma_f32_16x16x32_bf16 v[104:107], a[8:11], a[44:47], 0
  s_add_u32 s88, s88, 262144
  ds_read_b64_tr_b16 a[74:75], v208 offset:1536
  v_mfma_f32_16x16x32_bf16 v[136:139], a[8:11], a[48:51], 0
  s_cmp_eq_u32 s88, 0x400000
  s_cselect_b32 s88, 0x80000, s88
  v_mfma_f32_16x16x32_bf16 v[12:15], a[12:15], a[32:35], 0
  s_add_u32 m0, s31, 49152
  s_add_u32 s44, s30, 0
  v_mfma_f32_16x16x32_bf16 v[44:47], a[12:15], a[36:39], 0
  buffer_load_dwordx4 v249, s[12:15], s44 offen offset:0 nt lds
  ds_read_b64_tr_b16 a[76:77], v205 offset:768
  v_mfma_f32_16x16x32_bf16 v[76:79], a[12:15], a[40:43], 0
  ds_read_b64_tr_b16 a[78:79], v205 offset:1792
  s_waitcnt lgkmcnt(11)
  ds_read_b64_tr_b16 a[80:81], v208 offset:768
  v_mfma_f32_16x16x32_bf16 v[108:111], a[12:15], a[44:47], 0
  ds_read_b64_tr_b16 a[82:83], v208 offset:1792
  v_mfma_f32_16x16x32_bf16 v[140:143], a[12:15], a[48:51], 0
  v_mfma_f32_16x16x32_bf16 v[16:19], a[16:19], a[32:35], 0
  buffer_load_dwordx4 v250, s[12:15], s44 offen offset:1024 nt lds
  v_mfma_f32_16x16x32_bf16 v[48:51], a[16:19], a[36:39], 0
  v_mfma_f32_16x16x32_bf16 v[80:83], a[16:19], a[40:43], 0
  v_mfma_f32_16x16x32_bf16 v[112:115], a[16:19], a[44:47], 0
  v_mfma_f32_16x16x32_bf16 v[144:147], a[16:19], a[48:51], 0
  buffer_load_dwordx4 v249, s[12:15], s44 offen offset:2048 nt lds
  v_mfma_f32_16x16x32_bf16 v[20:23], a[20:23], a[32:35], 0
  v_mfma_f32_16x16x32_bf16 v[52:55], a[20:23], a[36:39], 0
  v_mfma_f32_16x16x32_bf16 v[84:87], a[20:23], a[40:43], 0
  v_mfma_f32_16x16x32_bf16 v[116:119], a[20:23], a[44:47], 0
  buffer_load_dwordx4 v250, s[12:15], s44 offen offset:3072 nt lds
  v_mfma_f32_16x16x32_bf16 v[148:151], a[20:23], a[48:51], 0
  s_add_u32 m0, s31, 0
  s_add_u32 s44, s30, 8192
  v_mfma_f32_16x16x32_bf16 v[24:27], a[24:27], a[32:35], 0
  v_mfma_f32_16x16x32_bf16 v[56:59], a[24:27], a[36:39], 0
  v_mfma_f32_16x16x32_bf16 v[88:91], a[24:27], a[40:43], 0
  buffer_load_dwordx4 v249, s[12:15], s44 offen offset:0 nt lds
  v_mfma_f32_16x16x32_bf16 v[120:123], a[24:27], a[44:47], 0
  v_mfma_f32_16x16x32_bf16 v[152:155], a[24:27], a[48:51], 0
  v_mfma_f32_16x16x32_bf16 v[28:31], a[28:31], a[32:35], 0
  v_mfma_f32_16x16x32_bf16 v[60:63], a[28:31], a[36:39], 0
  buffer_load_dwordx4 v250, s[12:15], s44 offen offset:1024 nt lds
  v_mfma_f32_16x16x32_bf16 v[92:95], a[28:31], a[40:43], 0
  v_mfma_f32_16x16x32_bf16 v[124:127], a[28:31], a[44:47], 0
  v_mfma_f32_16x16x32_bf16 v[156:159], a[28:31], a[48:51], 0
  s_waitcnt vmcnt(10)
  s_waitcnt lgkmcnt(0)
  s_barrier
  v_mfma_f32_16x16x32_bf16 v[0:3], a[52:55], a[84:87], v[0:3]
  s_add_u32 m0, s31, 65536
  s_add_u32 s42, s90, 0
  v_mfma_f32_16x16x32_bf16 v[32:35], a[52:55], a[88:91], v[32:35]
  buffer_load_dwordx4 v200, s[8:11], s42 offen offset:0 lds
  ds_read_b64_tr_b16 a[0:1], v206 offset:0
  v_mfma_f32_16x16x32_bf16 v[64:67], a[52:55], a[92:95], v[64:67]
  s_add_u32 s42, s90, 31744
  ds_read_b64_tr_b16 a[2:3], v206 offset:1024
  v_mfma_f32_16x16x32_bf16 v[96:99], a[52:55], a[96:99], v[96:99]
  ds_read_b128 a[32:35], v211 offset:0
  ds_read_b128 a[36:39], v211 offset:2048
  v_mfma_f32_16x16x32_bf16 v[128:131], a[52:55], a[100:103], v[128:131]
  ds_read_b128 a[40:43], v211 offset:4096
  ds_read_b128 a[44:47], v211 offset:6144
  v_mfma_f32_16x16x32_bf16 v[4:7], a[56:59], a[84:87], v[4:7]
  buffer_load_dwordx4 v200, s[8:11], s42 offen offset:1024 lds
  ds_read_b128 a[48:51], v211 offset:8192
  v_mfma_f32_16x16x32_bf16 v[36:39], a[56:59], a[88:91], v[36:39]
  s_add_u32 s42, s90, 63488
  ds_read_b64_tr_b16 a[4:5], v209 offset:0
  v_mfma_f32_16x16x32_bf16 v[68:71], a[56:59], a[92:95], v[68:71]
  ds_read_b64_tr_b16 a[6:7], v209 offset:1024
  ds_read_b64_tr_b16 a[8:9], v206 offset:256
  v_mfma_f32_16x16x32_bf16 v[100:103], a[56:59], a[96:99], v[100:103]
  ds_read_b64_tr_b16 a[10:11], v206 offset:1280
  ds_read_b64_tr_b16 a[12:13], v209 offset:256
  v_mfma_f32_16x16x32_bf16 v[132:135], a[56:59], a[100:103], v[132:135]
  buffer_load_dwordx4 v201, s[8:11], s42 offen offset:2048 lds
  ds_read_b64_tr_b16 a[14:15], v209 offset:1280
  v_mfma_f32_16x16x32_bf16 v[8:11], a[60:63], a[84:87], v[8:11]
  s_add_u32 s42, s90, 95232
  ds_read_b64_tr_b16 a[16:17], v206 offset:512
  v_mfma_f32_16x16x32_bf16 v[40:43], a[60:63], a[88:91], v[40:43]
  ds_read_b64_tr_b16 a[18:19], v206 offset:1536
  s_waitcnt lgkmcnt(11)
  ds_read_b64_tr_b16 a[20:21], v209 offset:512
  v_mfma_f32_16x16x32_bf16 v[72:75], a[60:63], a[92:95], v[72:75]
  ds_read_b64_tr_b16 a[22:23], v209 offset:1536
  ds_read_b64_tr_b16 a[24:25], v206 offset:768
  v_mfma_f32_16x16x32_bf16 v[104:107], a[60:63], a[96:99], v[104:107]
  buffer_load_dwordx4 v201, s[8:11], s42 offen offset:3072 lds
  s_add_u32 s90, s88, s32
  v_mfma_f32_16x16x32_bf16 v[136:139], a[60:63], a[100:103], v[136:139]
  s_add_u32 s88, s88, 262144
  ds_read_b64_tr_b16 a[26:27], v206 offset:1792
  v_mfma_f32_16x16x32_bf16 v[12:15], a[64:67], a[84:87], v[12:15]
  s_cmp_eq_u32 s88, 0x400000
  s_cselect_b32 s88, 0x80000, s88
  v_mfma_f32_16x16x32_bf16 v[44:47], a[64:67], a[88:91], v[44:47]
  s_add_u32 m0, s34, 81920
  s_add_u32 s42, s91, 0
  v_mfma_f32_16x16x32_bf16 v[76:79], a[64:67], a[92:95], v[76:79]
  buffer_load_dwordx4 v202, s[4:7], s42 offen offset:0 lds
  s_waitcnt lgkmcnt(11)
  ds_read_b64_tr_b16 a[28:29], v209 offset:768
  v_mfma_f32_16x16x32_bf16 v[108:111], a[64:67], a[96:99], v[108:111]
  s_add_u32 s42, s91, 7168
  ds_read_b64_tr_b16 a[30:31], v209 offset:1792
  v_mfma_f32_16x16x32_bf16 v[140:143], a[64:67], a[100:103], v[140:143]
  v_mfma_f32_16x16x32_bf16 v[16:19], a[68:71], a[84:87], v[16:19]
  v_mfma_f32_16x16x32_bf16 v[48:51], a[68:71], a[88:91], v[48:51]
  buffer_load_dwordx4 v203, s[4:7], s42 offen offset:1024 lds
  v_mfma_f32_16x16x32_bf16 v[80:83], a[68:71], a[92:95], v[80:83]
  s_add_u32 s42, s91, 14336
  v_mfma_f32_16x16x32_bf16 v[112:115], a[68:71], a[96:99], v[112:115]
  v_mfma_f32_16x16x32_bf16 v[144:147], a[68:71], a[100:103], v[144:147]
  v_mfma_f32_16x16x32_bf16 v[20:23], a[72:75], a[84:87], v[20:23]
  buffer_load_dwordx4 v202, s[4:7], s42 offen offset:2048 lds
  v_mfma_f32_16x16x32_bf16 v[52:55], a[72:75], a[88:91], v[52:55]
  s_add_u32 s42, s91, 21504
  v_mfma_f32_16x16x32_bf16 v[84:87], a[72:75], a[92:95], v[84:87]
  v_mfma_f32_16x16x32_bf16 v[116:119], a[72:75], a[96:99], v[116:119]
  v_mfma_f32_16x16x32_bf16 v[148:151], a[72:75], a[100:103], v[148:151]
  buffer_load_dwordx4 v203, s[4:7], s42 offen offset:3072 lds
  v_mfma_f32_16x16x32_bf16 v[24:27], a[76:79], a[84:87], v[24:27]
  s_add_u32 m0, s34, 86016
  s_add_u32 s42, s91, 32768
  v_mfma_f32_16x16x32_bf16 v[56:59], a[76:79], a[88:91], v[56:59]
  v_mfma_f32_16x16x32_bf16 v[88:91], a[76:79], a[92:95], v[88:91]
  v_mfma_f32_16x16x32_bf16 v[120:123], a[76:79], a[96:99], v[120:123]
  buffer_load_dwordx4 v202, s[4:7], s42 offen offset:0 lds
  s_add_u32 s91, s89, s33
  v_mfma_f32_16x16x32_bf16 v[152:155], a[76:79], a[100:103], v[152:155]
  s_add_u32 s89, s89, 128
  v_mfma_f32_16x16x32_bf16 v[28:31], a[80:83], a[84:87], v[28:31]
  s_cmp_eq_u32 s89, 1024
  s_cselect_b32 s89, 128, s89
  v_mfma_f32_16x16x32_bf16 v[60:63], a[80:83], a[88:91], v[60:63]
  v_mfma_f32_16x16x32_bf16 v[92:95], a[80:83], a[92:95], v[92:95]
  v_mfma_f32_16x16x32_bf16 v[124:127], a[80:83], a[96:99], v[124:127]
  v_mfma_f32_16x16x32_bf16 v[156:159], a[80:83], a[100:103], v[156:159]
  s_waitcnt vmcnt(15)
  s_waitcnt lgkmcnt(0)
  s_barrier
  v_mfma_f32_16x16x32_bf16 v[0:3], a[0:3], a[32:35], v[0:3]
  s_add_u32 m0, s31, 102400
  s_add_u32 s42, s90, 0
  v_mfma_f32_16x16x32_bf16 v[32:35], a[0:3], a[36:39], v[32:35]
  buffer_load_dwordx4 v200, s[8:11], s42 offen offset:0 lds
  s_add_u32 s42, s90, 31744
  v_mfma_f32_16x16x32_bf16 v[64:67], a[0:3], a[40:43], v[64:67]
  ds_read_b64_tr_b16 a[52:53], v204 offset:0
  ds_read_b64_tr_b16 a[54:55], v204 offset:1024
  v_mfma_f32_16x16x32_bf16 v[96:99], a[0:3], a[44:47], v[96:99]
  ds_read_b128 a[84:87], v211 offset:512
  ds_read_b128 a[88:91], v211 offset:2560
  v_mfma_f32_16x16x32_bf16 v[128:131], a[0:3], a[48:51], v[128:131]
  buffer_load_dwordx4 v200, s[8:11], s42 offen offset:1024 lds
  ds_read_b128 a[92:95], v211 offset:4608
  v_mfma_f32_16x16x32_bf16 v[4:7], a[4:7], a[32:35], v[4:7]
  s_add_u32 s42, s90, 63488
  ds_read_b128 a[96:99], v211 offset:6656
  v_mfma_f32_16x16x32_bf16 v[36:39], a[4:7], a[36:39], v[36:39]
  ds_read_b128 a[100:103], v211 offset:8704
  ds_read_b64_tr_b16 a[56:57], v207 offset:0
  v_mfma_f32_16x16x32_bf16 v[68:71], a[4:7], a[40:43], v[68:71]
  ds_read_b64_tr_b16 a[58:59], v207 offset:1024
  ds_read_b64_tr_b16 a[60:61], v204 offset:256
  v_mfma_f32_16x16x32_bf16 v[100:103], a[4:7], a[44:47], v[100:103]
  buffer_load_dwordx4 v201, s[8:11], s42 offen offset:2048 lds
  ds_read_b64_tr_b16 a[62:63], v204 offset:1280
  v_mfma_f32_16x16x32_bf16 v[132:135], a[4:7], a[48:51], v[132:135]
  s_add_u32 s42, s90, 95232
  ds_read_b64_tr_b16 a[64:65], v207 offset:256
  v_mfma_f32_16x16x32_bf16 v[8:11], a[8:11], a[32:35], v[8:11]
  ds_read_b64_tr_b16 a[66:67], v207 offset:1280
  ds_read_b64_tr_b16 a[68:69], v204 offset:512
  v_mfma_f32_16x16x32_bf16 v[40:43], a[8:11], a[36:39], v[40:43]
  ds_read_b64_tr_b16 a[70:71], v204 offset:1536
  s_waitcnt lgkmcnt(11)
  ds_read_b64_tr_b16 a[72:73], v207 offset:512
  v_mfma_f32_16x16x32_bf16 v[72:75], a[8:11], a[40:43], v[72:75]
  buffer_load_dwordx4 v201, s[8:11], s42 offen offset:3072 lds
  s_add_u32 s90, s88, s32
  v_mfma_f32_16x16x32_bf16 v[104:107], a[8:11], a[44:47], v[104:107]
  s_add_u32 s88, s88, 262144
  ds_read_b64_tr_b16 a[74:75], v207 offset:1536
  v_mfma_f32_16x16x32_bf16 v[136:139], a[8:11], a[48:51], v[136:139]
  s_cmp_eq_u32 s88, 0x400000
  s_cselect_b32 s88, 0x80000, s88
  v_mfma_f32_16x16x32_bf16 v[12:15], a[12:15], a[32:35], v[12:15]
  s_add_u32 m0, s31, 0
  v_mfma_f32_16x16x32_bf16 v[44:47], a[12:15], a[36:39], v[44:47]
  buffer_load_dwordx4 v249, s[12:15], s44 offen offset:2048 nt lds
  ds_read_b64_tr_b16 a[76:77], v204 offset:768
  v_mfma_f32_16x16x32_bf16 v[76:79], a[12:15], a[40:43], v[76:79]
  ds_read_b64_tr_b16 a[78:79], v204 offset:1792
  s_waitcnt lgkmcnt(11)
  ds_read_b64_tr_b16 a[80:81], v207 offset:768
  v_mfma_f32_16x16x32_bf16 v[108:111], a[12:15], a[44:47], v[108:111]
  ds_read_b64_tr_b16 a[82:83], v207 offset:1792
  v_mfma_f32_16x16x32_bf16 v[140:143], a[12:15], a[48:51], v[140:143]
  v_mfma_f32_16x16x32_bf16 v[16:19], a[16:19], a[32:35], v[16:19]
  buffer_load_dwordx4 v250, s[12:15], s44 offen offset:3072 nt lds
  v_mfma_f32_16x16x32_bf16 v[48:51], a[16:19], a[36:39], v[48:51]
  s_add_u32 m0, s31, 16384
  s_add_u32 s44, s30, 0
  v_mfma_f32_16x16x32_bf16 v[80:83], a[16:19], a[40:43], v[80:83]
  v_mfma_f32_16x16x32_bf16 v[112:115], a[16:19], a[44:47], v[112:115]
  v_mfma_f32_16x16x32_bf16 v[144:147], a[16:19], a[48:51], v[144:147]
  buffer_load_dwordx4 v249, s[16:19], s44 offen offset:0 nt lds
  v_mfma_f32_16x16x32_bf16 v[20:23], a[20:23], a[32:35], v[20:23]
  v_mfma_f32_16x16x32_bf16 v[52:55], a[20:23], a[36:39], v[52:55]
  v_mfma_f32_16x16x32_bf16 v[84:87], a[20:23], a[40:43], v[84:87]
  v_mfma_f32_16x16x32_bf16 v[116:119], a[20:23], a[44:47], v[116:119]
  buffer_load_dwordx4 v250, s[16:19], s44 offen offset:1024 nt lds
  v_mfma_f32_16x16x32_bf16 v[148:151], a[20:23], a[48:51], v[148:151]
  v_mfma_f32_16x16x32_bf16 v[24:27], a[24:27], a[32:35], v[24:27]
  v_mfma_f32_16x16x32_bf16 v[56:59], a[24:27], a[36:39], v[56:59]
  v_mfma_f32_16x16x32_bf16 v[88:91], a[24:27], a[40:43], v[88:91]
  buffer_load_dwordx4 v249, s[16:19], s44 offen offset:2048 nt lds
  v_mfma_f32_16x16x32_bf16 v[120:123], a[24:27], a[44:47], v[120:123]
  v_mfma_f32_16x16x32_bf16 v[152:155], a[24:27], a[48:51], v[152:155]
  v_mfma_f32_16x16x32_bf16 v[28:31], a[28:31], a[32:35], v[28:31]
  v_mfma_f32_16x16x32_bf16 v[60:63], a[28:31], a[36:39], v[60:63]
  buffer_load_dwordx4 v250, s[16:19], s44 offen offset:3072 nt lds
  v_mfma_f32_16x16x32_bf16 v[92:95], a[28:31], a[40:43], v[92:95]
  v_mfma_f32_16x16x32_bf16 v[124:127], a[28:31], a[44:47], v[124:127]
  v_mfma_f32_16x16x32_bf16 v[156:159], a[28:31], a[48:51], v[156:159]
  s_waitcnt vmcnt(10)
  s_waitcnt lgkmcnt(0)
  s_barrier
  v_mfma_f32_16x16x32_bf16 v[0:3], a[52:55], a[84:87], v[0:3]
  s_add_u32 m0, s31, 147456
  s_add_u32 s42, s90, 0
  v_mfma_f32_16x16x32_bf16 v[32:35], a[52:55], a[88:91], v[32:35]
  buffer_load_dwordx4 v200, s[8:11], s42 offen offset:0 lds
  ds_read_b64_tr_b16 a[0:1], v205 offset:0
  v_mfma_f32_16x16x32_bf16 v[64:67], a[52:55], a[92:95], v[64:67]
  s_add_u32 s42, s90, 31744
  ds_read_b64_tr_b16 a[2:3], v205 offset:1024
  v_mfma_f32_16x16x32_bf16 v[96:99], a[52:55], a[96:99], v[96:99]
  ds_read_b128 a[32:35], v210 offset:0
  ds_read_b128 a[36:39], v210 offset:2048
  v_mfma_f32_16x16x32_bf16 v[128:131], a[52:55], a[100:103], v[128:131]
  ds_read_b128 a[40:43], v210 offset:4096
  ds_read_b128 a[44:47], v210 offset:6144
  v_mfma_f32_16x16x32_bf16 v[4:7], a[56:59], a[84:87], v[4:7]
  buffer_load_dwordx4 v200, s[8:11], s42 offen offset:1024 lds
  ds_read_b128 a[48:51], v210 offset:8192
  v_mfma_f32_16x16x32_bf16 v[36:39], a[56:59], a[88:91], v[36:39]
  s_add_u32 s42, s90, 63488
  ds_read_b64_tr_b16 a[4:5], v208 offset:0
  v_mfma_f32_16x16x32_bf16 v[68:71], a[56:59], a[92:95], v[68:71]
  ds_read_b64_tr_b16 a[6:7], v208 offset:1024
  ds_read_b64_tr_b16 a[8:9], v205 offset:256
  v_mfma_f32_16x16x32_bf16 v[100:103], a[56:59], a[96:99], v[100:103]
  ds_read_b64_tr_b16 a[10:11], v205 offset:1280
  ds_read_b64_tr_b16 a[12:13], v208 offset:256
  v_mfma_f32_16x16x32_bf16 v[132:135], a[56:59], a[100:103], v[132:135]
  buffer_load_dwordx4 v201, s[8:11], s42 offen offset:2048 lds
  ds_read_b64_tr_b16 a[14:15], v208 offset:1280
  v_mfma_f32_16x16x32_bf16 v[8:11], a[60:63], a[84:87], v[8:11]
  s_add_u32 s42, s90, 95232
  ds_read_b64_tr_b16 a[16:17], v205 offset:512
  v_mfma_f32_16x16x32_bf16 v[40:43], a[60:63], a[88:91], v[40:43]
  ds_read_b64_tr_b16 a[18:19], v205 offset:1536
  s_waitcnt lgkmcnt(11)
  ds_read_b64_tr_b16 a[20:21], v208 offset:512
  v_mfma_f32_16x16x32_bf16 v[72:75], a[60:63], a[92:95], v[72:75]
  ds_read_b64_tr_b16 a[22:23], v208 offset:1536
  ds_read_b64_tr_b16 a[24:25], v205 offset:768
  v_mfma_f32_16x16x32_bf16 v[104:107], a[60:63], a[96:99], v[104:107]
  buffer_load_dwordx4 v201, s[8:11], s42 offen offset:3072 lds
  s_add_u32 s90, s88, s32
  v_mfma_f32_16x16x32_bf16 v[136:139], a[60:63], a[100:103], v[136:139]
  s_add_u32 s88, s88, 262144
  ds_read_b64_tr_b16 a[26:27], v205 offset:1792
  v_mfma_f32_16x16x32_bf16 v[12:15], a[64:67], a[84:87], v[12:15]
  s_cmp_eq_u32 s88, 0x400000
  s_cselect_b32 s88, 0x80000, s88
  v_mfma_f32_16x16x32_bf16 v[44:47], a[64:67], a[88:91], v[44:47]
  s_add_u32 m0, s34, 126976
  s_add_u32 s42, s91, 0
  v_mfma_f32_16x16x32_bf16 v[76:79], a[64:67], a[92:95], v[76:79]
  buffer_load_dwordx4 v202, s[4:7], s42 offen offset:0 lds
  s_waitcnt lgkmcnt(11)
  ds_read_b64_tr_b16 a[28:29], v208 offset:768
  v_mfma_f32_16x16x32_bf16 v[108:111], a[64:67], a[96:99], v[108:111]
  s_add_u32 s42, s91, 7168
  ds_read_b64_tr_b16 a[30:31], v208 offset:1792
  v_mfma_f32_16x16x32_bf16 v[140:143], a[64:67], a[100:103], v[140:143]
  v_mfma_f32_16x16x32_bf16 v[16:19], a[68:71], a[84:87], v[16:19]
  v_mfma_f32_16x16x32_bf16 v[48:51], a[68:71], a[88:91], v[48:51]
  buffer_load_dwordx4 v203, s[4:7], s42 offen offset:1024 lds
  v_mfma_f32_16x16x32_bf16 v[80:83], a[68:71], a[92:95], v[80:83]
  s_add_u32 s42, s91, 14336
  v_mfma_f32_16x16x32_bf16 v[112:115], a[68:71], a[96:99], v[112:115]
  v_mfma_f32_16x16x32_bf16 v[144:147], a[68:71], a[100:103], v[144:147]
  v_mfma_f32_16x16x32_bf16 v[20:23], a[72:75], a[84:87], v[20:23]
  buffer_load_dwordx4 v202, s[4:7], s42 offen offset:2048 lds
  v_mfma_f32_16x16x32_bf16 v[52:55], a[72:75], a[88:91], v[52:55]
  s_add_u32 s42, s91, 21504
  v_mfma_f32_16x16x32_bf16 v[84:87], a[72:75], a[92:95], v[84:87]
  v_mfma_f32_16x16x32_bf16 v[116:119], a[72:75], a[96:99], v[116:119]
  v_mfma_f32_16x16x32_bf16 v[148:151], a[72:75], a[100:103], v[148:151]
  buffer_load_dwordx4 v203, s[4:7], s42 offen offset:3072 lds
  v_mfma_f32_16x16x32_bf16 v[24:27], a[76:79], a[84:87], v[24:27]
  s_add_u32 m0, s34, 131072
  s_add_u32 s42, s91, 32768
  v_mfma_f32_16x16x32_bf16 v[56:59], a[76:79], a[88:91], v[56:59]
  v_readlane_b32 s72, v215, 0
  v_readlane_b32 s73, v215, 1
  v_mfma_f32_16x16x32_bf16 v[88:91], a[76:79], a[92:95], v[88:91]
  v_readlane_b32 s74, v215, 2
  v_readlane_b32 s75, v215, 3
  v_mfma_f32_16x16x32_bf16 v[120:123], a[76:79], a[96:99], v[120:123]
  buffer_load_dwordx4 v202, s[4:7], s42 offen offset:0 lds
  v_readlane_b32 s0, v214, 0
  v_mfma_f32_16x16x32_bf16 v[152:155], a[76:79], a[100:103], v[152:155]
  v_readlane_b32 s1, v214, 1
  v_readlane_b32 s93, v214, 2
  v_mfma_f32_16x16x32_bf16 v[28:31], a[80:83], a[84:87], v[28:31]
  v_readlane_b32 s36, v214, 3
  s_add_u32 s91, s89, s33
  v_mfma_f32_16x16x32_bf16 v[60:63], a[80:83], a[88:91], v[60:63]
  s_add_u32 s89, s89, 128
  v_mfma_f32_16x16x32_bf16 v[92:95], a[80:83], a[92:95], v[92:95]
  s_cmp_eq_u32 s89, 1024
  s_cselect_b32 s89, 128, s89
  v_mfma_f32_16x16x32_bf16 v[124:127], a[80:83], a[96:99], v[124:127]
  v_mfma_f32_16x16x32_bf16 v[156:159], a[80:83], a[100:103], v[156:159]
  s_waitcnt vmcnt(15)
  s_waitcnt lgkmcnt(0)
  s_barrier
  v_mfma_f32_16x16x32_bf16 v[0:3], a[0:3], a[32:35], v[0:3]
  s_add_u32 m0, s31, 65536
  s_add_u32 s42, s90, 0
  v_mfma_f32_16x16x32_bf16 v[32:35], a[0:3], a[36:39], v[32:35]
  buffer_load_dwordx4 v200, s[8:11], s42 offen offset:0 lds
  s_add_u32 s42, s90, 31744
  v_mfma_f32_16x16x32_bf16 v[64:67], a[0:3], a[40:43], v[64:67]
  ds_read_b64_tr_b16 a[52:53], v206 offset:0
  ds_read_b64_tr_b16 a[54:55], v206 offset:1024
  v_mfma_f32_16x16x32_bf16 v[96:99], a[0:3], a[44:47], v[96:99]
  ds_read_b128 a[84:87], v210 offset:512
  ds_read_b128 a[88:91], v210 offset:2560
  v_mfma_f32_16x16x32_bf16 v[128:131], a[0:3], a[48:51], v[128:131]
  buffer_load_dwordx4 v200, s[8:11], s42 offen offset:1024 lds
  ds_read_b128 a[92:95], v210 offset:4608
  v_mfma_f32_16x16x32_bf16 v[4:7], a[4:7], a[32:35], v[4:7]
  s_add_u32 s42, s90, 63488
  ds_read_b128 a[96:99], v210 offset:6656
  v_mfma_f32_16x16x32_bf16 v[36:39], a[4:7], a[36:39], v[36:39]
  ds_read_b128 a[100:103], v210 offset:8704
  ds_read_b64_tr_b16 a[56:57], v209 offset:0
  v_mfma_f32_16x16x32_bf16 v[68:71], a[4:7], a[40:43], v[68:71]
  ds_read_b64_tr_b16 a[58:59], v209 offset:1024
  ds_read_b64_tr_b16 a[60:61], v206 offset:256
  v_mfma_f32_16x16x32_bf16 v[100:103], a[4:7], a[44:47], v[100:103]
  buffer_load_dwordx4 v201, s[8:11], s42 offen offset:2048 lds
  ds_read_b64_tr_b16 a[62:63], v206 offset:1280
  v_mfma_f32_16x16x32_bf16 v[132:135], a[4:7], a[48:51], v[132:135]
  s_add_u32 s42, s90, 95232
  ds_read_b64_tr_b16 a[64:65], v209 offset:256
  v_mfma_f32_16x16x32_bf16 v[8:11], a[8:11], a[32:35], v[8:11]
  ds_read_b64_tr_b16 a[66:67], v209 offset:1280
  ds_read_b64_tr_b16 a[68:69], v206 offset:512
  v_mfma_f32_16x16x32_bf16 v[40:43], a[8:11], a[36:39], v[40:43]
  ds_read_b64_tr_b16 a[70:71], v206 offset:1536
  s_waitcnt lgkmcnt(11)
  ds_read_b64_tr_b16 a[72:73], v209 offset:512
  v_mfma_f32_16x16x32_bf16 v[72:75], a[8:11], a[40:43], v[72:75]
  buffer_load_dwordx4 v201, s[8:11], s42 offen offset:3072 lds
  s_add_u32 s90, s88, s32
  v_mfma_f32_16x16x32_bf16 v[104:107], a[8:11], a[44:47], v[104:107]
  s_add_u32 s88, s88, 262144
  ds_read_b64_tr_b16 a[74:75], v209 offset:1536
  v_mfma_f32_16x16x32_bf16 v[136:139], a[8:11], a[48:51], v[136:139]
  s_cmp_eq_u32 s88, 0x400000
  s_cselect_b32 s88, 0x80000, s88
  v_mfma_f32_16x16x32_bf16 v[12:15], a[12:15], a[32:35], v[12:15]
  s_add_u32 m0, s31, 32768
  s_add_u32 s44, s30, 16384
  v_mfma_f32_16x16x32_bf16 v[44:47], a[12:15], a[36:39], v[44:47]
  buffer_load_dwordx4 v249, s[12:15], s44 offen offset:0 nt lds
  ds_read_b64_tr_b16 a[76:77], v206 offset:768
  v_mfma_f32_16x16x32_bf16 v[76:79], a[12:15], a[40:43], v[76:79]
  ds_read_b64_tr_b16 a[78:79], v206 offset:1792
  s_waitcnt lgkmcnt(11)
  ds_read_b64_tr_b16 a[80:81], v209 offset:768
  v_mfma_f32_16x16x32_bf16 v[108:111], a[12:15], a[44:47], v[108:111]
  ds_read_b64_tr_b16 a[82:83], v209 offset:1792
  v_mfma_f32_16x16x32_bf16 v[140:143], a[12:15], a[48:51], v[140:143]
  v_mfma_f32_16x16x32_bf16 v[16:19], a[16:19], a[32:35], v[16:19]
  buffer_load_dwordx4 v250, s[12:15], s44 offen offset:1024 nt lds
  v_mfma_f32_16x16x32_bf16 v[48:51], a[16:19], a[36:39], v[48:51]
  v_mfma_f32_16x16x32_bf16 v[80:83], a[16:19], a[40:43], v[80:83]
  v_mfma_f32_16x16x32_bf16 v[112:115], a[16:19], a[44:47], v[112:115]
  v_mfma_f32_16x16x32_bf16 v[144:147], a[16:19], a[48:51], v[144:147]
  buffer_load_dwordx4 v249, s[12:15], s44 offen offset:2048 nt lds
  v_mfma_f32_16x16x32_bf16 v[20:23], a[20:23], a[32:35], v[20:23]
  v_mfma_f32_16x16x32_bf16 v[52:55], a[20:23], a[36:39], v[52:55]
  v_mfma_f32_16x16x32_bf16 v[84:87], a[20:23], a[40:43], v[84:87]
  v_mfma_f32_16x16x32_bf16 v[116:119], a[20:23], a[44:47], v[116:119]
  buffer_load_dwordx4 v250, s[12:15], s44 offen offset:3072 nt lds
  v_mfma_f32_16x16x32_bf16 v[148:151], a[20:23], a[48:51], v[148:151]
  s_add_u32 s44, s30, 24576
  v_mfma_f32_16x16x32_bf16 v[24:27], a[24:27], a[32:35], v[24:27]
  v_mfma_f32_16x16x32_bf16 v[56:59], a[24:27], a[36:39], v[56:59]
  v_mfma_f32_16x16x32_bf16 v[88:91], a[24:27], a[40:43], v[88:91]
  buffer_load_dwordx4 a[160:163], v249, s[12:15], s44 offen offset:0 nt
  v_mfma_f32_16x16x32_bf16 v[120:123], a[24:27], a[44:47], v[120:123]
  v_mfma_f32_16x16x32_bf16 v[152:155], a[24:27], a[48:51], v[152:155]
  v_mfma_f32_16x16x32_bf16 v[28:31], a[28:31], a[32:35], v[28:31]
  v_mfma_f32_16x16x32_bf16 v[60:63], a[28:31], a[36:39], v[60:63]
  buffer_load_dwordx4 a[164:167], v250, s[12:15], s44 offen offset:1024 nt
  v_mfma_f32_16x16x32_bf16 v[92:95], a[28:31], a[40:43], v[92:95]
  v_mfma_f32_16x16x32_bf16 v[124:127], a[28:31], a[44:47], v[124:127]
  v_mfma_f32_16x16x32_bf16 v[156:159], a[28:31], a[48:51], v[156:159]
  s_waitcnt vmcnt(10)
  s_waitcnt lgkmcnt(0)
  s_barrier
  v_mfma_f32_16x16x32_bf16 v[0:3], a[52:55], a[84:87], v[0:3]
  s_add_u32 m0, s31, 102400
  s_add_u32 s42, s90, 0
  v_mfma_f32_16x16x32_bf16 v[32:35], a[52:55], a[88:91], v[32:35]
  buffer_load_dwordx4 v200, s[8:11], s42 offen offset:0 lds
  ds_read_b64_tr_b16 a[0:1], v204 offset:0
  v_mfma_f32_16x16x32_bf16 v[64:67], a[52:55], a[92:95], v[64:67]
  s_add_u32 s42, s90, 31744
  ds_read_b64_tr_b16 a[2:3], v204 offset:1024
  v_mfma_f32_16x16x32_bf16 v[96:99], a[52:55], a[96:99], v[96:99]
  ds_read_b128 a[32:35], v211 offset:0
  ds_read_b128 a[36:39], v211 offset:2048
  v_mfma_f32_16x16x32_bf16 v[128:131], a[52:55], a[100:103], v[128:131]
  ds_read_b128 a[40:43], v211 offset:4096
  ds_read_b128 a[44:47], v211 offset:6144
  v_mfma_f32_16x16x32_bf16 v[4:7], a[56:59], a[84:87], v[4:7]
  buffer_load_dwordx4 v200, s[8:11], s42 offen offset:1024 lds
  ds_read_b128 a[48:51], v211 offset:8192
  v_mfma_f32_16x16x32_bf16 v[36:39], a[56:59], a[88:91], v[36:39]
  s_add_u32 s42, s90, 63488
  ds_read_b64_tr_b16 a[4:5], v207 offset:0
  v_mfma_f32_16x16x32_bf16 v[68:71], a[56:59], a[92:95], v[68:71]
  ds_read_b64_tr_b16 a[6:7], v207 offset:1024
  ds_read_b64_tr_b16 a[8:9], v204 offset:256
  v_mfma_f32_16x16x32_bf16 v[100:103], a[56:59], a[96:99], v[100:103]
  ds_read_b64_tr_b16 a[10:11], v204 offset:1280
  ds_read_b64_tr_b16 a[12:13], v207 offset:256
  v_mfma_f32_16x16x32_bf16 v[132:135], a[56:59], a[100:103], v[132:135]
  buffer_load_dwordx4 v201, s[8:11], s42 offen offset:2048 lds
  ds_read_b64_tr_b16 a[14:15], v207 offset:1280
  v_mfma_f32_16x16x32_bf16 v[8:11], a[60:63], a[84:87], v[8:11]
  s_add_u32 s42, s90, 95232
  ds_read_b64_tr_b16 a[16:17], v204 offset:512
  v_mfma_f32_16x16x32_bf16 v[40:43], a[60:63], a[88:91], v[40:43]
  ds_read_b64_tr_b16 a[18:19], v204 offset:1536
  s_waitcnt lgkmcnt(11)
  ds_read_b64_tr_b16 a[20:21], v207 offset:512
  v_mfma_f32_16x16x32_bf16 v[72:75], a[60:63], a[92:95], v[72:75]
  ds_read_b64_tr_b16 a[22:23], v207 offset:1536
  ds_read_b64_tr_b16 a[24:25], v204 offset:768
  v_mfma_f32_16x16x32_bf16 v[104:107], a[60:63], a[96:99], v[104:107]
  buffer_load_dwordx4 v201, s[8:11], s42 offen offset:3072 lds
  s_add_u32 s90, s88, s32
  v_mfma_f32_16x16x32_bf16 v[136:139], a[60:63], a[100:103], v[136:139]
  s_add_u32 s88, s88, 262144
  ds_read_b64_tr_b16 a[26:27], v204 offset:1792
  v_mfma_f32_16x16x32_bf16 v[12:15], a[64:67], a[84:87], v[12:15]
  s_cmp_eq_u32 s88, 0x400000
  s_cselect_b32 s88, 0x80000, s88
  v_mfma_f32_16x16x32_bf16 v[44:47], a[64:67], a[88:91], v[44:47]
  s_add_u32 m0, s34, 81920
  s_add_u32 s42, s91, 0
  v_mfma_f32_16x16x32_bf16 v[76:79], a[64:67], a[92:95], v[76:79]
  buffer_load_dwordx4 v202, s[4:7], s42 offen offset:0 lds
  s_waitcnt lgkmcnt(11)
  ds_read_b64_tr_b16 a[28:29], v207 offset:768
  v_mfma_f32_16x16x32_bf16 v[108:111], a[64:67], a[96:99], v[108:111]
  s_add_u32 s42, s91, 7168
  ds_read_b64_tr_b16 a[30:31], v207 offset:1792
  v_mfma_f32_16x16x32_bf16 v[140:143], a[64:67], a[100:103], v[140:143]
  v_mfma_f32_16x16x32_bf16 v[16:19], a[68:71], a[84:87], v[16:19]
  v_mfma_f32_16x16x32_bf16 v[48:51], a[68:71], a[88:91], v[48:51]
  buffer_load_dwordx4 v203, s[4:7], s42 offen offset:1024 lds
  v_mfma_f32_16x16x32_bf16 v[80:83], a[68:71], a[92:95], v[80:83]
  s_add_u32 s42, s91, 14336
  v_mfma_f32_16x16x32_bf16 v[112:115], a[68:71], a[96:99], v[112:115]
  v_mfma_f32_16x16x32_bf16 v[144:147], a[68:71], a[100:103], v[144:147]
  v_mfma_f32_16x16x32_bf16 v[20:23], a[72:75], a[84:87], v[20:23]
  buffer_load_dwordx4 v202, s[4:7], s42 offen offset:2048 lds
  v_mfma_f32_16x16x32_bf16 v[52:55], a[72:75], a[88:91], v[52:55]
  s_add_u32 s42, s91, 21504
  v_mfma_f32_16x16x32_bf16 v[84:87], a[72:75], a[92:95], v[84:87]
  v_mfma_f32_16x16x32_bf16 v[116:119], a[72:75], a[96:99], v[116:119]
  v_mfma_f32_16x16x32_bf16 v[148:151], a[72:75], a[100:103], v[148:151]
  buffer_load_dwordx4 v203, s[4:7], s42 offen offset:3072 lds
  v_mfma_f32_16x16x32_bf16 v[24:27], a[76:79], a[84:87], v[24:27]
  s_add_u32 m0, s34, 86016
  s_add_u32 s42, s91, 32768
  v_mfma_f32_16x16x32_bf16 v[56:59], a[76:79], a[88:91], v[56:59]
  v_mfma_f32_16x16x32_bf16 v[88:91], a[76:79], a[92:95], v[88:91]
  v_mfma_f32_16x16x32_bf16 v[120:123], a[76:79], a[96:99], v[120:123]
  buffer_load_dwordx4 v202, s[4:7], s42 offen offset:0 lds
  s_add_u32 s91, s89, s33
  v_mfma_f32_16x16x32_bf16 v[152:155], a[76:79], a[100:103], v[152:155]
  s_add_u32 s89, s89, 128
  v_mfma_f32_16x16x32_bf16 v[28:31], a[80:83], a[84:87], v[28:31]
  s_cmp_eq_u32 s89, 1024
  s_cselect_b32 s89, 128, s89
  v_mfma_f32_16x16x32_bf16 v[60:63], a[80:83], a[88:91], v[60:63]
  v_mfma_f32_16x16x32_bf16 v[92:95], a[80:83], a[92:95], v[92:95]
  v_mfma_f32_16x16x32_bf16 v[124:127], a[80:83], a[96:99], v[124:127]
  v_mfma_f32_16x16x32_bf16 v[156:159], a[80:83], a[100:103], v[156:159]
  s_waitcnt vmcnt(15)
  s_waitcnt lgkmcnt(0)
  s_barrier
  v_mfma_f32_16x16x32_bf16 v[0:3], a[0:3], a[32:35], v[0:3]
  s_add_u32 m0, s31, 147456
  s_add_u32 s42, s90, 0
  v_mfma_f32_16x16x32_bf16 v[32:35], a[0:3], a[36:39], v[32:35]
  buffer_load_dwordx4 v200, s[8:11], s42 offen offset:0 lds
  s_add_u32 s42, s90, 31744
  v_mfma_f32_16x16x32_bf16 v[64:67], a[0:3], a[40:43], v[64:67]
  ds_read_b64_tr_b16 a[52:53], v205 offset:0
  ds_read_b64_tr_b16 a[54:55], v205 offset:1024
  v_mfma_f32_16x16x32_bf16 v[96:99], a[0:3], a[44:47], v[96:99]
  ds_read_b128 a[84:87], v211 offset:512
  ds_read_b128 a[88:91], v211 offset:2560
  v_mfma_f32_16x16x32_bf16 v[128:131], a[0:3], a[48:51], v[128:131]
  buffer_load_dwordx4 v200, s[8:11], s42 offen offset:1024 lds
  ds_read_b128 a[92:95], v211 offset:4608
  v_mfma_f32_16x16x32_bf16 v[4:7], a[4:7], a[32:35], v[4:7]
  s_add_u32 s42, s90, 63488
  ds_read_b128 a[96:99], v211 offset:6656
  v_mfma_f32_16x16x32_bf16 v[36:39], a[4:7], a[36:39], v[36:39]
  ds_read_b128 a[100:103], v211 offset:8704
  ds_read_b64_tr_b16 a[56:57], v208 offset:0
  v_mfma_f32_16x16x32_bf16 v[68:71], a[4:7], a[40:43], v[68:71]
  ds_read_b64_tr_b16 a[58:59], v208 offset:1024
  ds_read_b64_tr_b16 a[60:61], v205 offset:256
  v_mfma_f32_16x16x32_bf16 v[100:103], a[4:7], a[44:47], v[100:103]
  buffer_load_dwordx4 v201, s[8:11], s42 offen offset:2048 lds
  ds_read_b64_tr_b16 a[62:63], v205 offset:1280
  v_mfma_f32_16x16x32_bf16 v[132:135], a[4:7], a[48:51], v[132:135]
  s_add_u32 s42, s90, 95232
  ds_read_b64_tr_b16 a[64:65], v208 offset:256
  v_mfma_f32_16x16x32_bf16 v[8:11], a[8:11], a[32:35], v[8:11]
  ds_read_b64_tr_b16 a[66:67], v208 offset:1280
  ds_read_b64_tr_b16 a[68:69], v205 offset:512
  v_mfma_f32_16x16x32_bf16 v[40:43], a[8:11], a[36:39], v[40:43]
  ds_read_b64_tr_b16 a[70:71], v205 offset:1536
  s_waitcnt lgkmcnt(11)
  ds_read_b64_tr_b16 a[72:73], v208 offset:512
  v_mfma_f32_16x16x32_bf16 v[72:75], a[8:11], a[40:43], v[72:75]
  buffer_load_dwordx4 v201, s[8:11], s42 offen offset:3072 lds
  s_add_u32 s90, s88, s32
  v_mfma_f32_16x16x32_bf16 v[104:107], a[8:11], a[44:47], v[104:107]
  s_add_u32 s88, s88, 262144
  ds_read_b64_tr_b16 a[74:75], v208 offset:1536
  v_mfma_f32_16x16x32_bf16 v[136:139], a[8:11], a[48:51], v[136:139]
  s_cmp_eq_u32 s88, 0x400000
  s_cselect_b32 s88, 0x80000, s88
  v_mfma_f32_16x16x32_bf16 v[12:15], a[12:15], a[32:35], v[12:15]
  ds_read_b64_tr_b16 a[76:77], v205 offset:768
  v_mfma_f32_16x16x32_bf16 v[44:47], a[12:15], a[36:39], v[44:47]
  buffer_load_dwordx4 a[168:171], v249, s[12:15], s44 offen offset:2048 nt
  ds_read_b64_tr_b16 a[78:79], v205 offset:1792
  v_mfma_f32_16x16x32_bf16 v[76:79], a[12:15], a[40:43], v[76:79]
  s_waitcnt lgkmcnt(11)
  ds_read_b64_tr_b16 a[80:81], v208 offset:768
  ds_read_b64_tr_b16 a[82:83], v208 offset:1792
  v_mfma_f32_16x16x32_bf16 v[108:111], a[12:15], a[44:47], v[108:111]
  v_mfma_f32_16x16x32_bf16 v[140:143], a[12:15], a[48:51], v[140:143]
  v_mfma_f32_16x16x32_bf16 v[16:19], a[16:19], a[32:35], v[16:19]
  buffer_load_dwordx4 a[172:175], v250, s[12:15], s44 offen offset:3072 nt
  v_mfma_f32_16x16x32_bf16 v[48:51], a[16:19], a[36:39], v[48:51]
  s_add_u32 s44, s30, 16384
  v_mfma_f32_16x16x32_bf16 v[80:83], a[16:19], a[40:43], v[80:83]
  v_mfma_f32_16x16x32_bf16 v[112:115], a[16:19], a[44:47], v[112:115]
  v_mfma_f32_16x16x32_bf16 v[144:147], a[16:19], a[48:51], v[144:147]
  buffer_load_dwordx4 a[176:179], v249, s[16:19], s44 offen offset:0 nt
  v_mfma_f32_16x16x32_bf16 v[20:23], a[20:23], a[32:35], v[20:23]
  v_mfma_f32_16x16x32_bf16 v[52:55], a[20:23], a[36:39], v[52:55]
  v_mfma_f32_16x16x32_bf16 v[84:87], a[20:23], a[40:43], v[84:87]
  v_mfma_f32_16x16x32_bf16 v[116:119], a[20:23], a[44:47], v[116:119]
  buffer_load_dwordx4 a[180:183], v250, s[16:19], s44 offen offset:1024 nt
  v_mfma_f32_16x16x32_bf16 v[148:151], a[20:23], a[48:51], v[148:151]
  v_mfma_f32_16x16x32_bf16 v[24:27], a[24:27], a[32:35], v[24:27]
  v_mfma_f32_16x16x32_bf16 v[56:59], a[24:27], a[36:39], v[56:59]
  v_mfma_f32_16x16x32_bf16 v[88:91], a[24:27], a[40:43], v[88:91]
  buffer_load_dwordx4 a[184:187], v249, s[16:19], s44 offen offset:2048 nt
  v_mfma_f32_16x16x32_bf16 v[120:123], a[24:27], a[44:47], v[120:123]
  v_mfma_f32_16x16x32_bf16 v[152:155], a[24:27], a[48:51], v[152:155]
  v_mfma_f32_16x16x32_bf16 v[28:31], a[28:31], a[32:35], v[28:31]
  v_mfma_f32_16x16x32_bf16 v[60:63], a[28:31], a[36:39], v[60:63]
  buffer_load_dwordx4 a[188:191], v250, s[16:19], s44 offen offset:3072 nt
  v_mfma_f32_16x16x32_bf16 v[92:95], a[28:31], a[40:43], v[92:95]
  v_mfma_f32_16x16x32_bf16 v[124:127], a[28:31], a[44:47], v[124:127]
  v_mfma_f32_16x16x32_bf16 v[156:159], a[28:31], a[48:51], v[156:159]
  s_waitcnt vmcnt(10)
  s_waitcnt lgkmcnt(0)
  s_barrier
  v_mfma_f32_16x16x32_bf16 v[0:3], a[52:55], a[84:87], v[0:3]
  s_add_u32 m0, s31, 65536
  s_add_u32 s42, s90, 0
  v_mfma_f32_16x16x32_bf16 v[32:35], a[52:55], a[88:91], v[32:35]
  buffer_load_dwordx4 v200, s[8:11], s42 offen offset:0 lds
  ds_read_b64_tr_b16 a[0:1], v206 offset:0
  v_mfma_f32_16x16x32_bf16 v[64:67], a[52:55], a[92:95], v[64:67]
  s_add_u32 s42, s90, 31744
  ds_read_b64_tr_b16 a[2:3], v206 offset:1024
  v_mfma_f32_16x16x32_bf16 v[96:99], a[52:55], a[96:99], v[96:99]
  ds_read_b128 a[32:35], v210 offset:0
  ds_read_b128 a[36:39], v210 offset:2048
  v_mfma_f32_16x16x32_bf16 v[128:131], a[52:55], a[100:103], v[128:131]
  ds_read_b128 a[40:43], v210 offset:4096
  ds_read_b128 a[44:47], v210 offset:6144
  v_mfma_f32_16x16x32_bf16 v[4:7], a[56:59], a[84:87], v[4:7]
  buffer_load_dwordx4 v200, s[8:11], s42 offen offset:1024 lds
  ds_read_b128 a[48:51], v210 offset:8192
  v_mfma_f32_16x16x32_bf16 v[36:39], a[56:59], a[88:91], v[36:39]
  s_add_u32 s42, s90, 63488
  ds_read_b64_tr_b16 a[4:5], v209 offset:0
  v_mfma_f32_16x16x32_bf16 v[68:71], a[56:59], a[92:95], v[68:71]
  ds_read_b64_tr_b16 a[6:7], v209 offset:1024
  ds_read_b64_tr_b16 a[8:9], v206 offset:256
  v_mfma_f32_16x16x32_bf16 v[100:103], a[56:59], a[96:99], v[100:103]
  ds_read_b64_tr_b16 a[10:11], v206 offset:1280
  ds_read_b64_tr_b16 a[12:13], v209 offset:256
  v_mfma_f32_16x16x32_bf16 v[132:135], a[56:59], a[100:103], v[132:135]
  buffer_load_dwordx4 v201, s[8:11], s42 offen offset:2048 lds
  ds_read_b64_tr_b16 a[14:15], v209 offset:1280
  v_mfma_f32_16x16x32_bf16 v[8:11], a[60:63], a[84:87], v[8:11]
  s_add_u32 s42, s90, 95232
  ds_read_b64_tr_b16 a[16:17], v206 offset:512
  v_mfma_f32_16x16x32_bf16 v[40:43], a[60:63], a[88:91], v[40:43]
  ds_read_b64_tr_b16 a[18:19], v206 offset:1536
  s_waitcnt lgkmcnt(11)
  ds_read_b64_tr_b16 a[20:21], v209 offset:512
  v_mfma_f32_16x16x32_bf16 v[72:75], a[60:63], a[92:95], v[72:75]
  ds_read_b64_tr_b16 a[22:23], v209 offset:1536
  ds_read_b64_tr_b16 a[24:25], v206 offset:768
  v_mfma_f32_16x16x32_bf16 v[104:107], a[60:63], a[96:99], v[104:107]
  buffer_load_dwordx4 v201, s[8:11], s42 offen offset:3072 lds
  s_add_u32 s90, s88, s32
  v_mfma_f32_16x16x32_bf16 v[136:139], a[60:63], a[100:103], v[136:139]
  s_add_u32 s88, s88, 262144
  ds_read_b64_tr_b16 a[26:27], v206 offset:1792
  v_mfma_f32_16x16x32_bf16 v[12:15], a[64:67], a[84:87], v[12:15]
  s_cmp_eq_u32 s88, 0x400000
  s_cselect_b32 s88, 0x80000, s88
  v_mfma_f32_16x16x32_bf16 v[44:47], a[64:67], a[88:91], v[44:47]
  s_add_u32 m0, s34, 126976
  s_add_u32 s42, s91, 0
  v_mfma_f32_16x16x32_bf16 v[76:79], a[64:67], a[92:95], v[76:79]
  buffer_load_dwordx4 v202, s[4:7], s42 offen offset:0 lds
  s_waitcnt lgkmcnt(11)
  ds_read_b64_tr_b16 a[28:29], v209 offset:768
  v_mfma_f32_16x16x32_bf16 v[108:111], a[64:67], a[96:99], v[108:111]
  s_add_u32 s42, s91, 7168
  ds_read_b64_tr_b16 a[30:31], v209 offset:1792
  v_mfma_f32_16x16x32_bf16 v[140:143], a[64:67], a[100:103], v[140:143]
  v_mfma_f32_16x16x32_bf16 v[16:19], a[68:71], a[84:87], v[16:19]
  v_mfma_f32_16x16x32_bf16 v[48:51], a[68:71], a[88:91], v[48:51]
  buffer_load_dwordx4 v203, s[4:7], s42 offen offset:1024 lds
  v_mfma_f32_16x16x32_bf16 v[80:83], a[68:71], a[92:95], v[80:83]
  s_add_u32 s42, s91, 14336
  v_mfma_f32_16x16x32_bf16 v[112:115], a[68:71], a[96:99], v[112:115]
  v_mfma_f32_16x16x32_bf16 v[144:147], a[68:71], a[100:103], v[144:147]
  v_mfma_f32_16x16x32_bf16 v[20:23], a[72:75], a[84:87], v[20:23]
  buffer_load_dwordx4 v202, s[4:7], s42 offen offset:2048 lds
  v_mfma_f32_16x16x32_bf16 v[52:55], a[72:75], a[88:91], v[52:55]
  s_add_u32 s42, s91, 21504
  v_mfma_f32_16x16x32_bf16 v[84:87], a[72:75], a[92:95], v[84:87]
  v_mfma_f32_16x16x32_bf16 v[116:119], a[72:75], a[96:99], v[116:119]
  v_mfma_f32_16x16x32_bf16 v[148:151], a[72:75], a[100:103], v[148:151]
  buffer_load_dwordx4 v203, s[4:7], s42 offen offset:3072 lds
  v_mfma_f32_16x16x32_bf16 v[24:27], a[76:79], a[84:87], v[24:27]
  s_add_u32 m0, s34, 131072
  s_add_u32 s42, s91, 32768
  v_mfma_f32_16x16x32_bf16 v[56:59], a[76:79], a[88:91], v[56:59]
  v_mfma_f32_16x16x32_bf16 v[88:91], a[76:79], a[92:95], v[88:91]
  v_mfma_f32_16x16x32_bf16 v[120:123], a[76:79], a[96:99], v[120:123]
  buffer_load_dwordx4 v202, s[4:7], s42 offen offset:0 lds
  s_add_u32 s91, s89, s33
  v_mfma_f32_16x16x32_bf16 v[152:155], a[76:79], a[100:103], v[152:155]
  s_add_u32 s89, s89, 128
  v_mfma_f32_16x16x32_bf16 v[28:31], a[80:83], a[84:87], v[28:31]
  s_cmp_eq_u32 s89, 1024
  s_cselect_b32 s89, 128, s89
  v_mfma_f32_16x16x32_bf16 v[60:63], a[80:83], a[88:91], v[60:63]
  v_mfma_f32_16x16x32_bf16 v[92:95], a[80:83], a[92:95], v[92:95]
  v_mfma_f32_16x16x32_bf16 v[124:127], a[80:83], a[96:99], v[124:127]
  v_mfma_f32_16x16x32_bf16 v[156:159], a[80:83], a[100:103], v[156:159]
  s_waitcnt vmcnt(15)
  s_waitcnt lgkmcnt(0)
  s_barrier
  v_mfma_f32_16x16x32_bf16 v[0:3], a[0:3], a[32:35], v[0:3]
  s_add_u32 m0, s31, 102400
  s_add_u32 s42, s90, 0
  v_mfma_f32_16x16x32_bf16 v[32:35], a[0:3], a[36:39], v[32:35]
  buffer_load_dwordx4 v200, s[8:11], s42 offen offset:0 lds
  s_add_u32 s42, s90, 31744
  v_mfma_f32_16x16x32_bf16 v[64:67], a[0:3], a[40:43], v[64:67]
  ds_read_b64_tr_b16 a[52:53], v204 offset:0
  ds_read_b64_tr_b16 a[54:55], v204 offset:1024
  v_mfma_f32_16x16x32_bf16 v[96:99], a[0:3], a[44:47], v[96:99]
  ds_read_b128 a[84:87], v210 offset:512
  ds_read_b128 a[88:91], v210 offset:2560
  v_mfma_f32_16x16x32_bf16 v[128:131], a[0:3], a[48:51], v[128:131]
  buffer_load_dwordx4 v200, s[8:11], s42 offen offset:1024 lds
  ds_read_b128 a[92:95], v210 offset:4608
  v_mfma_f32_16x16x32_bf16 v[4:7], a[4:7], a[32:35], v[4:7]
  s_add_u32 s42, s90, 63488
  ds_read_b128 a[96:99], v210 offset:6656
  v_mfma_f32_16x16x32_bf16 v[36:39], a[4:7], a[36:39], v[36:39]
  ds_read_b128 a[100:103], v210 offset:8704
  ds_read_b64_tr_b16 a[56:57], v207 offset:0
  v_mfma_f32_16x16x32_bf16 v[68:71], a[4:7], a[40:43], v[68:71]
  ds_read_b64_tr_b16 a[58:59], v207 offset:1024
  ds_read_b64_tr_b16 a[60:61], v204 offset:256
  v_mfma_f32_16x16x32_bf16 v[100:103], a[4:7], a[44:47], v[100:103]
  buffer_load_dwordx4 v201, s[8:11], s42 offen offset:2048 lds
  ds_read_b64_tr_b16 a[62:63], v204 offset:1280
  v_mfma_f32_16x16x32_bf16 v[132:135], a[4:7], a[48:51], v[132:135]
  s_add_u32 s42, s90, 95232
  ds_read_b64_tr_b16 a[64:65], v207 offset:256
  v_mfma_f32_16x16x32_bf16 v[8:11], a[8:11], a[32:35], v[8:11]
  ds_read_b64_tr_b16 a[66:67], v207 offset:1280
  ds_read_b64_tr_b16 a[68:69], v204 offset:512
  v_mfma_f32_16x16x32_bf16 v[40:43], a[8:11], a[36:39], v[40:43]
  ds_read_b64_tr_b16 a[70:71], v204 offset:1536
  s_waitcnt lgkmcnt(11)
  ds_read_b64_tr_b16 a[72:73], v207 offset:512
  v_mfma_f32_16x16x32_bf16 v[72:75], a[8:11], a[40:43], v[72:75]
  buffer_load_dwordx4 v201, s[8:11], s42 offen offset:3072 lds
  s_add_u32 s90, s88, s32
  v_mfma_f32_16x16x32_bf16 v[104:107], a[8:11], a[44:47], v[104:107]
  s_add_u32 s88, s88, 262144
  ds_read_b64_tr_b16 a[74:75], v207 offset:1536
  v_mfma_f32_16x16x32_bf16 v[136:139], a[8:11], a[48:51], v[136:139]
  s_cmp_eq_u32 s88, 0x400000
  s_cselect_b32 s88, 0x80000, s88
  v_mfma_f32_16x16x32_bf16 v[12:15], a[12:15], a[32:35], v[12:15]
  s_add_u32 s44, s30, 32768
  ds_read_b64_tr_b16 a[76:77], v204 offset:768
  v_mfma_f32_16x16x32_bf16 v[44:47], a[12:15], a[36:39], v[44:47]
  buffer_load_dwordx4 a[192:195], v249, s[12:15], s44 offen offset:0 nt
  ds_read_b64_tr_b16 a[78:79], v204 offset:1792
  v_mfma_f32_16x16x32_bf16 v[76:79], a[12:15], a[40:43], v[76:79]
  s_waitcnt lgkmcnt(11)
  ds_read_b64_tr_b16 a[80:81], v207 offset:768
  ds_read_b64_tr_b16 a[82:83], v207 offset:1792
  v_mfma_f32_16x16x32_bf16 v[108:111], a[12:15], a[44:47], v[108:111]
  v_mfma_f32_16x16x32_bf16 v[140:143], a[12:15], a[48:51], v[140:143]
  v_mfma_f32_16x16x32_bf16 v[16:19], a[16:19], a[32:35], v[16:19]
  buffer_load_dwordx4 a[196:199], v250, s[12:15], s44 offen offset:1024 nt
  v_mfma_f32_16x16x32_bf16 v[48:51], a[16:19], a[36:39], v[48:51]
  v_mfma_f32_16x16x32_bf16 v[80:83], a[16:19], a[40:43], v[80:83]
  v_mfma_f32_16x16x32_bf16 v[112:115], a[16:19], a[44:47], v[112:115]
  v_mfma_f32_16x16x32_bf16 v[144:147], a[16:19], a[48:51], v[144:147]
  buffer_load_dwordx4 a[200:203], v249, s[12:15], s44 offen offset:2048 nt
  v_mfma_f32_16x16x32_bf16 v[20:23], a[20:23], a[32:35], v[20:23]
  v_mfma_f32_16x16x32_bf16 v[52:55], a[20:23], a[36:39], v[52:55]
  v_mfma_f32_16x16x32_bf16 v[84:87], a[20:23], a[40:43], v[84:87]
  v_mfma_f32_16x16x32_bf16 v[116:119], a[20:23], a[44:47], v[116:119]
  buffer_load_dwordx4 a[204:207], v250, s[12:15], s44 offen offset:3072 nt
  v_mfma_f32_16x16x32_bf16 v[148:151], a[20:23], a[48:51], v[148:151]
  s_add_u32 s44, s30, 24576
  v_mfma_f32_16x16x32_bf16 v[24:27], a[24:27], a[32:35], v[24:27]
  v_mfma_f32_16x16x32_bf16 v[56:59], a[24:27], a[36:39], v[56:59]
  v_mfma_f32_16x16x32_bf16 v[88:91], a[24:27], a[40:43], v[88:91]
  buffer_load_dwordx4 a[208:211], v249, s[16:19], s44 offen offset:0 nt
  v_mfma_f32_16x16x32_bf16 v[120:123], a[24:27], a[44:47], v[120:123]
  v_mfma_f32_16x16x32_bf16 v[152:155], a[24:27], a[48:51], v[152:155]
  v_mfma_f32_16x16x32_bf16 v[28:31], a[28:31], a[32:35], v[28:31]
  v_mfma_f32_16x16x32_bf16 v[60:63], a[28:31], a[36:39], v[60:63]
  buffer_load_dwordx4 a[212:215], v250, s[16:19], s44 offen offset:1024 nt
  v_mfma_f32_16x16x32_bf16 v[92:95], a[28:31], a[40:43], v[92:95]
  v_mfma_f32_16x16x32_bf16 v[124:127], a[28:31], a[44:47], v[124:127]
  v_mfma_f32_16x16x32_bf16 v[156:159], a[28:31], a[48:51], v[156:159]
  s_waitcnt vmcnt(10)
  s_waitcnt lgkmcnt(0)
  s_barrier
  v_mfma_f32_16x16x32_bf16 v[0:3], a[52:55], a[84:87], v[0:3]
  s_add_u32 m0, s31, 147456
  s_add_u32 s42, s90, 0
  v_mfma_f32_16x16x32_bf16 v[32:35], a[52:55], a[88:91], v[32:35]
  buffer_load_dwordx4 v200, s[8:11], s42 offen offset:0 lds
  ds_read_b64_tr_b16 a[0:1], v205 offset:0
  v_mfma_f32_16x16x32_bf16 v[64:67], a[52:55], a[92:95], v[64:67]
  s_add_u32 s42, s90, 31744
  ds_read_b64_tr_b16 a[2:3], v205 offset:1024
  v_mfma_f32_16x16x32_bf16 v[96:99], a[52:55], a[96:99], v[96:99]
  ds_read_b128 a[32:35], v211 offset:0
  ds_read_b128 a[36:39], v211 offset:2048
  v_mfma_f32_16x16x32_bf16 v[128:131], a[52:55], a[100:103], v[128:131]
  ds_read_b128 a[40:43], v211 offset:4096
  ds_read_b128 a[44:47], v211 offset:6144
  v_mfma_f32_16x16x32_bf16 v[4:7], a[56:59], a[84:87], v[4:7]
  buffer_load_dwordx4 v200, s[8:11], s42 offen offset:1024 lds
  ds_read_b128 a[48:51], v211 offset:8192
  v_mfma_f32_16x16x32_bf16 v[36:39], a[56:59], a[88:91], v[36:39]
  s_add_u32 s42, s90, 63488
  ds_read_b64_tr_b16 a[4:5], v208 offset:0
  v_mfma_f32_16x16x32_bf16 v[68:71], a[56:59], a[92:95], v[68:71]
  ds_read_b64_tr_b16 a[6:7], v208 offset:1024
  ds_read_b64_tr_b16 a[8:9], v205 offset:256
  v_mfma_f32_16x16x32_bf16 v[100:103], a[56:59], a[96:99], v[100:103]
  ds_read_b64_tr_b16 a[10:11], v205 offset:1280
  ds_read_b64_tr_b16 a[12:13], v208 offset:256
  v_mfma_f32_16x16x32_bf16 v[132:135], a[56:59], a[100:103], v[132:135]
  buffer_load_dwordx4 v201, s[8:11], s42 offen offset:2048 lds
  ds_read_b64_tr_b16 a[14:15], v208 offset:1280
  v_mfma_f32_16x16x32_bf16 v[8:11], a[60:63], a[84:87], v[8:11]
  s_add_u32 s42, s90, 95232
  ds_read_b64_tr_b16 a[16:17], v205 offset:512
  v_mfma_f32_16x16x32_bf16 v[40:43], a[60:63], a[88:91], v[40:43]
  ds_read_b64_tr_b16 a[18:19], v205 offset:1536
  s_waitcnt lgkmcnt(11)
  ds_read_b64_tr_b16 a[20:21], v208 offset:512
  v_mfma_f32_16x16x32_bf16 v[72:75], a[60:63], a[92:95], v[72:75]
  ds_read_b64_tr_b16 a[22:23], v208 offset:1536
  ds_read_b64_tr_b16 a[24:25], v205 offset:768
  v_mfma_f32_16x16x32_bf16 v[104:107], a[60:63], a[96:99], v[104:107]
  buffer_load_dwordx4 v201, s[8:11], s42 offen offset:3072 lds
  s_add_u32 s90, s88, s32
  v_mfma_f32_16x16x32_bf16 v[136:139], a[60:63], a[100:103], v[136:139]
  s_add_u32 s88, s88, 262144
  ds_read_b64_tr_b16 a[26:27], v205 offset:1792
  v_mfma_f32_16x16x32_bf16 v[12:15], a[64:67], a[84:87], v[12:15]
  s_cmp_eq_u32 s88, 0x400000
  s_cselect_b32 s88, 0x80000, s88
  v_mfma_f32_16x16x32_bf16 v[44:47], a[64:67], a[88:91], v[44:47]
  s_add_u32 m0, s34, 81920
  s_add_u32 s42, s91, 0
  v_mfma_f32_16x16x32_bf16 v[76:79], a[64:67], a[92:95], v[76:79]
  buffer_load_dwordx4 v202, s[4:7], s42 offen offset:0 lds
  s_waitcnt lgkmcnt(11)
  ds_read_b64_tr_b16 a[28:29], v208 offset:768
  v_mfma_f32_16x16x32_bf16 v[108:111], a[64:67], a[96:99], v[108:111]
  s_add_u32 s42, s91, 7168
  ds_read_b64_tr_b16 a[30:31], v208 offset:1792
  v_mfma_f32_16x16x32_bf16 v[140:143], a[64:67], a[100:103], v[140:143]
  v_mfma_f32_16x16x32_bf16 v[16:19], a[68:71], a[84:87], v[16:19]
  v_mfma_f32_16x16x32_bf16 v[48:51], a[68:71], a[88:91], v[48:51]
  buffer_load_dwordx4 v203, s[4:7], s42 offen offset:1024 lds
  v_mfma_f32_16x16x32_bf16 v[80:83], a[68:71], a[92:95], v[80:83]
  s_add_u32 s42, s91, 14336
  v_mfma_f32_16x16x32_bf16 v[112:115], a[68:71], a[96:99], v[112:115]
  v_mfma_f32_16x16x32_bf16 v[144:147], a[68:71], a[100:103], v[144:147]
  v_mfma_f32_16x16x32_bf16 v[20:23], a[72:75], a[84:87], v[20:23]
  buffer_load_dwordx4 v202, s[4:7], s42 offen offset:2048 lds
  v_mfma_f32_16x16x32_bf16 v[52:55], a[72:75], a[88:91], v[52:55]
  s_add_u32 s42, s91, 21504
  v_mfma_f32_16x16x32_bf16 v[84:87], a[72:75], a[92:95], v[84:87]
  v_mfma_f32_16x16x32_bf16 v[116:119], a[72:75], a[96:99], v[116:119]
  v_mfma_f32_16x16x32_bf16 v[148:151], a[72:75], a[100:103], v[148:151]
  buffer_load_dwordx4 v203, s[4:7], s42 offen offset:3072 lds
  v_mfma_f32_16x16x32_bf16 v[24:27], a[76:79], a[84:87], v[24:27]
  s_add_u32 m0, s34, 86016
  s_add_u32 s42, s91, 32768
  v_mfma_f32_16x16x32_bf16 v[56:59], a[76:79], a[88:91], v[56:59]
  v_mfma_f32_16x16x32_bf16 v[88:91], a[76:79], a[92:95], v[88:91]
  v_mfma_f32_16x16x32_bf16 v[120:123], a[76:79], a[96:99], v[120:123]
  buffer_load_dwordx4 v202, s[4:7], s42 offen offset:0 lds
  s_add_u32 s91, s89, s33
  v_mfma_f32_16x16x32_bf16 v[152:155], a[76:79], a[100:103], v[152:155]
  s_add_u32 s89, s89, 128
  v_mfma_f32_16x16x32_bf16 v[28:31], a[80:83], a[84:87], v[28:31]
  s_cmp_eq_u32 s89, 1024
  s_cselect_b32 s89, 128, s89
  v_mfma_f32_16x16x32_bf16 v[60:63], a[80:83], a[88:91], v[60:63]
  v_mfma_f32_16x16x32_bf16 v[92:95], a[80:83], a[92:95], v[92:95]
  v_mfma_f32_16x16x32_bf16 v[124:127], a[80:83], a[96:99], v[124:127]
  v_mfma_f32_16x16x32_bf16 v[156:159], a[80:83], a[100:103], v[156:159]
  s_waitcnt vmcnt(15)
  s_waitcnt lgkmcnt(0)
  s_barrier
  v_mfma_f32_16x16x32_bf16 v[0:3], a[0:3], a[32:35], v[0:3]
  s_add_u32 m0, s31, 65536
  s_add_u32 s42, s90, 0
  v_mfma_f32_16x16x32_bf16 v[32:35], a[0:3], a[36:39], v[32:35]
  buffer_load_dwordx4 v200, s[8:11], s42 offen offset:0 lds
  ds_read_b64_tr_b16 a[52:53], v206 offset:0
  v_mfma_f32_16x16x32_bf16 v[64:67], a[0:3], a[40:43], v[64:67]
  s_add_u32 s42, s90, 31744
  ds_read_b64_tr_b16 a[54:55], v206 offset:1024
  v_mfma_f32_16x16x32_bf16 v[96:99], a[0:3], a[44:47], v[96:99]
  ds_read_b128 a[84:87], v211 offset:512
  ds_read_b128 a[88:91], v211 offset:2560
  v_mfma_f32_16x16x32_bf16 v[128:131], a[0:3], a[48:51], v[128:131]
  ds_read_b128 a[92:95], v211 offset:4608
  ds_read_b128 a[96:99], v211 offset:6656
  v_mfma_f32_16x16x32_bf16 v[4:7], a[4:7], a[32:35], v[4:7]
  buffer_load_dwordx4 v200, s[8:11], s42 offen offset:1024 lds
  ds_read_b128 a[100:103], v211 offset:8704
  v_mfma_f32_16x16x32_bf16 v[36:39], a[4:7], a[36:39], v[36:39]
  s_add_u32 s42, s90, 63488
  ds_read_b64_tr_b16 a[56:57], v209 offset:0
  v_mfma_f32_16x16x32_bf16 v[68:71], a[4:7], a[40:43], v[68:71]
  ds_read_b64_tr_b16 a[58:59], v209 offset:1024
  ds_read_b64_tr_b16 a[60:61], v206 offset:256
  v_mfma_f32_16x16x32_bf16 v[100:103], a[4:7], a[44:47], v[100:103]
  ds_read_b64_tr_b16 a[62:63], v206 offset:1280
  ds_read_b64_tr_b16 a[64:65], v209 offset:256
  v_mfma_f32_16x16x32_bf16 v[132:135], a[4:7], a[48:51], v[132:135]
  buffer_load_dwordx4 v201, s[8:11], s42 offen offset:2048 lds
  ds_read_b64_tr_b16 a[66:67], v209 offset:1280
  v_mfma_f32_16x16x32_bf16 v[8:11], a[8:11], a[32:35], v[8:11]
  s_add_u32 s42, s90, 95232
  ds_read_b64_tr_b16 a[68:69], v206 offset:512
  v_mfma_f32_16x16x32_bf16 v[40:43], a[8:11], a[36:39], v[40:43]
  ds_read_b64_tr_b16 a[70:71], v206 offset:1536
  s_waitcnt lgkmcnt(11)
  ds_read_b64_tr_b16 a[72:73], v209 offset:512
  v_mfma_f32_16x16x32_bf16 v[72:75], a[8:11], a[40:43], v[72:75]
  ds_read_b64_tr_b16 a[74:75], v209 offset:1536
  ds_read_b64_tr_b16 a[76:77], v206 offset:768
  v_mfma_f32_16x16x32_bf16 v[104:107], a[8:11], a[44:47], v[104:107]
  buffer_load_dwordx4 v201, s[8:11], s42 offen offset:3072 lds
  s_add_u32 s90, s88, s32
  v_mfma_f32_16x16x32_bf16 v[136:139], a[8:11], a[48:51], v[136:139]
  s_add_u32 s88, s88, 262144
  ds_read_b64_tr_b16 a[78:79], v206 offset:1792
  v_mfma_f32_16x16x32_bf16 v[12:15], a[12:15], a[32:35], v[12:15]
  s_cmp_eq_u32 s88, 0x400000
  s_cselect_b32 s88, 0x80000, s88
  v_mfma_f32_16x16x32_bf16 v[44:47], a[12:15], a[36:39], v[44:47]
  s_waitcnt lgkmcnt(11)
  ds_read_b64_tr_b16 a[80:81], v209 offset:768
  v_mfma_f32_16x16x32_bf16 v[76:79], a[12:15], a[40:43], v[76:79]
  buffer_load_dwordx4 a[216:219], v249, s[16:19], s44 offen offset:2048 nt
  ds_read_b64_tr_b16 a[82:83], v209 offset:1792
  v_mfma_f32_16x16x32_bf16 v[108:111], a[12:15], a[44:47], v[108:111]
  v_mfma_f32_16x16x32_bf16 v[140:143], a[12:15], a[48:51], v[140:143]
  v_mfma_f32_16x16x32_bf16 v[16:19], a[16:19], a[32:35], v[16:19]
  v_mfma_f32_16x16x32_bf16 v[48:51], a[16:19], a[36:39], v[48:51]
  buffer_load_dwordx4 a[220:223], v250, s[16:19], s44 offen offset:3072 nt
  v_mfma_f32_16x16x32_bf16 v[80:83], a[16:19], a[40:43], v[80:83]
  s_add_u32 s44, s30, 40960
  v_mfma_f32_16x16x32_bf16 v[112:115], a[16:19], a[44:47], v[112:115]
  v_mfma_f32_16x16x32_bf16 v[144:147], a[16:19], a[48:51], v[144:147]
  v_mfma_f32_16x16x32_bf16 v[20:23], a[20:23], a[32:35], v[20:23]
  buffer_load_dwordx4 a[224:227], v249, s[12:15], s44 offen offset:0 nt
  v_mfma_f32_16x16x32_bf16 v[52:55], a[20:23], a[36:39], v[52:55]
  v_mfma_f32_16x16x32_bf16 v[84:87], a[20:23], a[40:43], v[84:87]
  v_mfma_f32_16x16x32_bf16 v[116:119], a[20:23], a[44:47], v[116:119]
  v_mfma_f32_16x16x32_bf16 v[148:151], a[20:23], a[48:51], v[148:151]
  buffer_load_dwordx4 a[228:231], v250, s[12:15], s44 offen offset:1024 nt
  v_mfma_f32_16x16x32_bf16 v[24:27], a[24:27], a[32:35], v[24:27]
  v_mfma_f32_16x16x32_bf16 v[56:59], a[24:27], a[36:39], v[56:59]
  v_mfma_f32_16x16x32_bf16 v[88:91], a[24:27], a[40:43], v[88:91]
  v_mfma_f32_16x16x32_bf16 v[120:123], a[24:27], a[44:47], v[120:123]
  buffer_load_dwordx4 a[232:235], v249, s[12:15], s44 offen offset:2048 nt
  v_mfma_f32_16x16x32_bf16 v[152:155], a[24:27], a[48:51], v[152:155]
  v_mfma_f32_16x16x32_bf16 v[28:31], a[28:31], a[32:35], v[28:31]
  v_mfma_f32_16x16x32_bf16 v[60:63], a[28:31], a[36:39], v[60:63]
  v_mfma_f32_16x16x32_bf16 v[92:95], a[28:31], a[40:43], v[92:95]
  v_mfma_f32_16x16x32_bf16 v[124:127], a[28:31], a[44:47], v[124:127]
  v_mfma_f32_16x16x32_bf16 v[156:159], a[28:31], a[48:51], v[156:159]
  s_waitcnt vmcnt(9)
  s_waitcnt lgkmcnt(0)
  s_barrier
  v_mfma_f32_16x16x32_bf16 v[0:3], a[52:55], a[84:87], v[0:3]
  s_add_u32 m0, s31, 102400
  s_add_u32 s42, s90, 0
  v_mfma_f32_16x16x32_bf16 v[32:35], a[52:55], a[88:91], v[32:35]
  buffer_load_dwordx4 v200, s[8:11], s42 offen offset:0 lds
  ds_read_b64_tr_b16 a[0:1], v204 offset:0
  v_mfma_f32_16x16x32_bf16 v[64:67], a[52:55], a[92:95], v[64:67]
  s_add_u32 s42, s90, 31744
  ds_read_b64_tr_b16 a[2:3], v204 offset:1024
  v_mfma_f32_16x16x32_bf16 v[96:99], a[52:55], a[96:99], v[96:99]
  ds_read_b128 a[32:35], v210 offset:0
  ds_read_b128 a[36:39], v210 offset:2048
  v_mfma_f32_16x16x32_bf16 v[128:131], a[52:55], a[100:103], v[128:131]
  ds_read_b128 a[40:43], v210 offset:4096
  ds_read_b128 a[44:47], v210 offset:6144
  v_mfma_f32_16x16x32_bf16 v[4:7], a[56:59], a[84:87], v[4:7]
  buffer_load_dwordx4 v200, s[8:11], s42 offen offset:1024 lds
  ds_read_b128 a[48:51], v210 offset:8192
  v_mfma_f32_16x16x32_bf16 v[36:39], a[56:59], a[88:91], v[36:39]
  s_add_u32 s42, s90, 63488
  ds_read_b64_tr_b16 a[4:5], v207 offset:0
  v_mfma_f32_16x16x32_bf16 v[68:71], a[56:59], a[92:95], v[68:71]
  ds_read_b64_tr_b16 a[6:7], v207 offset:1024
  ds_read_b64_tr_b16 a[8:9], v204 offset:256
  v_mfma_f32_16x16x32_bf16 v[100:103], a[56:59], a[96:99], v[100:103]
  ds_read_b64_tr_b16 a[10:11], v204 offset:1280
  ds_read_b64_tr_b16 a[12:13], v207 offset:256
  v_mfma_f32_16x16x32_bf16 v[132:135], a[56:59], a[100:103], v[132:135]
  buffer_load_dwordx4 v201, s[8:11], s42 offen offset:2048 lds
  ds_read_b64_tr_b16 a[14:15], v207 offset:1280
  v_mfma_f32_16x16x32_bf16 v[8:11], a[60:63], a[84:87], v[8:11]
  s_add_u32 s42, s90, 95232
  ds_read_b64_tr_b16 a[16:17], v204 offset:512
  v_mfma_f32_16x16x32_bf16 v[40:43], a[60:63], a[88:91], v[40:43]
  ds_read_b64_tr_b16 a[18:19], v204 offset:1536
  s_waitcnt lgkmcnt(11)
  ds_read_b64_tr_b16 a[20:21], v207 offset:512
  v_mfma_f32_16x16x32_bf16 v[72:75], a[60:63], a[92:95], v[72:75]
  ds_read_b64_tr_b16 a[22:23], v207 offset:1536
  ds_read_b64_tr_b16 a[24:25], v204 offset:768
  v_mfma_f32_16x16x32_bf16 v[104:107], a[60:63], a[96:99], v[104:107]
  buffer_load_dwordx4 v201, s[8:11], s42 offen offset:3072 lds
  s_add_u32 s90, s88, s32
  v_mfma_f32_16x16x32_bf16 v[136:139], a[60:63], a[100:103], v[136:139]
  s_add_u32 s88, s88, 262144
  ds_read_b64_tr_b16 a[26:27], v204 offset:1792
  v_mfma_f32_16x16x32_bf16 v[12:15], a[64:67], a[84:87], v[12:15]
  s_cmp_eq_u32 s88, 0x400000
  s_cselect_b32 s88, 0x80000, s88
  v_mfma_f32_16x16x32_bf16 v[44:47], a[64:67], a[88:91], v[44:47]
  s_add_u32 m0, s34, 126976
  s_add_u32 s42, s91, 0
  v_mfma_f32_16x16x32_bf16 v[76:79], a[64:67], a[92:95], v[76:79]
  buffer_load_dwordx4 v202, s[4:7], s42 offen offset:0 lds
  s_waitcnt lgkmcnt(11)
  ds_read_b64_tr_b16 a[28:29], v207 offset:768
  v_mfma_f32_16x16x32_bf16 v[108:111], a[64:67], a[96:99], v[108:111]
  s_add_u32 s42, s91, 7168
  ds_read_b64_tr_b16 a[30:31], v207 offset:1792
  v_mfma_f32_16x16x32_bf16 v[140:143], a[64:67], a[100:103], v[140:143]
  v_mfma_f32_16x16x32_bf16 v[16:19], a[68:71], a[84:87], v[16:19]
  v_mfma_f32_16x16x32_bf16 v[48:51], a[68:71], a[88:91], v[48:51]
  buffer_load_dwordx4 v203, s[4:7], s42 offen offset:1024 lds
  v_mfma_f32_16x16x32_bf16 v[80:83], a[68:71], a[92:95], v[80:83]
  s_add_u32 s42, s91, 14336
  v_mfma_f32_16x16x32_bf16 v[112:115], a[68:71], a[96:99], v[112:115]
  v_mfma_f32_16x16x32_bf16 v[144:147], a[68:71], a[100:103], v[144:147]
  v_mfma_f32_16x16x32_bf16 v[20:23], a[72:75], a[84:87], v[20:23]
  buffer_load_dwordx4 v202, s[4:7], s42 offen offset:2048 lds
  v_mfma_f32_16x16x32_bf16 v[52:55], a[72:75], a[88:91], v[52:55]
  s_add_u32 s42, s91, 21504
  v_mfma_f32_16x16x32_bf16 v[84:87], a[72:75], a[92:95], v[84:87]
  v_mfma_f32_16x16x32_bf16 v[116:119], a[72:75], a[96:99], v[116:119]
  v_mfma_f32_16x16x32_bf16 v[148:151], a[72:75], a[100:103], v[148:151]
  buffer_load_dwordx4 v203, s[4:7], s42 offen offset:3072 lds
  v_mfma_f32_16x16x32_bf16 v[24:27], a[76:79], a[84:87], v[24:27]
  s_add_u32 m0, s34, 131072
  s_add_u32 s42, s91, 32768
  v_mfma_f32_16x16x32_bf16 v[56:59], a[76:79], a[88:91], v[56:59]
  v_mfma_f32_16x16x32_bf16 v[88:91], a[76:79], a[92:95], v[88:91]
  v_mfma_f32_16x16x32_bf16 v[120:123], a[76:79], a[96:99], v[120:123]
  buffer_load_dwordx4 v202, s[4:7], s42 offen offset:0 lds
  v_mfma_f32_16x16x32_bf16 v[152:155], a[76:79], a[100:103], v[152:155]
  v_mfma_f32_16x16x32_bf16 v[28:31], a[80:83], a[84:87], v[28:31]
  v_mfma_f32_16x16x32_bf16 v[60:63], a[80:83], a[88:91], v[60:63]
  v_mfma_f32_16x16x32_bf16 v[92:95], a[80:83], a[92:95], v[92:95]
  v_mfma_f32_16x16x32_bf16 v[124:127], a[80:83], a[96:99], v[124:127]
  v_mfma_f32_16x16x32_bf16 v[156:159], a[80:83], a[100:103], v[156:159]
  s_waitcnt vmcnt(14)
  s_waitcnt lgkmcnt(0)
  s_barrier
  v_mfma_f32_16x16x32_bf16 v[0:3], a[0:3], a[32:35], v[0:3]
  s_add_u32 m0, s31, 147456
  s_add_u32 s42, s90, 0
  v_mfma_f32_16x16x32_bf16 v[32:35], a[0:3], a[36:39], v[32:35]
  buffer_load_dwordx4 v200, s[8:11], s42 offen offset:0 lds
  ds_read_b64_tr_b16 a[52:53], v205 offset:0
  v_mfma_f32_16x16x32_bf16 v[64:67], a[0:3], a[40:43], v[64:67]
  s_add_u32 s42, s90, 31744
  ds_read_b64_tr_b16 a[54:55], v205 offset:1024
  v_mfma_f32_16x16x32_bf16 v[96:99], a[0:3], a[44:47], v[96:99]
  ds_read_b128 a[84:87], v210 offset:512
  ds_read_b128 a[88:91], v210 offset:2560
  v_mfma_f32_16x16x32_bf16 v[128:131], a[0:3], a[48:51], v[128:131]
  ds_read_b128 a[92:95], v210 offset:4608
  ds_read_b128 a[96:99], v210 offset:6656
  v_mfma_f32_16x16x32_bf16 v[4:7], a[4:7], a[32:35], v[4:7]
  buffer_load_dwordx4 v200, s[8:11], s42 offen offset:1024 lds
  ds_read_b128 a[100:103], v210 offset:8704
  v_mfma_f32_16x16x32_bf16 v[36:39], a[4:7], a[36:39], v[36:39]
  s_add_u32 s42, s90, 63488
  ds_read_b64_tr_b16 a[56:57], v208 offset:0
  v_mfma_f32_16x16x32_bf16 v[68:71], a[4:7], a[40:43], v[68:71]
  ds_read_b64_tr_b16 a[58:59], v208 offset:1024
  ds_read_b64_tr_b16 a[60:61], v205 offset:256
  v_mfma_f32_16x16x32_bf16 v[100:103], a[4:7], a[44:47], v[100:103]
  ds_read_b64_tr_b16 a[62:63], v205 offset:1280
  ds_read_b64_tr_b16 a[64:65], v208 offset:256
  v_mfma_f32_16x16x32_bf16 v[132:135], a[4:7], a[48:51], v[132:135]
  buffer_load_dwordx4 v201, s[8:11], s42 offen offset:2048 lds
  ds_read_b64_tr_b16 a[66:67], v208 offset:1280
  v_mfma_f32_16x16x32_bf16 v[8:11], a[8:11], a[32:35], v[8:11]
  s_add_u32 s42, s90, 95232
  ds_read_b64_tr_b16 a[68:69], v205 offset:512
  v_mfma_f32_16x16x32_bf16 v[40:43], a[8:11], a[36:39], v[40:43]
  ds_read_b64_tr_b16 a[70:71], v205 offset:1536
  s_waitcnt lgkmcnt(11)
  ds_read_b64_tr_b16 a[72:73], v208 offset:512
  v_mfma_f32_16x16x32_bf16 v[72:75], a[8:11], a[40:43], v[72:75]
  ds_read_b64_tr_b16 a[74:75], v208 offset:1536
  ds_read_b64_tr_b16 a[76:77], v205 offset:768
  v_mfma_f32_16x16x32_bf16 v[104:107], a[8:11], a[44:47], v[104:107]
  buffer_load_dwordx4 v201, s[8:11], s42 offen offset:3072 lds
  ds_read_b64_tr_b16 a[78:79], v205 offset:1792
  v_mfma_f32_16x16x32_bf16 v[136:139], a[8:11], a[48:51], v[136:139]
  s_waitcnt lgkmcnt(11)
  ds_read_b64_tr_b16 a[80:81], v208 offset:768
  v_mfma_f32_16x16x32_bf16 v[12:15], a[12:15], a[32:35], v[12:15]
  ds_read_b64_tr_b16 a[82:83], v208 offset:1792
  v_mfma_f32_16x16x32_bf16 v[44:47], a[12:15], a[36:39], v[44:47]
  v_mfma_f32_16x16x32_bf16 v[76:79], a[12:15], a[40:43], v[76:79]
  buffer_load_dwordx4 a[236:239], v250, s[12:15], s44 offen offset:3072 nt
  v_mfma_f32_16x16x32_bf16 v[108:111], a[12:15], a[44:47], v[108:111]
  s_add_u32 s44, s30, 32768
  v_mfma_f32_16x16x32_bf16 v[140:143], a[12:15], a[48:51], v[140:143]
  v_mfma_f32_16x16x32_bf16 v[16:19], a[16:19], a[32:35], v[16:19]
  v_mfma_f32_16x16x32_bf16 v[48:51], a[16:19], a[36:39], v[48:51]
  buffer_load_dwordx4 a[240:243], v249, s[16:19], s44 offen offset:0 nt
  v_mfma_f32_16x16x32_bf16 v[80:83], a[16:19], a[40:43], v[80:83]
  v_mfma_f32_16x16x32_bf16 v[112:115], a[16:19], a[44:47], v[112:115]
  v_mfma_f32_16x16x32_bf16 v[144:147], a[16:19], a[48:51], v[144:147]
  v_mfma_f32_16x16x32_bf16 v[20:23], a[20:23], a[32:35], v[20:23]
  buffer_load_dwordx4 a[244:247], v250, s[16:19], s44 offen offset:1024 nt
  v_mfma_f32_16x16x32_bf16 v[52:55], a[20:23], a[36:39], v[52:55]
  v_mfma_f32_16x16x32_bf16 v[84:87], a[20:23], a[40:43], v[84:87]
  v_mfma_f32_16x16x32_bf16 v[116:119], a[20:23], a[44:47], v[116:119]
  v_mfma_f32_16x16x32_bf16 v[148:151], a[20:23], a[48:51], v[148:151]
  buffer_load_dwordx4 a[248:251], v249, s[16:19], s44 offen offset:2048 nt
  v_mfma_f32_16x16x32_bf16 v[24:27], a[24:27], a[32:35], v[24:27]
  v_mfma_f32_16x16x32_bf16 v[56:59], a[24:27], a[36:39], v[56:59]
  v_mfma_f32_16x16x32_bf16 v[88:91], a[24:27], a[40:43], v[88:91]
  v_mfma_f32_16x16x32_bf16 v[120:123], a[24:27], a[44:47], v[120:123]
  buffer_load_dwordx4 a[252:255], v250, s[16:19], s44 offen offset:3072 nt
  v_mfma_f32_16x16x32_bf16 v[152:155], a[24:27], a[48:51], v[152:155]
  v_mfma_f32_16x16x32_bf16 v[28:31], a[28:31], a[32:35], v[28:31]
  v_mfma_f32_16x16x32_bf16 v[60:63], a[28:31], a[36:39], v[60:63]
  v_mfma_f32_16x16x32_bf16 v[92:95], a[28:31], a[40:43], v[92:95]
  v_mfma_f32_16x16x32_bf16 v[124:127], a[28:31], a[44:47], v[124:127]
  v_mfma_f32_16x16x32_bf16 v[156:159], a[28:31], a[48:51], v[156:159]
  s_waitcnt vmcnt(9)
  s_waitcnt lgkmcnt(0)
  s_barrier
  v_mfma_f32_16x16x32_bf16 v[0:3], a[52:55], a[84:87], v[0:3]
  ds_read_b64_tr_b16 a[0:1], v206 offset:0
  ds_read_b64_tr_b16 a[2:3], v206 offset:1024
  v_mfma_f32_16x16x32_bf16 v[32:35], a[52:55], a[88:91], v[32:35]
  ds_read_b128 a[32:35], v211 offset:0
  ds_read_b128 a[36:39], v211 offset:2048
  v_mfma_f32_16x16x32_bf16 v[64:67], a[52:55], a[92:95], v[64:67]
  ds_read_b128 a[40:43], v211 offset:4096
  ds_read_b128 a[44:47], v211 offset:6144
  v_mfma_f32_16x16x32_bf16 v[96:99], a[52:55], a[96:99], v[96:99]
  ds_read_b128 a[48:51], v211 offset:8192
  ds_read_b64_tr_b16 a[4:5], v209 offset:0
  v_mfma_f32_16x16x32_bf16 v[128:131], a[52:55], a[100:103], v[128:131]
  ds_read_b64_tr_b16 a[6:7], v209 offset:1024
  ds_read_b64_tr_b16 a[8:9], v206 offset:256
  v_mfma_f32_16x16x32_bf16 v[4:7], a[56:59], a[84:87], v[4:7]
  ds_read_b64_tr_b16 a[10:11], v206 offset:1280
  ds_read_b64_tr_b16 a[12:13], v209 offset:256
  v_mfma_f32_16x16x32_bf16 v[36:39], a[56:59], a[88:91], v[36:39]
  ds_read_b64_tr_b16 a[14:15], v209 offset:1280
  ds_read_b64_tr_b16 a[16:17], v206 offset:512
  v_mfma_f32_16x16x32_bf16 v[68:71], a[56:59], a[92:95], v[68:71]
  ds_read_b64_tr_b16 a[18:19], v206 offset:1536
  s_waitcnt lgkmcnt(11)
  ds_read_b64_tr_b16 a[20:21], v209 offset:512
  v_mfma_f32_16x16x32_bf16 v[100:103], a[56:59], a[96:99], v[100:103]
  ds_read_b64_tr_b16 a[22:23], v209 offset:1536
  ds_read_b64_tr_b16 a[24:25], v206 offset:768
  v_mfma_f32_16x16x32_bf16 v[132:135], a[56:59], a[100:103], v[132:135]
  ds_read_b64_tr_b16 a[26:27], v206 offset:1792
  s_waitcnt lgkmcnt(11)
  ds_read_b64_tr_b16 a[28:29], v209 offset:768
  v_mfma_f32_16x16x32_bf16 v[8:11], a[60:63], a[84:87], v[8:11]
  ds_read_b64_tr_b16 a[30:31], v209 offset:1792
  v_mfma_f32_16x16x32_bf16 v[40:43], a[60:63], a[88:91], v[40:43]
  v_mfma_f32_16x16x32_bf16 v[72:75], a[60:63], a[92:95], v[72:75]
  v_mfma_f32_16x16x32_bf16 v[104:107], a[60:63], a[96:99], v[104:107]
  v_mfma_f32_16x16x32_bf16 v[136:139], a[60:63], a[100:103], v[136:139]
  v_mfma_f32_16x16x32_bf16 v[12:15], a[64:67], a[84:87], v[12:15]
  v_mfma_f32_16x16x32_bf16 v[44:47], a[64:67], a[88:91], v[44:47]
  v_mfma_f32_16x16x32_bf16 v[76:79], a[64:67], a[92:95], v[76:79]
  v_mfma_f32_16x16x32_bf16 v[108:111], a[64:67], a[96:99], v[108:111]
  v_mfma_f32_16x16x32_bf16 v[140:143], a[64:67], a[100:103], v[140:143]
  v_mfma_f32_16x16x32_bf16 v[16:19], a[68:71], a[84:87], v[16:19]
  v_mfma_f32_16x16x32_bf16 v[48:51], a[68:71], a[88:91], v[48:51]
  v_mfma_f32_16x16x32_bf16 v[80:83], a[68:71], a[92:95], v[80:83]
  v_mfma_f32_16x16x32_bf16 v[112:115], a[68:71], a[96:99], v[112:115]
  v_mfma_f32_16x16x32_bf16 v[144:147], a[68:71], a[100:103], v[144:147]
  v_mfma_f32_16x16x32_bf16 v[20:23], a[72:75], a[84:87], v[20:23]
  v_mfma_f32_16x16x32_bf16 v[52:55], a[72:75], a[88:91], v[52:55]
  v_mfma_f32_16x16x32_bf16 v[84:87], a[72:75], a[92:95], v[84:87]
  v_mfma_f32_16x16x32_bf16 v[116:119], a[72:75], a[96:99], v[116:119]
  v_mfma_f32_16x16x32_bf16 v[148:151], a[72:75], a[100:103], v[148:151]
  v_mfma_f32_16x16x32_bf16 v[24:27], a[76:79], a[84:87], v[24:27]
  v_mfma_f32_16x16x32_bf16 v[56:59], a[76:79], a[88:91], v[56:59]
  v_mfma_f32_16x16x32_bf16 v[88:91], a[76:79], a[92:95], v[88:91]
  v_mfma_f32_16x16x32_bf16 v[120:123], a[76:79], a[96:99], v[120:123]
  v_mfma_f32_16x16x32_bf16 v[152:155], a[76:79], a[100:103], v[152:155]
  v_mfma_f32_16x16x32_bf16 v[28:31], a[80:83], a[84:87], v[28:31]
  v_mfma_f32_16x16x32_bf16 v[60:63], a[80:83], a[88:91], v[60:63]
  v_mfma_f32_16x16x32_bf16 v[92:95], a[80:83], a[92:95], v[92:95]
  v_mfma_f32_16x16x32_bf16 v[124:127], a[80:83], a[96:99], v[124:127]
  v_mfma_f32_16x16x32_bf16 v[156:159], a[80:83], a[100:103], v[156:159]
  s_waitcnt vmcnt(5)
  s_waitcnt lgkmcnt(0)
  s_barrier
  v_mfma_f32_16x16x32_bf16 v[0:3], a[0:3], a[32:35], v[0:3]
  ds_read_b64_tr_b16 a[52:53], v204 offset:0
  ds_read_b64_tr_b16 a[54:55], v204 offset:1024
  v_mfma_f32_16x16x32_bf16 v[32:35], a[0:3], a[36:39], v[32:35]
  ds_read_b128 a[84:87], v211 offset:512
  ds_read_b128 a[88:91], v211 offset:2560
  v_mfma_f32_16x16x32_bf16 v[64:67], a[0:3], a[40:43], v[64:67]
  ds_read_b128 a[92:95], v211 offset:4608
  ds_read_b128 a[96:99], v211 offset:6656
  v_mfma_f32_16x16x32_bf16 v[96:99], a[0:3], a[44:47], v[96:99]
  ds_read_b128 a[100:103], v211 offset:8704
  ds_read_b64_tr_b16 a[56:57], v207 offset:0
  v_mfma_f32_16x16x32_bf16 v[128:131], a[0:3], a[48:51], v[128:131]
  ds_read_b64_tr_b16 a[58:59], v207 offset:1024
  ds_read_b64_tr_b16 a[60:61], v204 offset:256
  v_mfma_f32_16x16x32_bf16 v[4:7], a[4:7], a[32:35], v[4:7]
  ds_read_b64_tr_b16 a[62:63], v204 offset:1280
  ds_read_b64_tr_b16 a[64:65], v207 offset:256
  v_mfma_f32_16x16x32_bf16 v[36:39], a[4:7], a[36:39], v[36:39]
  ds_read_b64_tr_b16 a[66:67], v207 offset:1280
  ds_read_b64_tr_b16 a[68:69], v204 offset:512
  v_mfma_f32_16x16x32_bf16 v[68:71], a[4:7], a[40:43], v[68:71]
  ds_read_b64_tr_b16 a[70:71], v204 offset:1536
  s_waitcnt lgkmcnt(11)
  ds_read_b64_tr_b16 a[72:73], v207 offset:512
  v_mfma_f32_16x16x32_bf16 v[100:103], a[4:7], a[44:47], v[100:103]
  ds_read_b64_tr_b16 a[74:75], v207 offset:1536
  ds_read_b64_tr_b16 a[76:77], v204 offset:768
  v_mfma_f32_16x16x32_bf16 v[132:135], a[4:7], a[48:51], v[132:135]
  ds_read_b64_tr_b16 a[78:79], v204 offset:1792
  s_waitcnt lgkmcnt(11)
  ds_read_b64_tr_b16 a[80:81], v207 offset:768
  v_mfma_f32_16x16x32_bf16 v[8:11], a[8:11], a[32:35], v[8:11]
  ds_read_b64_tr_b16 a[82:83], v207 offset:1792
  v_mfma_f32_16x16x32_bf16 v[40:43], a[8:11], a[36:39], v[40:43]
  v_mfma_f32_16x16x32_bf16 v[72:75], a[8:11], a[40:43], v[72:75]
  v_mfma_f32_16x16x32_bf16 v[104:107], a[8:11], a[44:47], v[104:107]
  v_mfma_f32_16x16x32_bf16 v[136:139], a[8:11], a[48:51], v[136:139]
  v_mfma_f32_16x16x32_bf16 v[12:15], a[12:15], a[32:35], v[12:15]
  v_mfma_f32_16x16x32_bf16 v[44:47], a[12:15], a[36:39], v[44:47]
  v_mfma_f32_16x16x32_bf16 v[76:79], a[12:15], a[40:43], v[76:79]
  v_mfma_f32_16x16x32_bf16 v[108:111], a[12:15], a[44:47], v[108:111]
  v_mfma_f32_16x16x32_bf16 v[140:143], a[12:15], a[48:51], v[140:143]
  v_mfma_f32_16x16x32_bf16 v[16:19], a[16:19], a[32:35], v[16:19]
  ds_write_b128 v212, a[160:163] offset:0
  v_mfma_f32_16x16x32_bf16 v[48:51], a[16:19], a[36:39], v[48:51]
  v_mfma_f32_16x16x32_bf16 v[80:83], a[16:19], a[40:43], v[80:83]
  ds_write_b128 v212, a[164:167] offset:1024
  v_mfma_f32_16x16x32_bf16 v[112:115], a[16:19], a[44:47], v[112:115]
  v_mfma_f32_16x16x32_bf16 v[144:147], a[16:19], a[48:51], v[144:147]
  s_waitcnt lgkmcnt(11)
  ds_write_b128 v212, a[168:171] offset:2048
  v_mfma_f32_16x16x32_bf16 v[20:23], a[20:23], a[32:35], v[20:23]
  v_mfma_f32_16x16x32_bf16 v[52:55], a[20:23], a[36:39], v[52:55]
  ds_write_b128 v212, a[172:175] offset:3072
  v_mfma_f32_16x16x32_bf16 v[84:87], a[20:23], a[40:43], v[84:87]
  v_mfma_f32_16x16x32_bf16 v[116:119], a[20:23], a[44:47], v[116:119]
  ds_write_b128 v212, a[176:179] offset:16384
  v_mfma_f32_16x16x32_bf16 v[148:151], a[20:23], a[48:51], v[148:151]
  v_mfma_f32_16x16x32_bf16 v[24:27], a[24:27], a[32:35], v[24:27]
  ds_write_b128 v212, a[180:183] offset:17408
  v_mfma_f32_16x16x32_bf16 v[56:59], a[24:27], a[36:39], v[56:59]
  v_mfma_f32_16x16x32_bf16 v[88:91], a[24:27], a[40:43], v[88:91]
  s_waitcnt lgkmcnt(11)
  ds_write_b128 v212, a[184:187] offset:18432
  v_mfma_f32_16x16x32_bf16 v[120:123], a[24:27], a[44:47], v[120:123]
  v_mfma_f32_16x16x32_bf16 v[152:155], a[24:27], a[48:51], v[152:155]
  ds_write_b128 v212, a[188:191] offset:19456
  v_mfma_f32_16x16x32_bf16 v[28:31], a[28:31], a[32:35], v[28:31]
  v_mfma_f32_16x16x32_bf16 v[60:63], a[28:31], a[36:39], v[60:63]
  v_mfma_f32_16x16x32_bf16 v[92:95], a[28:31], a[40:43], v[92:95]
  v_mfma_f32_16x16x32_bf16 v[124:127], a[28:31], a[44:47], v[124:127]
  v_mfma_f32_16x16x32_bf16 v[156:159], a[28:31], a[48:51], v[156:159]
  s_waitcnt lgkmcnt(0)
  s_barrier
L_conv:
  v_add_u32 v244, 49152, v247
  ds_read_b128 a[104:107], v244 offset:0
  ds_read_b128 a[120:123], v244 offset:4096
  ds_read_b128 a[108:111], v244 offset:256
  ds_read_b128 a[124:127], v244 offset:4352
  ds_read_b128 a[112:115], v244 offset:512
  ds_read_b128 a[128:131], v244 offset:4608
  ds_read_b128 a[116:119], v244 offset:768
  ds_read_b128 a[132:135], v244 offset:4864
  v_mfma_f32_16x16x32_bf16 v[0:3], a[52:55], a[84:87], v[0:3]
  v_mfma_f32_16x16x32_bf16 v[4:7], a[56:59], a[84:87], v[4:7]
  s_add_u32 s44, s30, 57344
  v_mfma_f32_16x16x32_bf16 v[8:11], a[60:63], a[84:87], v[8:11]
  v_mfma_f32_16x16x32_bf16 v[12:15], a[64:67], a[84:87], v[12:15]
  v_mfma_f32_16x16x32_bf16 v[16:19], a[68:71], a[84:87], v[16:19]
  buffer_load_dwordx4 a[32:35], v249, s[12:15], s44 offen offset:0 nt
  v_mfma_f32_16x16x32_bf16 v[20:23], a[72:75], a[84:87], v[20:23]
  v_mfma_f32_16x16x32_bf16 v[24:27], a[76:79], a[84:87], v[24:27]
  v_mfma_f32_16x16x32_bf16 v[28:31], a[80:83], a[84:87], v[28:31]
  v_mfma_f32_16x16x32_bf16 v[32:35], a[52:55], a[88:91], v[32:35]
  ds_write_b128 v212, a[192:195] offset:32768
  v_mfma_f32_16x16x32_bf16 v[36:39], a[56:59], a[88:91], v[36:39]
  v_pk_mul_f32 v[0:1], v[0:1], s[40:41] op_sel_hi:[1,0]
  v_pk_mul_f32 v[2:3], v[2:3], s[40:41] op_sel_hi:[1,0]
  v_pk_mul_f32 v[4:5], v[4:5], s[40:41] op_sel_hi:[1,0]
  v_pk_mul_f32 v[6:7], v[6:7], s[40:41] op_sel_hi:[1,0]
  v_pk_mul_f32 v[8:9], v[8:9], s[40:41] op_sel_hi:[1,0]
  v_pk_mul_f32 v[10:11], v[10:11], s[40:41] op_sel_hi:[1,0]
  v_mfma_f32_16x16x32_bf16 v[40:43], a[60:63], a[88:91], v[40:43]
  v_pk_mul_f32 v[12:13], v[12:13], s[40:41] op_sel_hi:[1,0]
  v_pk_mul_f32 v[14:15], v[14:15], s[40:41] op_sel_hi:[1,0]
  v_pk_mul_f32 v[16:17], v[16:17], s[40:41] op_sel_hi:[1,0]
  v_pk_mul_f32 v[18:19], v[18:19], s[40:41] op_sel_hi:[1,0]
  v_pk_mul_f32 v[20:21], v[20:21], s[40:41] op_sel_hi:[1,0]
  v_pk_mul_f32 v[22:23], v[22:23], s[40:41] op_sel_hi:[1,0]
  v_mfma_f32_16x16x32_bf16 v[44:47], a[64:67], a[88:91], v[44:47]
  v_pk_mul_f32 v[24:25], v[24:25], s[40:41] op_sel_hi:[1,0]
  v_pk_mul_f32 v[26:27], v[26:27], s[40:41] op_sel_hi:[1,0]
  v_pk_mul_f32 v[28:29], v[28:29], s[40:41] op_sel_hi:[1,0]
  v_pk_mul_f32 v[30:31], v[30:31], s[40:41] op_sel_hi:[1,0]
  v_cvt_pk_bf16_f32 v0, v0, v1
  v_cvt_pk_bf16_f32 v4, v4, v5
  v_mfma_f32_16x16x32_bf16 v[48:51], a[68:71], a[88:91], v[48:51]
  v_cvt_pk_bf16_f32 v1, v2, v3
  v_cvt_pk_bf16_f32 v5, v6, v7
  v_cvt_pk_bf16_f32 v8, v8, v9
  v_cvt_pk_bf16_f32 v12, v12, v13
  v_cvt_pk_bf16_f32 v9, v10, v11
  v_cvt_pk_bf16_f32 v13, v14, v15
  v_mfma_f32_16x16x32_bf16 v[52:55], a[72:75], a[88:91], v[52:55]
  buffer_load_dwordx4 a[36:39], v250, s[12:15], s44 offen offset:1024 nt
  v_cvt_pk_bf16_f32 v16, v16, v17
  v_cvt_pk_bf16_f32 v20, v20, v21
  v_cvt_pk_bf16_f32 v17, v18, v19
  v_cvt_pk_bf16_f32 v21, v22, v23
  v_cvt_pk_bf16_f32 v24, v24, v25
  v_mfma_f32_16x16x32_bf16 v[56:59], a[76:79], a[88:91], v[56:59]
  ds_write_b128 v212, a[196:199] offset:33792
  ds_write_b128 v212, a[200:203] offset:34816
  v_cvt_pk_bf16_f32 v28, v28, v29
  v_cvt_pk_bf16_f32 v25, v26, v27
  v_cvt_pk_bf16_f32 v29, v30, v31
  v_cndmask_b32 v2, v0, v4, vcc
  v_mfma_f32_16x16x32_bf16 v[60:63], a[80:83], a[88:91], v[60:63]
  ds_write_b128 v212, a[204:207] offset:35840
  v_cndmask_b32 v6, v4, v0, vcc
  v_cndmask_b32 v3, v1, v5, vcc
  v_cndmask_b32 v7, v5, v1, vcc
  v_cndmask_b32 v10, v8, v12, vcc
  v_cndmask_b32 v14, v12, v8, vcc
  v_mfma_f32_16x16x32_bf16 v[64:67], a[52:55], a[92:95], v[64:67]
  ds_write_b128 v212, a[208:211] offset:49152
  v_cndmask_b32 v11, v9, v13, vcc
  v_cndmask_b32 v15, v13, v9, vcc
  v_cndmask_b32 v18, v16, v20, vcc
  v_cndmask_b32 v22, v20, v16, vcc
  v_cndmask_b32 v19, v17, v21, vcc
  v_mfma_f32_16x16x32_bf16 v[68:71], a[56:59], a[92:95], v[68:71]
  v_cndmask_b32 v23, v21, v17, vcc
  v_cndmask_b32 v26, v24, v28, vcc
  v_cndmask_b32 v30, v28, v24, vcc
  v_cndmask_b32 v27, v25, v29, vcc
  v_cndmask_b32 v31, v29, v25, vcc
  v_accvgpr_write_b32 a160, v2
  v_mfma_f32_16x16x32_bf16 v[72:75], a[60:63], a[92:95], v[72:75]
  ds_write_b128 v212, a[212:215] offset:50176
  v_accvgpr_write_b32 a161, v3
  v_accvgpr_write_b32 a162, v6
  v_accvgpr_write_b32 a163, v7
  v_accvgpr_write_b32 a164, v10
  v_accvgpr_write_b32 a165, v11
  v_mfma_f32_16x16x32_bf16 v[76:79], a[64:67], a[92:95], v[76:79]
  v_accvgpr_write_b32 a166, v14
  v_accvgpr_write_b32 a167, v15
  v_accvgpr_write_b32 a168, v18
  v_accvgpr_write_b32 a169, v19
  v_accvgpr_write_b32 a170, v22
  v_accvgpr_write_b32 a171, v23
  v_mfma_f32_16x16x32_bf16 v[80:83], a[68:71], a[92:95], v[80:83]
  ds_write_b128 v212, a[216:219] offset:51200
  v_accvgpr_write_b32 a172, v26
  v_accvgpr_write_b32 a173, v27
  v_accvgpr_write_b32 a174, v30
  v_accvgpr_write_b32 a175, v31
  v_pk_mul_f32 v[32:33], v[32:33], s[40:41] op_sel_hi:[1,0]
  v_mfma_f32_16x16x32_bf16 v[84:87], a[72:75], a[92:95], v[84:87]
  v_pk_mul_f32 v[34:35], v[34:35], s[40:41] op_sel_hi:[1,0]
  v_pk_mul_f32 v[36:37], v[36:37], s[40:41] op_sel_hi:[1,0]
  v_pk_mul_f32 v[38:39], v[38:39], s[40:41] op_sel_hi:[1,0]
  v_pk_mul_f32 v[40:41], v[40:41], s[40:41] op_sel_hi:[1,0]
  v_pk_mul_f32 v[42:43], v[42:43], s[40:41] op_sel_hi:[1,0]
  v_pk_mul_f32 v[44:45], v[44:45], s[40:41] op_sel_hi:[1,0]
  v_mfma_f32_16x16x32_bf16 v[88:91], a[76:79], a[92:95], v[88:91]
  s_waitcnt lgkmcnt(11)
  ds_write_b128 v212, a[220:223] offset:52224
  buffer_load_dwordx4 a[40:43], v249, s[12:15], s44 offen offset:2048 nt
  v_pk_mul_f32 v[46:47], v[46:47], s[40:41] op_sel_hi:[1,0]
  v_pk_mul_f32 v[48:49], v[48:49], s[40:41] op_sel_hi:[1,0]
  v_pk_mul_f32 v[50:51], v[50:51], s[40:41] op_sel_hi:[1,0]
  v_pk_mul_f32 v[52:53], v[52:53], s[40:41] op_sel_hi:[1,0]
  v_mfma_f32_16x16x32_bf16 v[92:95], a[80:83], a[92:95], v[92:95]
  v_pk_mul_f32 v[54:55], v[54:55], s[40:41] op_sel_hi:[1,0]
  v_pk_mul_f32 v[56:57], v[56:57], s[40:41] op_sel_hi:[1,0]
  v_pk_mul_f32 v[58:59], v[58:59], s[40:41] op_sel_hi:[1,0]
  v_pk_mul_f32 v[60:61], v[60:61], s[40:41] op_sel_hi:[1,0]
  v_pk_mul_f32 v[62:63], v[62:63], s[40:41] op_sel_hi:[1,0]
  v_cvt_pk_bf16_f32 v32, v32, v33
  v_mfma_f32_16x16x32_bf16 v[96:99], a[52:55], a[96:99], v[96:99]
  v_cvt_pk_bf16_f32 v36, v36, v37
  v_cvt_pk_bf16_f32 v33, v34, v35
  v_cvt_pk_bf16_f32 v37, v38, v39
  v_cvt_pk_bf16_f32 v40, v40, v41
  v_cvt_pk_bf16_f32 v44, v44, v45
  v_cvt_pk_bf16_f32 v41, v42, v43
  v_mfma_f32_16x16x32_bf16 v[100:103], a[56:59], a[96:99], v[100:103]
  v_cvt_pk_bf16_f32 v45, v46, v47
  v_cvt_pk_bf16_f32 v48, v48, v49
  v_cvt_pk_bf16_f32 v52, v52, v53
  v_cvt_pk_bf16_f32 v49, v50, v51
  v_cvt_pk_bf16_f32 v53, v54, v55
  v_cvt_pk_bf16_f32 v56, v56, v57
  v_mfma_f32_16x16x32_bf16 v[104:107], a[60:63], a[96:99], v[104:107]
  v_cvt_pk_bf16_f32 v60, v60, v61
  v_cvt_pk_bf16_f32 v57, v58, v59
  v_cvt_pk_bf16_f32 v61, v62, v63
  v_cndmask_b32 v34, v32, v36, vcc
  v_cndmask_b32 v38, v36, v32, vcc
  v_cndmask_b32 v35, v33, v37, vcc
  v_mfma_f32_16x16x32_bf16 v[108:111], a[64:67], a[96:99], v[108:111]
  v_cndmask_b32 v39, v37, v33, vcc
  v_cndmask_b32 v42, v40, v44, vcc
  v_cndmask_b32 v46, v44, v40, vcc
  v_cndmask_b32 v43, v41, v45, vcc
  v_cndmask_b32 v47, v45, v41, vcc
  v_cndmask_b32 v50, v48, v52, vcc
  v_mfma_f32_16x16x32_bf16 v[112:115], a[68:71], a[96:99], v[112:115]
  v_cndmask_b32 v54, v52, v48, vcc
  v_cndmask_b32 v51, v49, v53, vcc
  v_cndmask_b32 v55, v53, v49, vcc
  v_cndmask_b32 v58, v56, v60, vcc
  v_cndmask_b32 v62, v60, v56, vcc
  v_cndmask_b32 v59, v57, v61, vcc
  v_mfma_f32_16x16x32_bf16 v[116:119], a[72:75], a[96:99], v[116:119]
  v_cndmask_b32 v63, v61, v57, vcc
  v_accvgpr_write_b32 a176, v34
  v_accvgpr_write_b32 a177, v35
  v_accvgpr_write_b32 a178, v38
  v_accvgpr_write_b32 a179, v39
  v_accvgpr_write_b32 a180, v42
  v_mfma_f32_16x16x32_bf16 v[120:123], a[76:79], a[96:99], v[120:123]
  v_accvgpr_write_b32 a181, v43
  v_accvgpr_write_b32 a182, v46
  v_accvgpr_write_b32 a183, v47
  v_accvgpr_write_b32 a184, v50
  v_accvgpr_write_b32 a185, v51
  v_accvgpr_write_b32 a186, v54
  v_mfma_f32_16x16x32_bf16 v[124:127], a[80:83], a[96:99], v[124:127]
  buffer_load_dwordx4 a[44:47], v250, s[12:15], s44 offen offset:3072 nt
  ds_write_b128 v213, a[224:227] offset:0
  v_accvgpr_write_b32 a187, v55
  v_accvgpr_write_b32 a188, v58
  v_accvgpr_write_b32 a189, v59
  v_accvgpr_write_b32 a190, v62
  v_mfma_f32_16x16x32_bf16 v[128:131], a[52:55], a[100:103], v[128:131]
  ds_write_b128 v213, a[228:231] offset:1024
  ds_write_b128 v213, a[232:235] offset:2048
  s_waitcnt vmcnt(8) lgkmcnt(11)
  ds_write_b128 v213, a[236:239] offset:3072
  v_accvgpr_write_b32 a191, v63
  v_pk_mul_f32 v[64:65], v[64:65], s[40:41] op_sel_hi:[1,0]
  v_pk_mul_f32 v[66:67], v[66:67], s[40:41] op_sel_hi:[1,0]
  v_mfma_f32_16x16x32_bf16 v[132:135], a[56:59], a[100:103], v[132:135]
  s_waitcnt vmcnt(7)
  ds_write_b128 v213, a[240:243] offset:16384
  v_pk_mul_f32 v[68:69], v[68:69], s[40:41] op_sel_hi:[1,0]
  v_pk_mul_f32 v[70:71], v[70:71], s[40:41] op_sel_hi:[1,0]
  v_pk_mul_f32 v[72:73], v[72:73], s[40:41] op_sel_hi:[1,0]
  v_pk_mul_f32 v[74:75], v[74:75], s[40:41] op_sel_hi:[1,0]
  v_pk_mul_f32 v[76:77], v[76:77], s[40:41] op_sel_hi:[1,0]
  v_mfma_f32_16x16x32_bf16 v[136:139], a[60:63], a[100:103], v[136:139]
  s_waitcnt vmcnt(6)
  ds_write_b128 v213, a[244:247] offset:17408
  v_pk_mul_f32 v[78:79], v[78:79], s[40:41] op_sel_hi:[1,0]
  v_pk_mul_f32 v[80:81], v[80:81], s[40:41] op_sel_hi:[1,0]
  v_pk_mul_f32 v[82:83], v[82:83], s[40:41] op_sel_hi:[1,0]
  v_pk_mul_f32 v[84:85], v[84:85], s[40:41] op_sel_hi:[1,0]
  v_pk_mul_f32 v[86:87], v[86:87], s[40:41] op_sel_hi:[1,0]
  v_mfma_f32_16x16x32_bf16 v[140:143], a[64:67], a[100:103], v[140:143]
  v_pk_mul_f32 v[88:89], v[88:89], s[40:41] op_sel_hi:[1,0]
  v_pk_mul_f32 v[90:91], v[90:91], s[40:41] op_sel_hi:[1,0]
  v_pk_mul_f32 v[92:93], v[92:93], s[40:41] op_sel_hi:[1,0]
  v_pk_mul_f32 v[94:95], v[94:95], s[40:41] op_sel_hi:[1,0]
  v_cvt_pk_bf16_f32 v64, v64, v65
  v_cvt_pk_bf16_f32 v68, v68, v69
  v_mfma_f32_16x16x32_bf16 v[144:147], a[68:71], a[100:103], v[144:147]
  s_waitcnt vmcnt(5)
  ds_write_b128 v213, a[248:251] offset:18432
  v_cvt_pk_bf16_f32 v65, v66, v67
  v_cvt_pk_bf16_f32 v69, v70, v71
  v_cvt_pk_bf16_f32 v72, v72, v73
  v_cvt_pk_bf16_f32 v76, v76, v77
  v_cvt_pk_bf16_f32 v73, v74, v75
  v_mfma_f32_16x16x32_bf16 v[148:151], a[72:75], a[100:103], v[148:151]
  v_cvt_pk_bf16_f32 v77, v78, v79
  v_cvt_pk_bf16_f32 v80, v80, v81
  v_cvt_pk_bf16_f32 v84, v84, v85
  v_cvt_pk_bf16_f32 v81, v82, v83
  v_cvt_pk_bf16_f32 v85, v86, v87
  v_cvt_pk_bf16_f32 v88, v88, v89
  v_mfma_f32_16x16x32_bf16 v[152:155], a[76:79], a[100:103], v[152:155]
  s_waitcnt vmcnt(4) lgkmcnt(11)
  ds_write_b128 v213, a[252:255] offset:19456
  v_cvt_pk_bf16_f32 v92, v92, v93
  v_cvt_pk_bf16_f32 v89, v90, v91
  v_cvt_pk_bf16_f32 v93, v94, v95
  v_cndmask_b32 v66, v64, v68, vcc
  v_cndmask_b32 v70, v68, v64, vcc
  v_mfma_f32_16x16x32_bf16 v[156:159], a[80:83], a[100:103], v[156:159]
  v_cndmask_b32 v67, v65, v69, vcc
  v_cndmask_b32 v71, v69, v65, vcc
  v_cndmask_b32 v74, v72, v76, vcc
  v_cndmask_b32 v78, v76, v72, vcc
  v_cndmask_b32 v75, v73, v77, vcc
  v_mfma_f32_16x16x32_bf16 v[160:163], a[104:107], a[160:163], 0
  v_cndmask_b32 v79, v77, v73, vcc
  v_cndmask_b32 v82, v80, v84, vcc
  v_cndmask_b32 v86, v84, v80, vcc
  v_cndmask_b32 v83, v81, v85, vcc
  v_cndmask_b32 v87, v85, v81, vcc
  v_cndmask_b32 v90, v88, v92, vcc
  v_mfma_f32_16x16x32_bf16 v[164:167], a[120:123], a[160:163], 0
  v_cndmask_b32 v94, v92, v88, vcc
  v_cndmask_b32 v91, v89, v93, vcc
  v_cndmask_b32 v95, v93, v89, vcc
  v_accvgpr_write_b32 a192, v66
  v_accvgpr_write_b32 a193, v67
  v_accvgpr_write_b32 a194, v70
  v_mfma_f32_16x16x32_bf16 v[160:163], a[108:111], a[164:167], v[160:163]
  v_accvgpr_write_b32 a195, v71
  v_accvgpr_write_b32 a196, v74
  v_accvgpr_write_b32 a197, v75
  v_accvgpr_write_b32 a198, v78
  v_accvgpr_write_b32 a199, v79
  v_accvgpr_write_b32 a200, v82
  v_mfma_f32_16x16x32_bf16 v[164:167], a[124:127], a[164:167], v[164:167]
  v_accvgpr_write_b32 a201, v83
  v_accvgpr_write_b32 a202, v86
  v_accvgpr_write_b32 a203, v87
  v_accvgpr_write_b32 a204, v90
  v_accvgpr_write_b32 a205, v91
  v_accvgpr_write_b32 a206, v94
  v_mfma_f32_16x16x32_bf16 v[160:163], a[112:115], a[168:171], v[160:163]
  v_accvgpr_write_b32 a207, v95
  v_pk_mul_f32 v[96:97], v[96:97], s[40:41] op_sel_hi:[1,0]
  v_pk_mul_f32 v[98:99], v[98:99], s[40:41] op_sel_hi:[1,0]
  v_pk_mul_f32 v[100:101], v[100:101], s[40:41] op_sel_hi:[1,0]
  v_pk_mul_f32 v[102:103], v[102:103], s[40:41] op_sel_hi:[1,0]
  v_pk_mul_f32 v[104:105], v[104:105], s[40:41] op_sel_hi:[1,0]
  v_mfma_f32_16x16x32_bf16 v[164:167], a[128:131], a[168:171], v[164:167]
  v_pk_mul_f32 v[106:107], v[106:107], s[40:41] op_sel_hi:[1,0]
  v_pk_mul_f32 v[108:109], v[108:109], s[40:41] op_sel_hi:[1,0]
  v_pk_mul_f32 v[110:111], v[110:111], s[40:41] op_sel_hi:[1,0]
  v_pk_mul_f32 v[112:113], v[112:113], s[40:41] op_sel_hi:[1,0]
  v_pk_mul_f32 v[114:115], v[114:115], s[40:41] op_sel_hi:[1,0]
  v_pk_mul_f32 v[116:117], v[116:117], s[40:41] op_sel_hi:[1,0]
  v_mfma_f32_16x16x32_bf16 v[160:163], a[116:119], a[172:175], v[160:163]
  s_barrier
  v_pk_mul_f32 v[118:119], v[118:119], s[40:41] op_sel_hi:[1,0]
  v_pk_mul_f32 v[120:121], v[120:121], s[40:41] op_sel_hi:[1,0]
  v_pk_mul_f32 v[122:123], v[122:123], s[40:41] op_sel_hi:[1,0]
  v_pk_mul_f32 v[124:125], v[124:125], s[40:41] op_sel_hi:[1,0]
  v_pk_mul_f32 v[126:127], v[126:127], s[40:41] op_sel_hi:[1,0]
  v_mfma_f32_16x16x32_bf16 v[164:167], a[132:135], a[172:175], v[164:167]
  s_add_u32 m0, s31, 49152
  s_add_u32 s44, s30, 8192
  v_cvt_pk_bf16_f32 v96, v96, v97
  v_cvt_pk_bf16_f32 v100, v100, v101
  v_cvt_pk_bf16_f32 v97, v98, v99
  v_cvt_pk_bf16_f32 v101, v102, v103
  v_mfma_f32_16x16x32_bf16 v[168:171], a[104:107], a[176:179], 0
  v_cvt_pk_bf16_f32 v104, v104, v105
  v_cvt_pk_bf16_f32 v108, v108, v109
  v_cvt_pk_bf16_f32 v105, v106, v107
  v_cvt_pk_bf16_f32 v109, v110, v111
  v_cvt_pk_bf16_f32 v112, v112, v113
  v_cvt_pk_bf16_f32 v116, v116, v117
  v_mfma_f32_16x16x32_bf16 v[172:175], a[120:123], a[176:179], 0
  v_cvt_pk_bf16_f32 v113, v114, v115
  v_cvt_pk_bf16_f32 v117, v118, v119
  v_cvt_pk_bf16_f32 v120, v120, v121
  v_cvt_pk_bf16_f32 v124, v124, v125
  v_cvt_pk_bf16_f32 v121, v122, v123
  v_cvt_pk_bf16_f32 v125, v126, v127
  v_mfma_f32_16x16x32_bf16 v[168:171], a[108:111], a[180:183], v[168:171]
  buffer_load_dwordx4 v249, s[16:19], s44 offen offset:0 nt lds
  v_cndmask_b32 v98, v96, v100, vcc
  v_cndmask_b32 v102, v100, v96, vcc
  v_cndmask_b32 v99, v97, v101, vcc
  v_cndmask_b32 v103, v101, v97, vcc
  v_cndmask_b32 v106, v104, v108, vcc
  v_mfma_f32_16x16x32_bf16 v[172:175], a[124:127], a[180:183], v[172:175]
  v_cndmask_b32 v110, v108, v104, vcc
  v_cndmask_b32 v107, v105, v109, vcc
  v_cndmask_b32 v111, v109, v105, vcc
  v_cndmask_b32 v114, v112, v116, vcc
  v_cndmask_b32 v118, v116, v112, vcc
  v_cndmask_b32 v115, v113, v117, vcc
  v_mfma_f32_16x16x32_bf16 v[168:171], a[112:115], a[184:187], v[168:171]
  v_cndmask_b32 v119, v117, v113, vcc
  v_cndmask_b32 v122, v120, v124, vcc
  v_cndmask_b32 v126, v124, v120, vcc
  v_cndmask_b32 v123, v121, v125, vcc
  v_cndmask_b32 v127, v125, v121, vcc
  v_accvgpr_write_b32 a208, v98
  v_mfma_f32_16x16x32_bf16 v[172:175], a[128:131], a[184:187], v[172:175]
  buffer_load_dwordx4 v250, s[16:19], s44 offen offset:1024 nt lds
  v_accvgpr_write_b32 a209, v99
  v_accvgpr_write_b32 a210, v102
  v_accvgpr_write_b32 a211, v103
  v_accvgpr_write_b32 a212, v106
  v_accvgpr_write_b32 a213, v107
  v_mfma_f32_16x16x32_bf16 v[168:171], a[116:119], a[188:191], v[168:171]
  v_accvgpr_write_b32 a214, v110
  v_accvgpr_write_b32 a215, v111
  v_accvgpr_write_b32 a216, v114
  v_accvgpr_write_b32 a217, v115
  v_accvgpr_write_b32 a218, v118
  v_accvgpr_write_b32 a219, v119
  v_mfma_f32_16x16x32_bf16 v[172:175], a[132:135], a[188:191], v[172:175]
  v_accvgpr_write_b32 a220, v122
  v_accvgpr_write_b32 a221, v123
  v_accvgpr_write_b32 a222, v126
  v_accvgpr_write_b32 a223, v127
  v_pk_mul_f32 v[128:129], v[128:129], s[40:41] op_sel_hi:[1,0]
  v_pk_mul_f32 v[130:131], v[130:131], s[40:41] op_sel_hi:[1,0]
  v_mfma_f32_16x16x32_bf16 v[176:179], a[104:107], a[192:195], 0
  v_pk_mul_f32 v[132:133], v[132:133], s[40:41] op_sel_hi:[1,0]
  v_pk_mul_f32 v[134:135], v[134:135], s[40:41] op_sel_hi:[1,0]
  v_pk_mul_f32 v[136:137], v[136:137], s[40:41] op_sel_hi:[1,0]
  v_pk_mul_f32 v[138:139], v[138:139], s[40:41] op_sel_hi:[1,0]
  v_pk_mul_f32 v[140:141], v[140:141], s[40:41] op_sel_hi:[1,0]
  v_pk_mul_f32 v[142:143], v[142:143], s[40:41] op_sel_hi:[1,0]
  v_mfma_f32_16x16x32_bf16 v[180:183], a[120:123], a[192:195], 0
  buffer_load_dwordx4 v249, s[16:19], s44 offen offset:2048 nt lds
  v_pk_mul_f32 v[144:145], v[144:145], s[40:41] op_sel_hi:[1,0]
  v_pk_mul_f32 v[146:147], v[146:147], s[40:41] op_sel_hi:[1,0]
  v_pk_mul_f32 v[148:149], v[148:149], s[40:41] op_sel_hi:[1,0]
  v_pk_mul_f32 v[150:151], v[150:151], s[40:41] op_sel_hi:[1,0]
  v_pk_mul_f32 v[152:153], v[152:153], s[40:41] op_sel_hi:[1,0]
  v_mfma_f32_16x16x32_bf16 v[176:179], a[108:111], a[196:199], v[176:179]
  v_pk_mul_f32 v[154:155], v[154:155], s[40:41] op_sel_hi:[1,0]
  v_pk_mul_f32 v[156:157], v[156:157], s[40:41] op_sel_hi:[1,0]
  v_pk_mul_f32 v[158:159], v[158:159], s[40:41] op_sel_hi:[1,0]
  v_cvt_pk_bf16_f32 v128, v128, v129
  v_cvt_pk_bf16_f32 v132, v132, v133
  v_cvt_pk_bf16_f32 v129, v130, v131
  v_mfma_f32_16x16x32_bf16 v[180:183], a[124:127], a[196:199], v[180:183]
  v_cvt_pk_bf16_f32 v133, v134, v135
  v_cvt_pk_bf16_f32 v136, v136, v137
  v_cvt_pk_bf16_f32 v140, v140, v141
  v_cvt_pk_bf16_f32 v137, v138, v139
  v_cvt_pk_bf16_f32 v141, v142, v143
  v_cvt_pk_bf16_f32 v144, v144, v145
  v_mfma_f32_16x16x32_bf16 v[176:179], a[112:115], a[200:203], v[176:179]
  v_cvt_pk_bf16_f32 v148, v148, v149
  v_cvt_pk_bf16_f32 v145, v146, v147
  v_cvt_pk_bf16_f32 v149, v150, v151
  v_cvt_pk_bf16_f32 v152, v152, v153
  v_cvt_pk_bf16_f32 v156, v156, v157
  v_cvt_pk_bf16_f32 v153, v154, v155
  v_mfma_f32_16x16x32_bf16 v[180:183], a[128:131], a[200:203], v[180:183]
  buffer_load_dwordx4 v250, s[16:19], s44 offen offset:3072 nt lds
  v_cvt_pk_bf16_f32 v157, v158, v159
  v_cndmask_b32 v130, v128, v132, vcc
  v_cndmask_b32 v134, v132, v128, vcc
  v_cndmask_b32 v131, v129, v133, vcc
  v_cndmask_b32 v135, v133, v129, vcc
  v_mfma_f32_16x16x32_bf16 v[176:179], a[116:119], a[204:207], v[176:179]
  v_cndmask_b32 v138, v136, v140, vcc
  v_cndmask_b32 v142, v140, v136, vcc
  v_cndmask_b32 v139, v137, v141, vcc
  v_cndmask_b32 v143, v141, v137, vcc
  v_cndmask_b32 v146, v144, v148, vcc
  v_cndmask_b32 v150, v148, v144, vcc
  v_mfma_f32_16x16x32_bf16 v[180:183], a[132:135], a[204:207], v[180:183]
  s_add_u32 s44, s30, 49152
  v_cndmask_b32 v147, v145, v149, vcc
  v_cndmask_b32 v151, v149, v145, vcc
  v_cndmask_b32 v154, v152, v156, vcc
  v_cndmask_b32 v158, v156, v152, vcc
  v_cndmask_b32 v155, v153, v157, vcc
  v_mfma_f32_16x16x32_bf16 v[184:187], a[104:107], a[208:211], 0
  v_cndmask_b32 v159, v157, v153, vcc
  v_accvgpr_write_b32 a224, v130
  v_accvgpr_write_b32 a225, v131
  v_accvgpr_write_b32 a226, v134
  v_accvgpr_write_b32 a227, v135
  v_accvgpr_write_b32 a228, v138
  v_mfma_f32_16x16x32_bf16 v[188:191], a[120:123], a[208:211], 0
  v_accvgpr_write_b32 a229, v139
  v_accvgpr_write_b32 a230, v142
  v_accvgpr_write_b32 a231, v143
  v_accvgpr_write_b32 a232, v146
  v_add_u32 v245, 0, v248
  v_accvgpr_write_b32 a233, v147
  v_mfma_f32_16x16x32_bf16 v[184:187], a[108:111], a[212:215], v[184:187]
  buffer_load_dwordx4 a[48:51], v249, s[16:19], s44 offen offset:0 nt
  v_xor_b32 v246, 32, v245
  v_accvgpr_write_b32 a234, v150
  v_accvgpr_write_b32 a235, v151
  v_accvgpr_write_b32 a236, v154
  v_accvgpr_write_b32 a237, v155
  v_mfma_f32_16x16x32_bf16 v[188:191], a[124:127], a[212:215], v[188:191]
  v_accvgpr_write_b32 a238, v158
  v_accvgpr_write_b32 a239, v159
  v_max3_f32 v240, v160, v161, v162
  v_max3_f32 v241, v163, v164, v165
  v_max3_f32 v240, v240, v166, v167
  v_max_f32 v240, v240, v241
  v_mfma_f32_16x16x32_bf16 v[184:187], a[112:115], a[216:219], v[184:187]
  v_mov_b32 v241, v240
  s_nop 1
  v_permlane32_swap_b32 v240, v241
  v_max_f32 v240, v240, v241
  v_mov_b32 v241, v240
  s_nop 1
  v_permlane16_swap_b32 v240, v241
  v_max_f32 v240, v240, v241
  v_mfma_f32_16x16x32_bf16 v[188:191], a[128:131], a[216:219], v[188:191]
  v_sub_f32 v220, 0, v240
  v_sub_f32 v221, 0, v240
  v_sub_f32 v222, 0, v240
  v_sub_f32 v223, 0, v240
  v_sub_f32 v160, v160, v240
  v_sub_f32 v161, v161, v240
  v_mfma_f32_16x16x32_bf16 v[184:187], a[116:119], a[220:223], v[184:187]
  v_sub_f32 v162, v162, v240
  v_sub_f32 v163, v163, v240
  v_sub_f32 v164, v164, v240
  v_sub_f32 v165, v165, v240
  v_sub_f32 v166, v166, v240
  v_sub_f32 v167, v167, v240
  v_mfma_f32_16x16x32_bf16 v[188:191], a[132:135], a[220:223], v[188:191]
  buffer_load_dwordx4 a[52:55], v250, s[16:19], s44 offen offset:1024 nt
  v_exp_f32 v160, v160
  v_exp_f32 v161, v161
  v_add_u32 v244, 0, v247
  v_mfma_f32_16x16x32_bf16 v[192:195], a[104:107], a[224:227], 0
  v_exp_f32 v162, v162
  v_exp_f32 v163, v163
  v_exp_f32 v164, v164
  v_mfma_f32_16x16x32_bf16 v[196:199], a[120:123], a[224:227], 0
  ds_read_b128 a[104:107], v244 offset:0
  ds_read_b128 a[120:123], v244 offset:4096
  v_exp_f32 v165, v165
  v_exp_f32 v166, v166
  v_mfma_f32_16x16x32_bf16 v[192:195], a[108:111], a[228:231], v[192:195]
  ds_read_b128 a[108:111], v244 offset:256
  v_exp_f32 v167, v167
  v_cvt_pk_bf16_f32 v200, v160, v161
  v_cvt_pk_bf16_f32 v201, v162, v163
  v_cvt_pk_bf16_f32 v202, v164, v165
  v_mfma_f32_16x16x32_bf16 v[196:199], a[124:127], a[228:231], v[196:199]
  s_waitcnt lgkmcnt(11)
  ds_read_b128 a[124:127], v244 offset:4352
  v_cvt_pk_bf16_f32 v203, v166, v167
  v_max3_f32 v240, v168, v169, v170
  v_max3_f32 v241, v171, v172, v173
  v_max3_f32 v240, v240, v174, v175
  v_max_f32 v240, v240, v241
  v_mfma_f32_16x16x32_bf16 v[192:195], a[112:115], a[232:235], v[192:195]
  ds_read_b128 a[112:115], v244 offset:512
  buffer_load_dwordx4 a[56:59], v249, s[16:19], s44 offen offset:2048 nt
  v_mov_b32 v241, v240
  s_nop 1
  v_permlane32_swap_b32 v240, v241
  v_max_f32 v240, v240, v241
  v_mov_b32 v241, v240
  v_mfma_f32_16x16x32_bf16 v[196:199], a[128:131], a[232:235], v[196:199]
  ds_read_b128 a[128:131], v244 offset:4608
  ds_read_b64_tr_b16 a[0:1], v245 offset:16384
  s_waitcnt lgkmcnt(11)
  ds_read_b64_tr_b16 a[2:3], v245 offset:20480
  v_permlane16_swap_b32 v240, v241
  v_max_f32 v240, v240, v241
  v_sub_f32 v224, 0, v240
  v_mfma_f32_16x16x32_bf16 v[192:195], a[116:119], a[236:239], v[192:195]
  ds_read_b128 a[116:119], v244 offset:768
  ds_read_b64_tr_b16 a[4:5], v246 offset:16384
  ds_read_b64_tr_b16 a[6:7], v246 offset:20480
  s_waitcnt lgkmcnt(11)
  ds_read_b64_tr_b16 a[8:9], v245 offset:16640
  v_sub_f32 v225, 0, v240
  v_sub_f32 v226, 0, v240
  v_mfma_f32_16x16x32_bf16 v[196:199], a[132:135], a[236:239], v[196:199]
  ds_read_b128 a[132:135], v244 offset:4864
  ds_read_b64_tr_b16 a[10:11], v245 offset:20736
  ds_read_b64_tr_b16 a[12:13], v246 offset:16640
  v_sub_f32 v227, 0, v240
  v_sub_f32 v168, v168, v240
  s_waitcnt lgkmcnt(2)
  v_mfma_f32_16x16x32_bf16 v[160:163], a[104:107], a[160:163], v[220:223]
  ds_read_b64_tr_b16 a[14:15], v246 offset:20736
  ds_read_b64_tr_b16 a[16:17], v245 offset:16896
  ds_read_b64_tr_b16 a[18:19], v245 offset:20992
  v_sub_f32 v169, v169, v240
  v_sub_f32 v170, v170, v240
  v_sub_f32 v171, v171, v240
  v_mfma_f32_16x16x32_bf16 v[164:167], a[120:123], a[160:163], v[220:223]
  ds_read_b64_tr_b16 a[20:21], v246 offset:16896
  ds_read_b64_tr_b16 a[22:23], v246 offset:20992
  ds_read_b64_tr_b16 a[24:25], v245 offset:17152
  v_sub_f32 v172, v172, v240
  v_sub_f32 v173, v173, v240
  v_sub_f32 v174, v174, v240
  v_mfma_f32_16x16x32_bf16 v[160:163], a[108:111], a[164:167], v[160:163]
  ds_read_b64_tr_b16 a[26:27], v245 offset:21248
  ds_read_b64_tr_b16 a[28:29], v246 offset:17152
  ds_read_b64_tr_b16 a[30:31], v246 offset:21248
  v_sub_f32 v175, v175, v240
  v_exp_f32 v168, v168
  v_mfma_f32_16x16x32_bf16 v[164:167], a[124:127], a[164:167], v[164:167]
  v_exp_f32 v169, v169
  v_exp_f32 v170, v170
  v_exp_f32 v171, v171
  v_mfma_f32_16x16x32_bf16 v[160:163], a[112:115], a[168:171], v[160:163]
  buffer_load_dwordx4 a[60:63], v250, s[16:19], s44 offen offset:3072 nt
  v_exp_f32 v172, v172
  v_exp_f32 v173, v173
  v_mfma_f32_16x16x32_bf16 v[164:167], a[128:131], a[168:171], v[164:167]
  v_exp_f32 v174, v174
  v_exp_f32 v175, v175
  v_cvt_pk_bf16_f32 v204, v168, v169
  v_cvt_pk_bf16_f32 v205, v170, v171
  v_mfma_f32_16x16x32_bf16 v[160:163], a[116:119], a[172:175], v[160:163]
  v_cvt_pk_bf16_f32 v206, v172, v173
  v_cvt_pk_bf16_f32 v207, v174, v175
  v_max3_f32 v240, v176, v177, v178
  v_max3_f32 v241, v179, v180, v181
  v_max3_f32 v240, v240, v182, v183
  v_max_f32 v240, v240, v241
  v_mfma_f32_16x16x32_bf16 v[164:167], a[132:135], a[172:175], v[164:167]
  v_mov_b32 v241, v240
  s_nop 1
  v_permlane32_swap_b32 v240, v241
  v_max_f32 v240, v240, v241
  v_mov_b32 v241, v240
  s_nop 1
  v_permlane16_swap_b32 v240, v241
  v_max_f32 v240, v240, v241
  v_mfma_f32_16x16x32_bf16 v[168:171], a[104:107], a[176:179], v[224:227]
  v_sub_f32 v228, 0, v240
  s_waitcnt lgkmcnt(0)
  s_barrier
  v_sub_f32 v229, 0, v240
  v_sub_f32 v230, 0, v240
  v_sub_f32 v231, 0, v240
  v_mfma_f32_16x16x32_bf16 v[172:175], a[120:123], a[176:179], v[224:227]
  v_sub_f32 v176, v176, v240
  v_sub_f32 v177, v177, v240
  v_sub_f32 v178, v178, v240
  v_sub_f32 v179, v179, v240
  v_sub_f32 v180, v180, v240
  v_sub_f32 v181, v181, v240
  v_mfma_f32_16x16x32_bf16 v[168:171], a[108:111], a[180:183], v[168:171]
  v_sub_f32 v182, v182, v240
  v_sub_f32 v183, v183, v240
  v_exp_f32 v176, v176
  s_add_u32 m0, s31, 0
  v_mfma_f32_16x16x32_bf16 v[172:175], a[124:127], a[180:183], v[172:175]
  v_exp_f32 v177, v177
  v_exp_f32 v178, v178
  v_exp_f32 v179, v179
  v_mfma_f32_16x16x32_bf16 v[168:171], a[112:115], a[184:187], v[168:171]
  v_exp_f32 v180, v180
  v_exp_f32 v181, v181
  v_exp_f32 v182, v182
  v_mfma_f32_16x16x32_bf16 v[172:175], a[128:131], a[184:187], v[172:175]
  v_exp_f32 v183, v183
  v_cvt_pk_bf16_f32 v208, v176, v177
  v_cvt_pk_bf16_f32 v209, v178, v179
  v_cvt_pk_bf16_f32 v210, v180, v181
  v_cvt_pk_bf16_f32 v211, v182, v183
  v_mfma_f32_16x16x32_bf16 v[168:171], a[116:119], a[188:191], v[168:171]
  buffer_load_dwordx4 v249, s[12:15], s44 offen offset:0 nt lds
  v_max3_f32 v240, v184, v185, v186
  v_max3_f32 v241, v187, v188, v189
  v_max3_f32 v240, v240, v190, v191
  v_max_f32 v240, v240, v241
  v_mov_b32 v241, v240
  v_mfma_f32_16x16x32_bf16 v[172:175], a[132:135], a[188:191], v[172:175]
  s_nop 0
  v_permlane32_swap_b32 v240, v241
  v_max_f32 v240, v240, v241
  v_mov_b32 v241, v240
  s_nop 1
  v_permlane16_swap_b32 v240, v241
  v_max_f32 v240, v240, v241
  v_sub_f32 v232, 0, v240
  v_mfma_f32_16x16x32_bf16 v[176:179], a[104:107], a[192:195], v[228:231]
  buffer_load_dwordx4 v250, s[12:15], s44 offen offset:1024 nt lds
  v_sub_f32 v233, 0, v240
  v_sub_f32 v234, 0, v240
  v_sub_f32 v235, 0, v240
  v_sub_f32 v184, v184, v240
  v_sub_f32 v185, v185, v240
  v_mfma_f32_16x16x32_bf16 v[180:183], a[120:123], a[192:195], v[228:231]
  v_sub_f32 v186, v186, v240
  v_sub_f32 v187, v187, v240
  v_sub_f32 v188, v188, v240
  v_sub_f32 v189, v189, v240
  v_sub_f32 v190, v190, v240
  v_sub_f32 v191, v191, v240
  v_mfma_f32_16x16x32_bf16 v[176:179], a[108:111], a[196:199], v[176:179]
  v_exp_f32 v184, v184
  v_exp_f32 v185, v185
  v_exp_f32 v186, v186
  v_mfma_f32_16x16x32_bf16 v[180:183], a[124:127], a[196:199], v[180:183]
  buffer_load_dwordx4 v249, s[12:15], s44 offen offset:2048 nt lds
  v_exp_f32 v187, v187
  v_exp_f32 v188, v188
  v_mfma_f32_16x16x32_bf16 v[176:179], a[112:115], a[200:203], v[176:179]
  v_exp_f32 v189, v189
  v_exp_f32 v190, v190
  v_exp_f32 v191, v191
  v_mfma_f32_16x16x32_bf16 v[180:183], a[128:131], a[200:203], v[180:183]
  buffer_load_dwordx4 v250, s[12:15], s44 offen offset:3072 nt lds
  v_cvt_pk_bf16_f32 v212, v184, v185
  v_cvt_pk_bf16_f32 v213, v186, v187
  v_cvt_pk_bf16_f32 v214, v188, v189
  v_cvt_pk_bf16_f32 v215, v190, v191
  s_add_u32 m0, s31, 16384
  v_mfma_f32_16x16x32_bf16 v[176:179], a[116:119], a[204:207], v[176:179]
  s_add_u32 s44, s30, 40960
  v_max3_f32 v240, v192, v193, v194
  v_max3_f32 v241, v195, v196, v197
  v_max3_f32 v240, v240, v198, v199
  v_max_f32 v240, v240, v241
  v_mov_b32 v241, v240
  v_mfma_f32_16x16x32_bf16 v[180:183], a[132:135], a[204:207], v[180:183]
  s_nop 0
  v_permlane32_swap_b32 v240, v241
  v_max_f32 v240, v240, v241
  v_mov_b32 v241, v240
  s_nop 1
  v_permlane16_swap_b32 v240, v241
  v_max_f32 v240, v240, v241
  v_sub_f32 v236, 0, v240
  v_mfma_f32_16x16x32_bf16 v[184:187], a[104:107], a[208:211], v[232:235]
  v_sub_f32 v237, 0, v240
  v_sub_f32 v238, 0, v240
  v_sub_f32 v239, 0, v240
  v_sub_f32 v192, v192, v240
  v_sub_f32 v193, v193, v240
  v_sub_f32 v194, v194, v240
  v_mfma_f32_16x16x32_bf16 v[188:191], a[120:123], a[208:211], v[232:235]
  buffer_load_dwordx4 v249, s[16:19], s44 offen offset:0 nt lds
  v_sub_f32 v195, v195, v240
  v_sub_f32 v196, v196, v240
  v_sub_f32 v197, v197, v240
  v_sub_f32 v198, v198, v240
  v_sub_f32 v199, v199, v240
  v_mfma_f32_16x16x32_bf16 v[184:187], a[108:111], a[212:215], v[184:187]
  v_exp_f32 v192, v192
  v_exp_f32 v193, v193
  v_exp_f32 v194, v194
  v_mfma_f32_16x16x32_bf16 v[188:191], a[124:127], a[212:215], v[188:191]
  v_exp_f32 v195, v195
  v_exp_f32 v196, v196
  v_exp_f32 v197, v197
  v_mfma_f32_16x16x32_bf16 v[184:187], a[112:115], a[216:219], v[184:187]
  buffer_load_dwordx4 v250, s[16:19], s44 offen offset:1024 nt lds
  v_exp_f32 v198, v198
  v_exp_f32 v199, v199
  v_cvt_pk_bf16_f32 v216, v192, v193
  v_mfma_f32_16x16x32_bf16 v[188:191], a[128:131], a[216:219], v[188:191]
  v_cvt_pk_bf16_f32 v217, v194, v195
  v_cvt_pk_bf16_f32 v218, v196, v197
  v_cvt_pk_bf16_f32 v219, v198, v199
  v_mfma_f32_16x16x32_bf16 v[184:187], a[116:119], a[220:223], v[184:187]
  buffer_load_dwordx4 v249, s[16:19], s44 offen offset:2048 nt lds
  v_mfma_f32_16x16x32_bf16 v[188:191], a[132:135], a[220:223], v[188:191]
  v_mfma_f32_16x16x32_bf16 v[192:195], a[104:107], a[224:227], v[236:239]
  v_mfma_f32_16x16x32_bf16 v[196:199], a[120:123], a[224:227], v[236:239]
  buffer_load_dwordx4 v250, s[16:19], s44 offen offset:3072 nt lds
  v_mfma_f32_16x16x32_bf16 v[192:195], a[108:111], a[228:231], v[192:195]
  v_mfma_f32_16x16x32_bf16 v[196:199], a[124:127], a[228:231], v[196:199]
  v_mfma_f32_16x16x32_bf16 v[192:195], a[112:115], a[232:235], v[192:195]
  v_mfma_f32_16x16x32_bf16 v[196:199], a[128:131], a[232:235], v[196:199]
  v_mfma_f32_16x16x32_bf16 v[192:195], a[116:119], a[236:239], v[192:195]
  v_mfma_f32_16x16x32_bf16 v[196:199], a[132:135], a[236:239], v[196:199]
  s_waitcnt vmcnt(12)
  s_barrier
  v_mfma_f32_16x16x32_bf16 a[136:139], a[156:159], v[200:203], 0
  v_max_f32 v240, v160, v161
  v_max_f32 v241, v162, v163
  v_mfma_f32_16x16x32_bf16 a[140:143], a[156:159], v[204:207], 0
  v_max3_f32 v240, v164, v165, v240
  v_max3_f32 v241, v166, v167, v241
  v_mfma_f32_16x16x32_bf16 a[144:147], a[156:159], v[208:211], 0
  v_max3_f32 v240, v168, v169, v240
  v_max3_f32 v241, v170, v171, v241
  v_mfma_f32_16x16x32_bf16 a[148:151], a[156:159], v[212:215], 0
  v_max3_f32 v240, v172, v173, v240
  v_max3_f32 v241, v174, v175, v241
  v_mfma_f32_16x16x32_bf16 a[152:155], a[156:159], v[216:219], 0
  v_max3_f32 v240, v176, v177, v240
  v_max3_f32 v241, v178, v179, v241
  v_mfma_f32_16x16x32_bf16 v[0:3], a[0:3], v[200:203], 0
  v_max3_f32 v240, v180, v181, v240
  v_max3_f32 v241, v182, v183, v241
  v_mfma_f32_16x16x32_bf16 v[4:7], a[4:7], v[200:203], 0
  v_max3_f32 v240, v184, v185, v240
  v_max3_f32 v241, v186, v187, v241
  v_mfma_f32_16x16x32_bf16 v[8:11], a[8:11], v[200:203], 0
  v_max3_f32 v240, v188, v189, v240
  v_max3_f32 v241, v190, v191, v241
  v_mfma_f32_16x16x32_bf16 v[12:15], a[12:15], v[200:203], 0
  v_max3_f32 v240, v192, v193, v240
  v_max3_f32 v241, v194, v195, v241
  v_mfma_f32_16x16x32_bf16 v[16:19], a[16:19], v[200:203], 0
  v_max3_f32 v240, v196, v197, v240
  v_max3_f32 v241, v198, v199, v241
  v_mfma_f32_16x16x32_bf16 v[20:23], a[20:23], v[200:203], 0
  v_max_f32 v240, v240, v241
  v_cmp_lt_f32 vcc, s41, v240
  v_mfma_f32_16x16x32_bf16 v[24:27], a[24:27], v[200:203], 0
  s_cbranch_vccnz L_stub1
L_ret1:
  v_add_u32 v244, 32768, v247
  v_mfma_f32_16x16x32_bf16 v[28:31], a[28:31], v[200:203], 0
  v_exp_f32 v160, v160
  v_mfma_f32_16x16x32_bf16 v[32:35], a[0:3], v[204:207], 0
  v_exp_f32 v161, v161
  v_mfma_f32_16x16x32_bf16 v[36:39], a[4:7], v[204:207], 0
  v_exp_f32 v162, v162
  v_mfma_f32_16x16x32_bf16 v[40:43], a[8:11], v[204:207], 0
  v_exp_f32 v163, v163
  v_mfma_f32_16x16x32_bf16 v[44:47], a[12:15], v[204:207], 0
  v_exp_f32 v164, v164
  v_mfma_f32_16x16x32_bf16 v[48:51], a[16:19], v[204:207], 0
  v_exp_f32 v165, v165
  v_mfma_f32_16x16x32_bf16 v[52:55], a[20:23], v[204:207], 0
  v_exp_f32 v166, v166
  v_mfma_f32_16x16x32_bf16 v[56:59], a[24:27], v[204:207], 0
  ds_read_b128 a[104:107], v244 offset:0
  ds_read_b128 a[120:123], v244 offset:4096
  v_mfma_f32_16x16x32_bf16 v[60:63], a[28:31], v[204:207], 0
  v_exp_f32 v167, v167
  v_mfma_f32_16x16x32_bf16 v[64:67], a[0:3], v[208:211], 0
  s_add_u32 s44, s30, 65536
  ds_read_b128 a[108:111], v244 offset:256
  v_mfma_f32_16x16x32_bf16 v[68:71], a[4:7], v[208:211], 0
  ds_read_b128 a[124:127], v244 offset:4352
  v_cvt_pk_bf16_f32 v200, v160, v161
  v_mfma_f32_16x16x32_bf16 v[72:75], a[8:11], v[208:211], 0
  ds_read_b128 a[112:115], v244 offset:512
  v_cvt_pk_bf16_f32 v201, v162, v163
  v_mfma_f32_16x16x32_bf16 v[76:79], a[12:15], v[208:211], 0
  buffer_load_dwordx4 a[64:67], v249, s[12:15], s44 offen offset:0 nt
  ds_read_b128 a[128:131], v244 offset:4608
  v_mfma_f32_16x16x32_bf16 v[80:83], a[16:19], v[208:211], 0
  ds_read_b128 a[116:119], v244 offset:768
  v_cvt_pk_bf16_f32 v202, v164, v165
  v_mfma_f32_16x16x32_bf16 v[84:87], a[20:23], v[208:211], 0
  ds_read_b128 a[132:135], v244 offset:4864
  v_cvt_pk_bf16_f32 v203, v166, v167
  v_mfma_f32_16x16x32_bf16 v[88:91], a[24:27], v[208:211], 0
  v_exp_f32 v168, v168
  v_mfma_f32_16x16x32_bf16 v[92:95], a[28:31], v[208:211], 0
  v_exp_f32 v169, v169
  v_mfma_f32_16x16x32_bf16 v[96:99], a[0:3], v[212:215], 0
  v_exp_f32 v170, v170
  v_mfma_f32_16x16x32_bf16 v[100:103], a[4:7], v[212:215], 0
  v_exp_f32 v171, v171
  v_mfma_f32_16x16x32_bf16 v[104:107], a[8:11], v[212:215], 0
  buffer_load_dwordx4 a[68:71], v250, s[12:15], s44 offen offset:1024 nt
  v_add_u32 v245, 32768, v248
  v_mfma_f32_16x16x32_bf16 v[108:111], a[12:15], v[212:215], 0
  v_exp_f32 v172, v172
  v_mfma_f32_16x16x32_bf16 v[112:115], a[16:19], v[212:215], 0
  v_exp_f32 v173, v173
  v_mfma_f32_16x16x32_bf16 v[116:119], a[20:23], v[212:215], 0
  v_exp_f32 v174, v174
  v_mfma_f32_16x16x32_bf16 v[120:123], a[24:27], v[212:215], 0
  v_exp_f32 v175, v175
  v_mfma_f32_16x16x32_bf16 v[124:127], a[28:31], v[212:215], 0
  v_cvt_pk_bf16_f32 v204, v168, v169
  v_cvt_pk_bf16_f32 v205, v170, v171
  v_mfma_f32_16x16x32_bf16 v[128:131], a[0:3], v[216:219], 0
  v_cvt_pk_bf16_f32 v206, v172, v173
  v_cvt_pk_bf16_f32 v207, v174, v175
  v_mfma_f32_16x16x32_bf16 v[132:135], a[4:7], v[216:219], 0
  buffer_load_dwordx4 a[72:75], v249, s[12:15], s44 offen offset:2048 nt
  v_xor_b32 v246, 32, v245
  v_mfma_f32_16x16x32_bf16 v[136:139], a[8:11], v[216:219], 0
  v_exp_f32 v176, v176
  v_mfma_f32_16x16x32_bf16 v[140:143], a[12:15], v[216:219], 0
  v_exp_f32 v177, v177
  v_mfma_f32_16x16x32_bf16 v[144:147], a[16:19], v[216:219], 0
  v_exp_f32 v178, v178
  v_mfma_f32_16x16x32_bf16 v[148:151], a[20:23], v[216:219], 0
  v_exp_f32 v179, v179
  v_mfma_f32_16x16x32_bf16 v[152:155], a[24:27], v[216:219], 0
  v_exp_f32 v180, v180
  v_mfma_f32_16x16x32_bf16 v[156:159], a[28:31], v[216:219], 0
  ds_read_b64_tr_b16 a[0:1], v245 offset:16384
  s_waitcnt lgkmcnt(1)
  v_mfma_f32_16x16x32_bf16 v[160:163], a[104:107], a[160:163], v[220:223]
  buffer_load_dwordx4 a[76:79], v250, s[12:15], s44 offen offset:3072 nt
  ds_read_b64_tr_b16 a[2:3], v245 offset:20480
  v_mfma_f32_16x16x32_bf16 v[164:167], a[120:123], a[160:163], v[220:223]
  v_exp_f32 v181, v181
  v_mfma_f32_16x16x32_bf16 v[160:163], a[108:111], a[164:167], v[160:163]
  v_exp_f32 v182, v182
  v_mfma_f32_16x16x32_bf16 v[164:167], a[124:127], a[164:167], v[164:167]
  v_exp_f32 v183, v183
  v_mfma_f32_16x16x32_bf16 v[160:163], a[112:115], a[168:171], v[160:163]
  s_add_u32 s44, s30, 57344
  v_cvt_pk_bf16_f32 v208, v176, v177
  v_mfma_f32_16x16x32_bf16 v[164:167], a[128:131], a[168:171], v[164:167]
  v_cvt_pk_bf16_f32 v209, v178, v179
  v_cvt_pk_bf16_f32 v210, v180, v181
  v_mfma_f32_16x16x32_bf16 v[160:163], a[116:119], a[172:175], v[160:163]
  ds_read_b64_tr_b16 a[4:5], v246 offset:16384
  v_cvt_pk_bf16_f32 v211, v182, v183
  v_mfma_f32_16x16x32_bf16 v[164:167], a[132:135], a[172:175], v[164:167]
  buffer_load_dwordx4 a[80:83], v249, s[16:19], s44 offen offset:0 nt
  ds_read_b64_tr_b16 a[6:7], v246 offset:20480
  v_mfma_f32_16x16x32_bf16 v[168:171], a[104:107], a[176:179], v[224:227]
  v_exp_f32 v184, v184
  v_mfma_f32_16x16x32_bf16 v[172:175], a[120:123], a[176:179], v[224:227]
  v_exp_f32 v185, v185
  v_mfma_f32_16x16x32_bf16 v[168:171], a[108:111], a[180:183], v[168:171]
  v_exp_f32 v186, v186
  v_mfma_f32_16x16x32_bf16 v[172:175], a[124:127], a[180:183], v[172:175]
  v_exp_f32 v187, v187
  v_mfma_f32_16x16x32_bf16 v[168:171], a[112:115], a[184:187], v[168:171]
  v_exp_f32 v188, v188
  v_mfma_f32_16x16x32_bf16 v[172:175], a[128:131], a[184:187], v[172:175]
  v_exp_f32 v189, v189
  v_mfma_f32_16x16x32_bf16 v[168:171], a[116:119], a[188:191], v[168:171]
  v_exp_f32 v190, v190
  v_mfma_f32_16x16x32_bf16 v[172:175], a[132:135], a[188:191], v[172:175]
  buffer_load_dwordx4 a[84:87], v250, s[16:19], s44 offen offset:1024 nt
  ds_read_b64_tr_b16 a[8:9], v245 offset:16640
  v_mfma_f32_16x16x32_bf16 v[176:179], a[104:107], a[192:195], v[228:231]
  v_exp_f32 v191, v191
  v_mfma_f32_16x16x32_bf16 v[180:183], a[120:123], a[192:195], v[228:231]
  v_cvt_pk_bf16_f32 v212, v184, v185
  v_cvt_pk_bf16_f32 v213, v186, v187
  v_mfma_f32_16x16x32_bf16 v[176:179], a[108:111], a[196:199], v[176:179]
  v_cvt_pk_bf16_f32 v214, v188, v189
  v_cvt_pk_bf16_f32 v215, v190, v191
  v_mfma_f32_16x16x32_bf16 v[180:183], a[124:127], a[196:199], v[180:183]
  v_exp_f32 v192, v192
  v_mfma_f32_16x16x32_bf16 v[176:179], a[112:115], a[200:203], v[176:179]
  v_exp_f32 v193, v193
  v_mfma_f32_16x16x32_bf16 v[180:183], a[128:131], a[200:203], v[180:183]
  v_exp_f32 v194, v194
  v_mfma_f32_16x16x32_bf16 v[176:179], a[116:119], a[204:207], v[176:179]
  v_exp_f32 v195, v195
  v_mfma_f32_16x16x32_bf16 v[180:183], a[132:135], a[204:207], v[180:183]
  buffer_load_dwordx4 a[88:91], v249, s[16:19], s44 offen offset:2048 nt
  ds_read_b64_tr_b16 a[10:11], v245 offset:20736
  v_mfma_f32_16x16x32_bf16 v[184:187], a[104:107], a[208:211], v[232:235]
  v_exp_f32 v196, v196
  v_mfma_f32_16x16x32_bf16 v[188:191], a[120:123], a[208:211], v[232:235]
  v_exp_f32 v197, v197
  v_mfma_f32_16x16x32_bf16 v[184:187], a[108:111], a[212:215], v[184:187]
  v_exp_f32 v198, v198
  v_mfma_f32_16x16x32_bf16 v[188:191], a[124:127], a[212:215], v[188:191]
  v_exp_f32 v199, v199
  v_mfma_f32_16x16x32_bf16 v[184:187], a[112:115], a[216:219], v[184:187]
  v_cvt_pk_bf16_f32 v216, v192, v193
  v_cvt_pk_bf16_f32 v217, v194, v195
  v_mfma_f32_16x16x32_bf16 v[188:191], a[128:131], a[216:219], v[188:191]
  ds_read_b64_tr_b16 a[12:13], v246 offset:16640
  v_cvt_pk_bf16_f32 v218, v196, v197
  v_mfma_f32_16x16x32_bf16 v[184:187], a[116:119], a[220:223], v[184:187]
  ds_read_b64_tr_b16 a[14:15], v246 offset:20736
  v_cvt_pk_bf16_f32 v219, v198, v199
  v_mfma_f32_16x16x32_bf16 v[188:191], a[132:135], a[220:223], v[188:191]
  ds_read_b64_tr_b16 a[16:17], v245 offset:16896
  ds_read_b64_tr_b16 a[18:19], v245 offset:20992
  v_mfma_f32_16x16x32_bf16 v[192:195], a[104:107], a[224:227], v[236:239]
  buffer_load_dwordx4 a[92:95], v250, s[16:19], s44 offen offset:3072 nt
  ds_read_b64_tr_b16 a[20:21], v246 offset:16896
  v_mfma_f32_16x16x32_bf16 v[196:199], a[120:123], a[224:227], v[236:239]
  ds_read_b64_tr_b16 a[22:23], v246 offset:20992
  ds_read_b64_tr_b16 a[24:25], v245 offset:17152
  v_mfma_f32_16x16x32_bf16 v[192:195], a[108:111], a[228:231], v[192:195]
  ds_read_b64_tr_b16 a[26:27], v245 offset:21248
  ds_read_b64_tr_b16 a[28:29], v246 offset:17152
  v_mfma_f32_16x16x32_bf16 v[196:199], a[124:127], a[228:231], v[196:199]
  s_waitcnt lgkmcnt(11)
  ds_read_b64_tr_b16 a[30:31], v246 offset:21248
  v_mfma_f32_16x16x32_bf16 v[192:195], a[112:115], a[232:235], v[192:195]
  v_mfma_f32_16x16x32_bf16 v[196:199], a[128:131], a[232:235], v[196:199]
  v_mfma_f32_16x16x32_bf16 v[192:195], a[116:119], a[236:239], v[192:195]
  v_mfma_f32_16x16x32_bf16 v[196:199], a[132:135], a[236:239], v[196:199]
  s_waitcnt lgkmcnt(0)
  s_barrier
  v_mfma_f32_16x16x32_bf16 a[136:139], a[156:159], v[200:203], a[136:139]
  v_max_f32 v240, v160, v161
  v_max_f32 v241, v162, v163
  v_mfma_f32_16x16x32_bf16 a[140:143], a[156:159], v[204:207], a[140:143]
  v_max3_f32 v240, v164, v165, v240
  v_max3_f32 v241, v166, v167, v241
  v_mfma_f32_16x16x32_bf16 a[144:147], a[156:159], v[208:211], a[144:147]
  v_max3_f32 v240, v168, v169, v240
  v_max3_f32 v241, v170, v171, v241
  v_mfma_f32_16x16x32_bf16 a[148:151], a[156:159], v[212:215], a[148:151]
  v_max3_f32 v240, v172, v173, v240
  v_max3_f32 v241, v174, v175, v241
  v_mfma_f32_16x16x32_bf16 a[152:155], a[156:159], v[216:219], a[152:155]
  v_max3_f32 v240, v176, v177, v240
  v_max3_f32 v241, v178, v179, v241
  v_mfma_f32_16x16x32_bf16 v[0:3], a[0:3], v[200:203], v[0:3]
  v_max3_f32 v240, v180, v181, v240
  v_max3_f32 v241, v182, v183, v241
  v_mfma_f32_16x16x32_bf16 v[4:7], a[4:7], v[200:203], v[4:7]
  v_max3_f32 v240, v184, v185, v240
  v_max3_f32 v241, v186, v187, v241
  v_mfma_f32_16x16x32_bf16 v[8:11], a[8:11], v[200:203], v[8:11]
  v_max3_f32 v240, v188, v189, v240
  v_max3_f32 v241, v190, v191, v241
  v_mfma_f32_16x16x32_bf16 v[12:15], a[12:15], v[200:203], v[12:15]
  v_max3_f32 v240, v192, v193, v240
  v_max3_f32 v241, v194, v195, v241
  v_mfma_f32_16x16x32_bf16 v[16:19], a[16:19], v[200:203], v[16:19]
  v_max3_f32 v240, v196, v197, v240
  v_max3_f32 v241, v198, v199, v241
  v_mfma_f32_16x16x32_bf16 v[20:23], a[20:23], v[200:203], v[20:23]
  v_max_f32 v240, v240, v241
  v_cmp_lt_f32 vcc, s41, v240
  v_mfma_f32_16x16x32_bf16 v[24:27], a[24:27], v[200:203], v[24:27]
  s_cbranch_vccnz L_stub2
L_ret2:
  v_add_u32 v244, 65536, v247
  v_mfma_f32_16x16x32_bf16 v[28:31], a[28:31], v[200:203], v[28:31]
  v_exp_f32 v160, v160
  v_mfma_f32_16x16x32_bf16 v[32:35], a[0:3], v[204:207], v[32:35]
  v_exp_f32 v161, v161
  v_mfma_f32_16x16x32_bf16 v[36:39], a[4:7], v[204:207], v[36:39]
  v_exp_f32 v162, v162
  v_mfma_f32_16x16x32_bf16 v[40:43], a[8:11], v[204:207], v[40:43]
  v_exp_f32 v163, v163
  v_mfma_f32_16x16x32_bf16 v[44:47], a[12:15], v[204:207], v[44:47]
  v_exp_f32 v164, v164
  v_mfma_f32_16x16x32_bf16 v[48:51], a[16:19], v[204:207], v[48:51]
  v_exp_f32 v165, v165
  v_mfma_f32_16x16x32_bf16 v[52:55], a[20:23], v[204:207], v[52:55]
  v_exp_f32 v166, v166
  v_mfma_f32_16x16x32_bf16 v[56:59], a[24:27], v[204:207], v[56:59]
  ds_read_b128 a[104:107], v244 offset:0
  ds_read_b128 a[120:123], v244 offset:4096
  v_mfma_f32_16x16x32_bf16 v[60:63], a[28:31], v[204:207], v[60:63]
  v_exp_f32 v167, v167
  v_mfma_f32_16x16x32_bf16 v[64:67], a[0:3], v[208:211], v[64:67]
  ds_read_b128 a[108:111], v244 offset:256
  ds_read_b128 a[124:127], v244 offset:4352
  v_mfma_f32_16x16x32_bf16 v[68:71], a[4:7], v[208:211], v[68:71]
  ds_read_b128 a[112:115], v244 offset:512
  v_cvt_pk_bf16_f32 v200, v160, v161
  v_mfma_f32_16x16x32_bf16 v[72:75], a[8:11], v[208:211], v[72:75]
  ds_read_b128 a[128:131], v244 offset:4608
  v_cvt_pk_bf16_f32 v201, v162, v163
  v_mfma_f32_16x16x32_bf16 v[76:79], a[12:15], v[208:211], v[76:79]
  ds_write_b128 v254, a[32:35] offset:0
  v_cvt_pk_bf16_f32 v202, v164, v165
  v_mfma_f32_16x16x32_bf16 v[80:83], a[16:19], v[208:211], v[80:83]
  ds_read_b128 a[116:119], v244 offset:768
  v_cvt_pk_bf16_f32 v203, v166, v167
  v_mfma_f32_16x16x32_bf16 v[84:87], a[20:23], v[208:211], v[84:87]
  ds_read_b128 a[132:135], v244 offset:4864
  v_add_u32 v245, 65536, v248
  v_mfma_f32_16x16x32_bf16 v[88:91], a[24:27], v[208:211], v[88:91]
  v_exp_f32 v168, v168
  v_mfma_f32_16x16x32_bf16 v[92:95], a[28:31], v[208:211], v[92:95]
  v_exp_f32 v169, v169
  v_mfma_f32_16x16x32_bf16 v[96:99], a[0:3], v[212:215], v[96:99]
  v_exp_f32 v170, v170
  v_mfma_f32_16x16x32_bf16 v[100:103], a[4:7], v[212:215], v[100:103]
  v_exp_f32 v171, v171
  v_mfma_f32_16x16x32_bf16 v[104:107], a[8:11], v[212:215], v[104:107]
  ds_write_b128 v254, a[36:39] offset:1024
  v_xor_b32 v246, 32, v245
  v_mfma_f32_16x16x32_bf16 v[108:111], a[12:15], v[212:215], v[108:111]
  v_exp_f32 v172, v172
  v_mfma_f32_16x16x32_bf16 v[112:115], a[16:19], v[212:215], v[112:115]
  v_exp_f32 v173, v173
  v_mfma_f32_16x16x32_bf16 v[116:119], a[20:23], v[212:215], v[116:119]
  v_exp_f32 v174, v174
  v_mfma_f32_16x16x32_bf16 v[120:123], a[24:27], v[212:215], v[120:123]
  v_exp_f32 v175, v175
  v_mfma_f32_16x16x32_bf16 v[124:127], a[28:31], v[212:215], v[124:127]
  v_cvt_pk_bf16_f32 v204, v168, v169
  v_cvt_pk_bf16_f32 v205, v170, v171
  v_mfma_f32_16x16x32_bf16 v[128:131], a[0:3], v[216:219], v[128:131]
  v_cvt_pk_bf16_f32 v206, v172, v173
  v_cvt_pk_bf16_f32 v207, v174, v175
  v_mfma_f32_16x16x32_bf16 v[132:135], a[4:7], v[216:219], v[132:135]
  ds_write_b128 v254, a[40:43] offset:2048
  ds_read_b64_tr_b16 a[0:1], v245 offset:16384
  v_mfma_f32_16x16x32_bf16 v[136:139], a[8:11], v[216:219], v[136:139]
  v_exp_f32 v176, v176
  v_mfma_f32_16x16x32_bf16 v[140:143], a[12:15], v[216:219], v[140:143]
  v_exp_f32 v177, v177
  v_mfma_f32_16x16x32_bf16 v[144:147], a[16:19], v[216:219], v[144:147]
  v_exp_f32 v178, v178
  v_mfma_f32_16x16x32_bf16 v[148:151], a[20:23], v[216:219], v[148:151]
  v_exp_f32 v179, v179
  v_mfma_f32_16x16x32_bf16 v[152:155], a[24:27], v[216:219], v[152:155]
  v_exp_f32 v180, v180
  v_mfma_f32_16x16x32_bf16 v[156:159], a[28:31], v[216:219], v[156:159]
  ds_read_b64_tr_b16 a[2:3], v245 offset:20480
  s_waitcnt lgkmcnt(4)
  v_mfma_f32_16x16x32_bf16 v[160:163], a[104:107], a[160:163], v[220:223]
  ds_write_b128 v254, a[44:47] offset:3072
  ds_read_b64_tr_b16 a[4:5], v246 offset:16384
  v_mfma_f32_16x16x32_bf16 v[164:167], a[120:123], a[160:163], v[220:223]
  v_exp_f32 v181, v181
  v_mfma_f32_16x16x32_bf16 v[160:163], a[108:111], a[164:167], v[160:163]
  v_exp_f32 v182, v182
  v_mfma_f32_16x16x32_bf16 v[164:167], a[124:127], a[164:167], v[164:167]
  v_exp_f32 v183, v183
  v_mfma_f32_16x16x32_bf16 v[160:163], a[112:115], a[168:171], v[160:163]
  v_cvt_pk_bf16_f32 v208, v176, v177
  v_cvt_pk_bf16_f32 v209, v178, v179
  v_mfma_f32_16x16x32_bf16 v[164:167], a[128:131], a[168:171], v[164:167]
  v_cvt_pk_bf16_f32 v210, v180, v181
  v_cvt_pk_bf16_f32 v211, v182, v183
  v_mfma_f32_16x16x32_bf16 v[160:163], a[116:119], a[172:175], v[160:163]
  v_exp_f32 v184, v184
  v_mfma_f32_16x16x32_bf16 v[164:167], a[132:135], a[172:175], v[164:167]
  s_waitcnt vmcnt(19)
  ds_write_b128 v254, a[48:51] offset:16384
  ds_read_b64_tr_b16 a[6:7], v246 offset:20480
  v_mfma_f32_16x16x32_bf16 v[168:171], a[104:107], a[176:179], v[224:227]
  v_exp_f32 v185, v185
  v_mfma_f32_16x16x32_bf16 v[172:175], a[120:123], a[176:179], v[224:227]
  v_exp_f32 v186, v186
  v_mfma_f32_16x16x32_bf16 v[168:171], a[108:111], a[180:183], v[168:171]
  v_exp_f32 v187, v187
  v_mfma_f32_16x16x32_bf16 v[172:175], a[124:127], a[180:183], v[172:175]
  v_exp_f32 v188, v188
  v_mfma_f32_16x16x32_bf16 v[168:171], a[112:115], a[184:187], v[168:171]
  v_exp_f32 v189, v189
  v_mfma_f32_16x16x32_bf16 v[172:175], a[128:131], a[184:187], v[172:175]
  v_exp_f32 v190, v190
  v_mfma_f32_16x16x32_bf16 v[168:171], a[116:119], a[188:191], v[168:171]
  s_waitcnt vmcnt(18)
  ds_write_b128 v254, a[52:55] offset:17408
  ds_read_b64_tr_b16 a[8:9], v245 offset:16640
  v_mfma_f32_16x16x32_bf16 v[172:175], a[132:135], a[188:191], v[172:175]
  v_exp_f32 v191, v191
  v_mfma_f32_16x16x32_bf16 v[176:179], a[104:107], a[192:195], v[228:231]
  v_cvt_pk_bf16_f32 v212, v184, v185
  v_cvt_pk_bf16_f32 v213, v186, v187
  v_mfma_f32_16x16x32_bf16 v[180:183], a[120:123], a[192:195], v[228:231]
  v_cvt_pk_bf16_f32 v214, v188, v189
  v_cvt_pk_bf16_f32 v215, v190, v191
  v_mfma_f32_16x16x32_bf16 v[176:179], a[108:111], a[196:199], v[176:179]
  v_exp_f32 v192, v192
  v_mfma_f32_16x16x32_bf16 v[180:183], a[124:127], a[196:199], v[180:183]
  v_exp_f32 v193, v193
  v_mfma_f32_16x16x32_bf16 v[176:179], a[112:115], a[200:203], v[176:179]
  v_exp_f32 v194, v194
  v_mfma_f32_16x16x32_bf16 v[180:183], a[128:131], a[200:203], v[180:183]
  v_exp_f32 v195, v195
  v_mfma_f32_16x16x32_bf16 v[176:179], a[116:119], a[204:207], v[176:179]
  s_waitcnt vmcnt(17)
  ds_write_b128 v254, a[56:59] offset:18432
  ds_read_b64_tr_b16 a[10:11], v245 offset:20736
  v_mfma_f32_16x16x32_bf16 v[180:183], a[132:135], a[204:207], v[180:183]
  v_exp_f32 v196, v196
  v_mfma_f32_16x16x32_bf16 v[184:187], a[104:107], a[208:211], v[232:235]
  v_exp_f32 v197, v197
  v_mfma_f32_16x16x32_bf16 v[188:191], a[120:123], a[208:211], v[232:235]
  v_exp_f32 v198, v198
  v_mfma_f32_16x16x32_bf16 v[184:187], a[108:111], a[212:215], v[184:187]
  v_exp_f32 v199, v199
  v_mfma_f32_16x16x32_bf16 v[188:191], a[124:127], a[212:215], v[188:191]
  v_cvt_pk_bf16_f32 v216, v192, v193
  v_cvt_pk_bf16_f32 v217, v194, v195
  v_mfma_f32_16x16x32_bf16 v[184:187], a[112:115], a[216:219], v[184:187]
  ds_read_b64_tr_b16 a[12:13], v246 offset:16640
  v_cvt_pk_bf16_f32 v218, v196, v197
  v_mfma_f32_16x16x32_bf16 v[188:191], a[128:131], a[216:219], v[188:191]
  ds_read_b64_tr_b16 a[14:15], v246 offset:20736
  v_cvt_pk_bf16_f32 v219, v198, v199
  v_mfma_f32_16x16x32_bf16 v[184:187], a[116:119], a[220:223], v[184:187]
  ds_read_b64_tr_b16 a[16:17], v245 offset:16896
  s_waitcnt lgkmcnt(11)
  ds_read_b64_tr_b16 a[18:19], v245 offset:20992
  v_mfma_f32_16x16x32_bf16 v[188:191], a[132:135], a[220:223], v[188:191]
  s_waitcnt vmcnt(16)
  ds_write_b128 v254, a[60:63] offset:19456
  ds_read_b64_tr_b16 a[20:21], v246 offset:16896
  v_mfma_f32_16x16x32_bf16 v[192:195], a[104:107], a[224:227], v[236:239]
  ds_read_b64_tr_b16 a[22:23], v246 offset:20992
  s_waitcnt lgkmcnt(11)
  ds_read_b64_tr_b16 a[24:25], v245 offset:17152
  v_mfma_f32_16x16x32_bf16 v[196:199], a[120:123], a[224:227], v[236:239]
  ds_read_b64_tr_b16 a[26:27], v245 offset:21248
  ds_read_b64_tr_b16 a[28:29], v246 offset:17152
  v_mfma_f32_16x16x32_bf16 v[192:195], a[108:111], a[228:231], v[192:195]
  ds_read_b64_tr_b16 a[30:31], v246 offset:21248
  v_mfma_f32_16x16x32_bf16 v[196:199], a[124:127], a[228:231], v[196:199]
  v_mfma_f32_16x16x32_bf16 v[192:195], a[112:115], a[232:235], v[192:195]
  v_mfma_f32_16x16x32_bf16 v[196:199], a[128:131], a[232:235], v[196:199]
  v_mfma_f32_16x16x32_bf16 v[192:195], a[116:119], a[236:239], v[192:195]
  v_mfma_f32_16x16x32_bf16 v[196:199], a[132:135], a[236:239], v[196:199]
  s_waitcnt lgkmcnt(0)
  s_barrier
  v_mfma_f32_16x16x32_bf16 a[136:139], a[156:159], v[200:203], a[136:139]
  v_max_f32 v240, v160, v161
  v_max_f32 v241, v162, v163
  v_mfma_f32_16x16x32_bf16 a[140:143], a[156:159], v[204:207], a[140:143]
  v_max3_f32 v240, v164, v165, v240
  v_max3_f32 v241, v166, v167, v241
  v_mfma_f32_16x16x32_bf16 a[144:147], a[156:159], v[208:211], a[144:147]
  v_max3_f32 v240, v168, v169, v240
  v_max3_f32 v241, v170, v171, v241
  v_mfma_f32_16x16x32_bf16 a[148:151], a[156:159], v[212:215], a[148:151]
  v_max3_f32 v240, v172, v173, v240
  v_max3_f32 v241, v174, v175, v241
  v_mfma_f32_16x16x32_bf16 a[152:155], a[156:159], v[216:219], a[152:155]
  v_max3_f32 v240, v176, v177, v240
  v_max3_f32 v241, v178, v179, v241
  v_mfma_f32_16x16x32_bf16 v[0:3], a[0:3], v[200:203], v[0:3]
  v_max3_f32 v240, v180, v181, v240
  v_max3_f32 v241, v182, v183, v241
  v_mfma_f32_16x16x32_bf16 v[4:7], a[4:7], v[200:203], v[4:7]
  v_max3_f32 v240, v184, v185, v240
  v_max3_f32 v241, v186, v187, v241
  v_mfma_f32_16x16x32_bf16 v[8:11], a[8:11], v[200:203], v[8:11]
  v_max3_f32 v240, v188, v189, v240
  v_max3_f32 v241, v190, v191, v241
  v_mfma_f32_16x16x32_bf16 v[12:15], a[12:15], v[200:203], v[12:15]
  v_max3_f32 v240, v192, v193, v240
  v_max3_f32 v241, v194, v195, v241
  v_mfma_f32_16x16x32_bf16 v[16:19], a[16:19], v[200:203], v[16:19]
  v_max3_f32 v240, v196, v197, v240
  v_max3_f32 v241, v198, v199, v241
  v_mfma_f32_16x16x32_bf16 v[20:23], a[20:23], v[200:203], v[20:23]
  v_max_f32 v240, v240, v241
  v_cmp_lt_f32 vcc, s41, v240
  v_mfma_f32_16x16x32_bf16 v[24:27], a[24:27], v[200:203], v[24:27]
  s_cbranch_vccnz L_stub3
L_ret3:
  v_add_u32 v244, 98304, v247
  v_mfma_f32_16x16x32_bf16 v[28:31], a[28:31], v[200:203], v[28:31]
  v_exp_f32 v160, v160
  v_mfma_f32_16x16x32_bf16 v[32:35], a[0:3], v[204:207], v[32:35]
  v_exp_f32 v161, v161
  v_mfma_f32_16x16x32_bf16 v[36:39], a[4:7], v[204:207], v[36:39]
  v_exp_f32 v162, v162
  v_mfma_f32_16x16x32_bf16 v[40:43], a[8:11], v[204:207], v[40:43]
  v_exp_f32 v163, v163
  v_mfma_f32_16x16x32_bf16 v[44:47], a[12:15], v[204:207], v[44:47]
  v_exp_f32 v164, v164
  v_mfma_f32_16x16x32_bf16 v[48:51], a[16:19], v[204:207], v[48:51]
  v_exp_f32 v165, v165
  v_mfma_f32_16x16x32_bf16 v[52:55], a[20:23], v[204:207], v[52:55]
  v_exp_f32 v166, v166
  v_mfma_f32_16x16x32_bf16 v[56:59], a[24:27], v[204:207], v[56:59]
  ds_read_b128 a[104:107], v244 offset:0
  ds_read_b128 a[120:123], v244 offset:4096
  v_mfma_f32_16x16x32_bf16 v[60:63], a[28:31], v[204:207], v[60:63]
  v_exp_f32 v167, v167
  v_mfma_f32_16x16x32_bf16 v[64:67], a[0:3], v[208:211], v[64:67]
  ds_read_b128 a[108:111], v244 offset:256
  ds_read_b128 a[124:127], v244 offset:4352
  v_mfma_f32_16x16x32_bf16 v[68:71], a[4:7], v[208:211], v[68:71]
  ds_read_b128 a[112:115], v244 offset:512
  v_cvt_pk_bf16_f32 v200, v160, v161
  v_mfma_f32_16x16x32_bf16 v[72:75], a[8:11], v[208:211], v[72:75]
  ds_read_b128 a[128:131], v244 offset:4608
  v_cvt_pk_bf16_f32 v201, v162, v163
  v_mfma_f32_16x16x32_bf16 v[76:79], a[12:15], v[208:211], v[76:79]
  s_waitcnt vmcnt(7)
  ds_write_b128 v254, a[64:67] offset:32768
  v_cvt_pk_bf16_f32 v202, v164, v165
  v_mfma_f32_16x16x32_bf16 v[80:83], a[16:19], v[208:211], v[80:83]
  ds_read_b128 a[116:119], v244 offset:768
  v_cvt_pk_bf16_f32 v203, v166, v167
  v_mfma_f32_16x16x32_bf16 v[84:87], a[20:23], v[208:211], v[84:87]
  ds_read_b128 a[132:135], v244 offset:4864
  v_add_u32 v245, 98304, v248
  v_mfma_f32_16x16x32_bf16 v[88:91], a[24:27], v[208:211], v[88:91]
  v_exp_f32 v168, v168
  v_mfma_f32_16x16x32_bf16 v[92:95], a[28:31], v[208:211], v[92:95]
  v_exp_f32 v169, v169
  v_mfma_f32_16x16x32_bf16 v[96:99], a[0:3], v[212:215], v[96:99]
  v_exp_f32 v170, v170
  v_mfma_f32_16x16x32_bf16 v[100:103], a[4:7], v[212:215], v[100:103]
  v_exp_f32 v171, v171
  v_mfma_f32_16x16x32_bf16 v[104:107], a[8:11], v[212:215], v[104:107]
  s_waitcnt vmcnt(6)
  ds_write_b128 v254, a[68:71] offset:33792
  v_xor_b32 v246, 32, v245
  v_mfma_f32_16x16x32_bf16 v[108:111], a[12:15], v[212:215], v[108:111]
  v_exp_f32 v172, v172
  v_mfma_f32_16x16x32_bf16 v[112:115], a[16:19], v[212:215], v[112:115]
  v_exp_f32 v173, v173
  v_mfma_f32_16x16x32_bf16 v[116:119], a[20:23], v[212:215], v[116:119]
  v_exp_f32 v174, v174
  v_mfma_f32_16x16x32_bf16 v[120:123], a[24:27], v[212:215], v[120:123]
  v_exp_f32 v175, v175
  v_mfma_f32_16x16x32_bf16 v[124:127], a[28:31], v[212:215], v[124:127]
  v_cvt_pk_bf16_f32 v204, v168, v169
  v_cvt_pk_bf16_f32 v205, v170, v171
  v_mfma_f32_16x16x32_bf16 v[128:131], a[0:3], v[216:219], v[128:131]
  v_cvt_pk_bf16_f32 v206, v172, v173
  v_cvt_pk_bf16_f32 v207, v174, v175
  v_mfma_f32_16x16x32_bf16 v[132:135], a[4:7], v[216:219], v[132:135]
  s_waitcnt vmcnt(5)
  ds_write_b128 v254, a[72:75] offset:34816
  ds_read_b64_tr_b16 a[0:1], v245 offset:16384
  v_mfma_f32_16x16x32_bf16 v[136:139], a[8:11], v[216:219], v[136:139]
  v_exp_f32 v176, v176
  v_mfma_f32_16x16x32_bf16 v[140:143], a[12:15], v[216:219], v[140:143]
  v_exp_f32 v177, v177
  v_mfma_f32_16x16x32_bf16 v[144:147], a[16:19], v[216:219], v[144:147]
  v_exp_f32 v178, v178
  v_mfma_f32_16x16x32_bf16 v[148:151], a[20:23], v[216:219], v[148:151]
  v_exp_f32 v179, v179
  v_mfma_f32_16x16x32_bf16 v[152:155], a[24:27], v[216:219], v[152:155]
  v_exp_f32 v180, v180
  v_mfma_f32_16x16x32_bf16 v[156:159], a[28:31], v[216:219], v[156:159]
  ds_read_b64_tr_b16 a[2:3], v245 offset:20480
  s_waitcnt lgkmcnt(4)
  v_mfma_f32_16x16x32_bf16 v[160:163], a[104:107], a[160:163], v[220:223]
  s_waitcnt vmcnt(4)
  ds_write_b128 v254, a[76:79] offset:35840
  ds_read_b64_tr_b16 a[4:5], v246 offset:16384
  v_mfma_f32_16x16x32_bf16 v[164:167], a[120:123], a[160:163], v[220:223]
  v_exp_f32 v181, v181
  v_mfma_f32_16x16x32_bf16 v[160:163], a[108:111], a[164:167], v[160:163]
  v_exp_f32 v182, v182
  v_mfma_f32_16x16x32_bf16 v[164:167], a[124:127], a[164:167], v[164:167]
  v_exp_f32 v183, v183
  v_mfma_f32_16x16x32_bf16 v[160:163], a[112:115], a[168:171], v[160:163]
  v_cvt_pk_bf16_f32 v208, v176, v177
  v_cvt_pk_bf16_f32 v209, v178, v179
  v_mfma_f32_16x16x32_bf16 v[164:167], a[128:131], a[168:171], v[164:167]
  v_cvt_pk_bf16_f32 v210, v180, v181
  v_cvt_pk_bf16_f32 v211, v182, v183
  v_mfma_f32_16x16x32_bf16 v[160:163], a[116:119], a[172:175], v[160:163]
  v_exp_f32 v184, v184
  v_mfma_f32_16x16x32_bf16 v[164:167], a[132:135], a[172:175], v[164:167]
  s_waitcnt vmcnt(3)
  ds_write_b128 v254, a[80:83] offset:49152
  ds_read_b64_tr_b16 a[6:7], v246 offset:20480
  v_mfma_f32_16x16x32_bf16 v[168:171], a[104:107], a[176:179], v[224:227]
  v_exp_f32 v185, v185
  v_mfma_f32_16x16x32_bf16 v[172:175], a[120:123], a[176:179], v[224:227]
  v_exp_f32 v186, v186
  v_mfma_f32_16x16x32_bf16 v[168:171], a[108:111], a[180:183], v[168:171]
  v_exp_f32 v187, v187
  v_mfma_f32_16x16x32_bf16 v[172:175], a[124:127], a[180:183], v[172:175]
  v_exp_f32 v188, v188
  v_mfma_f32_16x16x32_bf16 v[168:171], a[112:115], a[184:187], v[168:171]
  v_exp_f32 v189, v189
  v_mfma_f32_16x16x32_bf16 v[172:175], a[128:131], a[184:187], v[172:175]
  v_exp_f32 v190, v190
  v_mfma_f32_16x16x32_bf16 v[168:171], a[116:119], a[188:191], v[168:171]
  s_waitcnt vmcnt(2)
  ds_write_b128 v254, a[84:87] offset:50176
  ds_read_b64_tr_b16 a[8:9], v245 offset:16640
  v_mfma_f32_16x16x32_bf16 v[172:175], a[132:135], a[188:191], v[172:175]
  v_exp_f32 v191, v191
  v_mfma_f32_16x16x32_bf16 v[176:179], a[104:107], a[192:195], v[228:231]
  v_cvt_pk_bf16_f32 v212, v184, v185
  v_cvt_pk_bf16_f32 v213, v186, v187
  v_mfma_f32_16x16x32_bf16 v[180:183], a[120:123], a[192:195], v[228:231]
  v_cvt_pk_bf16_f32 v214, v188, v189
  v_cvt_pk_bf16_f32 v215, v190, v191
  v_mfma_f32_16x16x32_bf16 v[176:179], a[108:111], a[196:199], v[176:179]
  v_exp_f32 v192, v192
  v_mfma_f32_16x16x32_bf16 v[180:183], a[124:127], a[196:199], v[180:183]
  v_exp_f32 v193, v193
  v_mfma_f32_16x16x32_bf16 v[176:179], a[112:115], a[200:203], v[176:179]
  v_exp_f32 v194, v194
  v_mfma_f32_16x16x32_bf16 v[180:183], a[128:131], a[200:203], v[180:183]
  v_exp_f32 v195, v195
  v_mfma_f32_16x16x32_bf16 v[176:179], a[116:119], a[204:207], v[176:179]
  s_waitcnt vmcnt(1)
  ds_write_b128 v254, a[88:91] offset:51200
  ds_read_b64_tr_b16 a[10:11], v245 offset:20736
  v_mfma_f32_16x16x32_bf16 v[180:183], a[132:135], a[204:207], v[180:183]
  v_exp_f32 v196, v196
  v_mfma_f32_16x16x32_bf16 v[184:187], a[104:107], a[208:211], v[232:235]
  v_exp_f32 v197, v197
  v_mfma_f32_16x16x32_bf16 v[188:191], a[120:123], a[208:211], v[232:235]
  v_exp_f32 v198, v198
  v_mfma_f32_16x16x32_bf16 v[184:187], a[108:111], a[212:215], v[184:187]
  v_exp_f32 v199, v199
  v_mfma_f32_16x16x32_bf16 v[188:191], a[124:127], a[212:215], v[188:191]
  v_cvt_pk_bf16_f32 v216, v192, v193
  v_cvt_pk_bf16_f32 v217, v194, v195
  v_mfma_f32_16x16x32_bf16 v[184:187], a[112:115], a[216:219], v[184:187]
  ds_read_b64_tr_b16 a[12:13], v246 offset:16640
  v_cvt_pk_bf16_f32 v218, v196, v197
  v_mfma_f32_16x16x32_bf16 v[188:191], a[128:131], a[216:219], v[188:191]
  ds_read_b64_tr_b16 a[14:15], v246 offset:20736
  v_cvt_pk_bf16_f32 v219, v198, v199
  v_mfma_f32_16x16x32_bf16 v[184:187], a[116:119], a[220:223], v[184:187]
  ds_read_b64_tr_b16 a[16:17], v245 offset:16896
  s_waitcnt lgkmcnt(11)
  ds_read_b64_tr_b16 a[18:19], v245 offset:20992
  v_mfma_f32_16x16x32_bf16 v[188:191], a[132:135], a[220:223], v[188:191]
  s_waitcnt vmcnt(0)
  ds_write_b128 v254, a[92:95] offset:52224
  ds_read_b64_tr_b16 a[20:21], v246 offset:16896
  v_mfma_f32_16x16x32_bf16 v[192:195], a[104:107], a[224:227], v[236:239]
  ds_read_b64_tr_b16 a[22:23], v246 offset:20992
  s_waitcnt lgkmcnt(11)
  ds_read_b64_tr_b16 a[24:25], v245 offset:17152
  v_mfma_f32_16x16x32_bf16 v[196:199], a[120:123], a[224:227], v[236:239]
  ds_read_b64_tr_b16 a[26:27], v245 offset:21248
  ds_read_b64_tr_b16 a[28:29], v246 offset:17152
  v_mfma_f32_16x16x32_bf16 v[192:195], a[108:111], a[228:231], v[192:195]
  ds_read_b64_tr_b16 a[30:31], v246 offset:21248
  v_mfma_f32_16x16x32_bf16 v[196:199], a[124:127], a[228:231], v[196:199]
  v_mfma_f32_16x16x32_bf16 v[192:195], a[112:115], a[232:235], v[192:195]
  v_mfma_f32_16x16x32_bf16 v[196:199], a[128:131], a[232:235], v[196:199]
  v_mfma_f32_16x16x32_bf16 v[192:195], a[116:119], a[236:239], v[192:195]
  v_mfma_f32_16x16x32_bf16 v[196:199], a[132:135], a[236:239], v[196:199]
  s_mov_b32 s46, 131072
  s_add_u32 s47, s31, 98304
  s_add_u32 s52, s30, 73728
  s_add_u32 s53, s30, 65536
  s_add_u32 s50, s30, 131072
L_loopmark4:
  s_waitcnt vmcnt(24) lgkmcnt(0)
  s_barrier
  v_mfma_f32_16x16x32_bf16 a[136:139], a[156:159], v[200:203], a[136:139]
  v_max_f32 v240, v160, v161
  v_max_f32 v241, v162, v163
  v_mfma_f32_16x16x32_bf16 a[140:143], a[156:159], v[204:207], a[140:143]
  v_max3_f32 v240, v164, v165, v240
  v_max3_f32 v241, v166, v167, v241
  v_mfma_f32_16x16x32_bf16 a[144:147], a[156:159], v[208:211], a[144:147]
  v_max3_f32 v240, v168, v169, v240
  v_max3_f32 v241, v170, v171, v241
  v_mfma_f32_16x16x32_bf16 a[148:151], a[156:159], v[212:215], a[148:151]
  v_max3_f32 v240, v172, v173, v240
  v_max3_f32 v241, v174, v175, v241
  v_mfma_f32_16x16x32_bf16 a[152:155], a[156:159], v[216:219], a[152:155]
  v_max3_f32 v240, v176, v177, v240
  v_max3_f32 v241, v178, v179, v241
  v_mfma_f32_16x16x32_bf16 v[0:3], a[0:3], v[200:203], v[0:3]
  v_max3_f32 v240, v180, v181, v240
  v_max3_f32 v241, v182, v183, v241
  v_mfma_f32_16x16x32_bf16 v[4:7], a[4:7], v[200:203], v[4:7]
  v_max3_f32 v240, v184, v185, v240
  v_max3_f32 v241, v186, v187, v241
  v_mfma_f32_16x16x32_bf16 v[8:11], a[8:11], v[200:203], v[8:11]
  v_max3_f32 v240, v188, v189, v240
  v_max3_f32 v241, v190, v191, v241
  v_mfma_f32_16x16x32_bf16 v[12:15], a[12:15], v[200:203], v[12:15]
  v_max3_f32 v240, v192, v193, v240
  v_max3_f32 v241, v194, v195, v241
  v_mfma_f32_16x16x32_bf16 v[16:19], a[16:19], v[200:203], v[16:19]
  v_max3_f32 v240, v196, v197, v240
  v_max3_f32 v241, v198, v199, v241
  v_mfma_f32_16x16x32_bf16 v[20:23], a[20:23], v[200:203], v[20:23]
  v_max_f32 v240, v240, v241
  v_cmp_lt_f32 vcc, s41, v240
  v_mfma_f32_16x16x32_bf16 v[24:27], a[24:27], v[200:203], v[24:27]
  s_cbranch_vccnz L_stub4
L_ret4:
  v_add_u32 v244, s46, v247
  v_mfma_f32_16x16x32_bf16 v[28:31], a[28:31], v[200:203], v[28:31]
  v_exp_f32 v160, v160
  v_mfma_f32_16x16x32_bf16 v[32:35], a[0:3], v[204:207], v[32:35]
  v_exp_f32 v161, v161
  v_mfma_f32_16x16x32_bf16 v[36:39], a[4:7], v[204:207], v[36:39]
  v_exp_f32 v162, v162
  v_mfma_f32_16x16x32_bf16 v[40:43], a[8:11], v[204:207], v[40:43]
  v_exp_f32 v163, v163
  v_mfma_f32_16x16x32_bf16 v[44:47], a[12:15], v[204:207], v[44:47]
  v_exp_f32 v164, v164
  v_mfma_f32_16x16x32_bf16 v[48:51], a[16:19], v[204:207], v[48:51]
  v_exp_f32 v165, v165
  v_mfma_f32_16x16x32_bf16 v[52:55], a[20:23], v[204:207], v[52:55]
  v_exp_f32 v166, v166
  v_mfma_f32_16x16x32_bf16 v[56:59], a[24:27], v[204:207], v[56:59]
  ds_read_b128 a[104:107], v244 offset:0
  ds_read_b128 a[120:123], v244 offset:4096
  v_mfma_f32_16x16x32_bf16 v[60:63], a[28:31], v[204:207], v[60:63]
  v_exp_f32 v167, v167
  v_mfma_f32_16x16x32_bf16 v[64:67], a[0:3], v[208:211], v[64:67]
  s_add_u32 m0, s47, 0
  ds_read_b128 a[108:111], v244 offset:256
  v_mfma_f32_16x16x32_bf16 v[68:71], a[4:7], v[208:211], v[68:71]
  ds_read_b128 a[124:127], v244 offset:4352
  v_cvt_pk_bf16_f32 v200, v160, v161
  v_mfma_f32_16x16x32_bf16 v[72:75], a[8:11], v[208:211], v[72:75]
  ds_read_b128 a[112:115], v244 offset:512
  v_cvt_pk_bf16_f32 v201, v162, v163
  v_mfma_f32_16x16x32_bf16 v[76:79], a[12:15], v[208:211], v[76:79]
  ds_read_b128 a[128:131], v244 offset:4608
  v_cvt_pk_bf16_f32 v202, v164, v165
  v_mfma_f32_16x16x32_bf16 v[80:83], a[16:19], v[208:211], v[80:83]
  ds_read_b128 a[116:119], v244 offset:768
  v_cvt_pk_bf16_f32 v203, v166, v167
  v_mfma_f32_16x16x32_bf16 v[84:87], a[20:23], v[208:211], v[84:87]
  ds_read_b128 a[132:135], v244 offset:4864
  v_add_u32 v245, s46, v248
  v_mfma_f32_16x16x32_bf16 v[88:91], a[24:27], v[208:211], v[88:91]
  v_exp_f32 v168, v168
  v_mfma_f32_16x16x32_bf16 v[92:95], a[28:31], v[208:211], v[92:95]
  v_exp_f32 v169, v169
  v_mfma_f32_16x16x32_bf16 v[96:99], a[0:3], v[212:215], v[96:99]
  buffer_load_dwordx4 v249, s[12:15], s52 offen offset:0 nt lds
  v_xor_b32 v246, 32, v245
  v_mfma_f32_16x16x32_bf16 v[100:103], a[4:7], v[212:215], v[100:103]
  v_exp_f32 v170, v170
  v_mfma_f32_16x16x32_bf16 v[104:107], a[8:11], v[212:215], v[104:107]
  v_exp_f32 v171, v171
  v_mfma_f32_16x16x32_bf16 v[108:111], a[12:15], v[212:215], v[108:111]
  v_exp_f32 v172, v172
  v_mfma_f32_16x16x32_bf16 v[112:115], a[16:19], v[212:215], v[112:115]
  v_exp_f32 v173, v173
  v_mfma_f32_16x16x32_bf16 v[116:119], a[20:23], v[212:215], v[116:119]
  v_exp_f32 v174, v174
  v_mfma_f32_16x16x32_bf16 v[120:123], a[24:27], v[212:215], v[120:123]
  buffer_load_dwordx4 v250, s[12:15], s52 offen offset:1024 nt lds
  v_mfma_f32_16x16x32_bf16 v[124:127], a[28:31], v[212:215], v[124:127]
  v_exp_f32 v175, v175
  v_mfma_f32_16x16x32_bf16 v[128:131], a[0:3], v[216:219], v[128:131]
  v_cvt_pk_bf16_f32 v204, v168, v169
  v_cvt_pk_bf16_f32 v205, v170, v171
  v_mfma_f32_16x16x32_bf16 v[132:135], a[4:7], v[216:219], v[132:135]
  v_cvt_pk_bf16_f32 v206, v172, v173
  v_cvt_pk_bf16_f32 v207, v174, v175
  v_mfma_f32_16x16x32_bf16 v[136:139], a[8:11], v[216:219], v[136:139]
  v_exp_f32 v176, v176
  v_mfma_f32_16x16x32_bf16 v[140:143], a[12:15], v[216:219], v[140:143]
  v_exp_f32 v177, v177
  v_mfma_f32_16x16x32_bf16 v[144:147], a[16:19], v[216:219], v[144:147]
  buffer_load_dwordx4 v249, s[12:15], s52 offen offset:2048 nt lds
  ds_read_b64_tr_b16 a[0:1], v245 offset:16384
  v_mfma_f32_16x16x32_bf16 v[148:151], a[20:23], v[216:219], v[148:151]
  v_exp_f32 v178, v178
  v_mfma_f32_16x16x32_bf16 v[152:155], a[24:27], v[216:219], v[152:155]
  v_exp_f32 v179, v179
  v_mfma_f32_16x16x32_bf16 v[156:159], a[28:31], v[216:219], v[156:159]
  ds_read_b64_tr_b16 a[2:3], v245 offset:20480
  s_waitcnt lgkmcnt(2)
  v_mfma_f32_16x16x32_bf16 v[160:163], a[104:107], a[160:163], v[220:223]
  v_exp_f32 v180, v180
  v_mfma_f32_16x16x32_bf16 v[164:167], a[120:123], a[160:163], v[220:223]
  buffer_load_dwordx4 v250, s[12:15], s52 offen offset:3072 nt lds
  ds_read_b64_tr_b16 a[4:5], v246 offset:16384
  v_mfma_f32_16x16x32_bf16 v[160:163], a[108:111], a[164:167], v[160:163]
  v_exp_f32 v181, v181
  v_mfma_f32_16x16x32_bf16 v[164:167], a[124:127], a[164:167], v[164:167]
  v_exp_f32 v182, v182
  v_mfma_f32_16x16x32_bf16 v[160:163], a[112:115], a[168:171], v[160:163]
  s_add_u32 m0, s47, 16384
  ds_read_b64_tr_b16 a[6:7], v246 offset:20480
  v_mfma_f32_16x16x32_bf16 v[164:167], a[128:131], a[168:171], v[164:167]
  v_exp_f32 v183, v183
  v_mfma_f32_16x16x32_bf16 v[160:163], a[116:119], a[172:175], v[160:163]
  v_cvt_pk_bf16_f32 v208, v176, v177
  v_cvt_pk_bf16_f32 v209, v178, v179
  v_mfma_f32_16x16x32_bf16 v[164:167], a[132:135], a[172:175], v[164:167]
  v_cvt_pk_bf16_f32 v210, v180, v181
  v_cvt_pk_bf16_f32 v211, v182, v183
  v_mfma_f32_16x16x32_bf16 v[168:171], a[104:107], a[176:179], v[224:227]
  v_exp_f32 v184, v184
  v_mfma_f32_16x16x32_bf16 v[172:175], a[120:123], a[176:179], v[224:227]
  v_exp_f32 v185, v185
  v_mfma_f32_16x16x32_bf16 v[168:171], a[108:111], a[180:183], v[168:171]
  v_exp_f32 v186, v186
  v_mfma_f32_16x16x32_bf16 v[172:175], a[124:127], a[180:183], v[172:175]
  v_exp_f32 v187, v187
  v_mfma_f32_16x16x32_bf16 v[168:171], a[112:115], a[184:187], v[168:171]
  v_exp_f32 v188, v188
  v_mfma_f32_16x16x32_bf16 v[172:175], a[128:131], a[184:187], v[172:175]
  v_exp_f32 v189, v189
  v_mfma_f32_16x16x32_bf16 v[168:171], a[116:119], a[188:191], v[168:171]
  buffer_load_dwordx4 v249, s[16:19], s53 offen offset:0 nt lds
  ds_read_b64_tr_b16 a[8:9], v245 offset:16640
  v_mfma_f32_16x16x32_bf16 v[172:175], a[132:135], a[188:191], v[172:175]
  v_exp_f32 v190, v190
  v_mfma_f32_16x16x32_bf16 v[176:179], a[104:107], a[192:195], v[228:231]
  v_exp_f32 v191, v191
  v_mfma_f32_16x16x32_bf16 v[180:183], a[120:123], a[192:195], v[228:231]
  v_cvt_pk_bf16_f32 v212, v184, v185
  v_cvt_pk_bf16_f32 v213, v186, v187
  v_mfma_f32_16x16x32_bf16 v[176:179], a[108:111], a[196:199], v[176:179]
  v_cvt_pk_bf16_f32 v214, v188, v189
  v_cvt_pk_bf16_f32 v215, v190, v191
  v_mfma_f32_16x16x32_bf16 v[180:183], a[124:127], a[196:199], v[180:183]
  v_exp_f32 v192, v192
  v_mfma_f32_16x16x32_bf16 v[176:179], a[112:115], a[200:203], v[176:179]
  buffer_load_dwordx4 v250, s[16:19], s53 offen offset:1024 nt lds
  ds_read_b64_tr_b16 a[10:11], v245 offset:20736
  v_mfma_f32_16x16x32_bf16 v[180:183], a[128:131], a[200:203], v[180:183]
  v_exp_f32 v193, v193
  v_mfma_f32_16x16x32_bf16 v[176:179], a[116:119], a[204:207], v[176:179]
  v_exp_f32 v194, v194
  v_mfma_f32_16x16x32_bf16 v[180:183], a[132:135], a[204:207], v[180:183]
  v_exp_f32 v195, v195
  v_mfma_f32_16x16x32_bf16 v[184:187], a[104:107], a[208:211], v[232:235]
  v_exp_f32 v196, v196
  v_mfma_f32_16x16x32_bf16 v[188:191], a[120:123], a[208:211], v[232:235]
  v_exp_f32 v197, v197
  v_mfma_f32_16x16x32_bf16 v[184:187], a[108:111], a[212:215], v[184:187]
  v_exp_f32 v198, v198
  v_mfma_f32_16x16x32_bf16 v[188:191], a[124:127], a[212:215], v[188:191]
  buffer_load_dwordx4 v249, s[16:19], s53 offen offset:2048 nt lds
  ds_read_b64_tr_b16 a[12:13], v246 offset:16640
  v_mfma_f32_16x16x32_bf16 v[184:187], a[112:115], a[216:219], v[184:187]
  v_exp_f32 v199, v199
  v_mfma_f32_16x16x32_bf16 v[188:191], a[128:131], a[216:219], v[188:191]
  v_cvt_pk_bf16_f32 v216, v192, v193
  v_cvt_pk_bf16_f32 v217, v194, v195
  v_mfma_f32_16x16x32_bf16 v[184:187], a[116:119], a[220:223], v[184:187]
  v_cvt_pk_bf16_f32 v218, v196, v197
  v_cvt_pk_bf16_f32 v219, v198, v199
  v_mfma_f32_16x16x32_bf16 v[188:191], a[132:135], a[220:223], v[188:191]
  ds_read_b64_tr_b16 a[14:15], v246 offset:20736
  ds_read_b64_tr_b16 a[16:17], v245 offset:16896
  v_mfma_f32_16x16x32_bf16 v[192:195], a[104:107], a[224:227], v[236:239]
  ds_read_b64_tr_b16 a[18:19], v245 offset:20992
  ds_read_b64_tr_b16 a[20:21], v246 offset:16896
  v_mfma_f32_16x16x32_bf16 v[196:199], a[120:123], a[224:227], v[236:239]
  ds_read_b64_tr_b16 a[22:23], v246 offset:20992
  ds_read_b64_tr_b16 a[24:25], v245 offset:17152
  v_mfma_f32_16x16x32_bf16 v[192:195], a[108:111], a[228:231], v[192:195]
  ds_read_b64_tr_b16 a[26:27], v245 offset:21248
  buffer_load_dwordx4 v250, s[16:19], s53 offen offset:3072 nt lds
  v_mfma_f32_16x16x32_bf16 v[196:199], a[124:127], a[228:231], v[196:199]
  ds_read_b64_tr_b16 a[28:29], v246 offset:17152
  s_waitcnt lgkmcnt(11)
  ds_read_b64_tr_b16 a[30:31], v246 offset:21248
  v_mfma_f32_16x16x32_bf16 v[192:195], a[112:115], a[232:235], v[192:195]
  s_add_u32 s47, s46, s31
  s_add_u32 s46, s46, 32768
  v_mfma_f32_16x16x32_bf16 v[196:199], a[128:131], a[232:235], v[196:199]
  s_cmp_eq_u32 s46, 163840
  s_cselect_b32 s46, 0, s46
  v_mfma_f32_16x16x32_bf16 v[192:195], a[116:119], a[236:239], v[192:195]
  s_mov_b32 s53, s52
  s_add_u32 s52, s52, 8192
  v_mfma_f32_16x16x32_bf16 v[196:199], a[132:135], a[236:239], v[196:199]
  s_cmp_lg_u32 s50, s52
  s_cbranch_scc1 L_loopmark4
  s_waitcnt vmcnt(24) lgkmcnt(0)
  s_barrier
  v_mfma_f32_16x16x32_bf16 a[136:139], a[156:159], v[200:203], a[136:139]
  v_max_f32 v240, v160, v161
  v_max_f32 v241, v162, v163
  v_mfma_f32_16x16x32_bf16 a[140:143], a[156:159], v[204:207], a[140:143]
  v_max3_f32 v240, v164, v165, v240
  v_max3_f32 v241, v166, v167, v241
  v_mfma_f32_16x16x32_bf16 a[144:147], a[156:159], v[208:211], a[144:147]
  v_max3_f32 v240, v168, v169, v240
  v_max3_f32 v241, v170, v171, v241
  v_mfma_f32_16x16x32_bf16 a[148:151], a[156:159], v[212:215], a[148:151]
  v_max3_f32 v240, v172, v173, v240
  v_max3_f32 v241, v174, v175, v241
  v_mfma_f32_16x16x32_bf16 a[152:155], a[156:159], v[216:219], a[152:155]
  v_max3_f32 v240, v176, v177, v240
  v_max3_f32 v241, v178, v179, v241
  v_mfma_f32_16x16x32_bf16 v[0:3], a[0:3], v[200:203], v[0:3]
  v_max3_f32 v240, v180, v181, v240
  v_max3_f32 v241, v182, v183, v241
  v_mfma_f32_16x16x32_bf16 v[4:7], a[4:7], v[200:203], v[4:7]
  v_max3_f32 v240, v184, v185, v240
  v_max3_f32 v241, v186, v187, v241
  v_mfma_f32_16x16x32_bf16 v[8:11], a[8:11], v[200:203], v[8:11]
  v_max3_f32 v240, v188, v189, v240
  v_max3_f32 v241, v190, v191, v241
  v_mfma_f32_16x16x32_bf16 v[12:15], a[12:15], v[200:203], v[12:15]
  v_max3_f32 v240, v192, v193, v240
  v_max3_f32 v241, v194, v195, v241
  v_mfma_f32_16x16x32_bf16 v[16:19], a[16:19], v[200:203], v[16:19]
  v_max3_f32 v240, v196, v197, v240
  v_max3_f32 v241, v198, v199, v241
  v_mfma_f32_16x16x32_bf16 v[20:23], a[20:23], v[200:203], v[20:23]
  v_max_f32 v240, v240, v241
  v_cmp_lt_f32 vcc, s41, v240
  v_mfma_f32_16x16x32_bf16 v[24:27], a[24:27], v[200:203], v[24:27]
  s_cbranch_vccnz L_stub11
L_ret11:
  v_add_u32 v244, 32768, v247
  v_mfma_f32_16x16x32_bf16 v[28:31], a[28:31], v[200:203], v[28:31]
  v_exp_f32 v160, v160
  v_mfma_f32_16x16x32_bf16 v[32:35], a[0:3], v[204:207], v[32:35]
  v_exp_f32 v161, v161
  v_mfma_f32_16x16x32_bf16 v[36:39], a[4:7], v[204:207], v[36:39]
  v_exp_f32 v162, v162
  v_mfma_f32_16x16x32_bf16 v[40:43], a[8:11], v[204:207], v[40:43]
  v_exp_f32 v163, v163
  v_mfma_f32_16x16x32_bf16 v[44:47], a[12:15], v[204:207], v[44:47]
  v_exp_f32 v164, v164
  v_mfma_f32_16x16x32_bf16 v[48:51], a[16:19], v[204:207], v[48:51]
  v_exp_f32 v165, v165
  v_mfma_f32_16x16x32_bf16 v[52:55], a[20:23], v[204:207], v[52:55]
  v_exp_f32 v166, v166
  v_mfma_f32_16x16x32_bf16 v[56:59], a[24:27], v[204:207], v[56:59]
  ds_read_b128 a[104:107], v244 offset:0
  ds_read_b128 a[120:123], v244 offset:4096
  v_mfma_f32_16x16x32_bf16 v[60:63], a[28:31], v[204:207], v[60:63]
  v_exp_f32 v167, v167
  v_mfma_f32_16x16x32_bf16 v[64:67], a[0:3], v[208:211], v[64:67]
  s_add_u32 m0, s31, 16384
  s_add_u32 s44, s30, 122880
  v_mfma_f32_16x16x32_bf16 v[68:71], a[4:7], v[208:211], v[68:71]
  ds_read_b128 a[108:111], v244 offset:256
  ds_read_b128 a[124:127], v244 offset:4352
  v_mfma_f32_16x16x32_bf16 v[72:75], a[8:11], v[208:211], v[72:75]
  ds_read_b128 a[112:115], v244 offset:512
  v_cvt_pk_bf16_f32 v200, v160, v161
  v_mfma_f32_16x16x32_bf16 v[76:79], a[12:15], v[208:211], v[76:79]
  buffer_load_dwordx4 v249, s[16:19], s44 offen offset:0 nt lds
  v_cvt_pk_bf16_f32 v201, v162, v163
  v_mfma_f32_16x16x32_bf16 v[80:83], a[16:19], v[208:211], v[80:83]
  ds_read_b128 a[128:131], v244 offset:4608
  v_cvt_pk_bf16_f32 v202, v164, v165
  v_mfma_f32_16x16x32_bf16 v[84:87], a[20:23], v[208:211], v[84:87]
  ds_read_b128 a[116:119], v244 offset:768
  v_cvt_pk_bf16_f32 v203, v166, v167
  v_mfma_f32_16x16x32_bf16 v[88:91], a[24:27], v[208:211], v[88:91]
  ds_read_b128 a[132:135], v244 offset:4864
  v_add_u32 v245, 32768, v248
  v_mfma_f32_16x16x32_bf16 v[92:95], a[28:31], v[208:211], v[92:95]
  v_exp_f32 v168, v168
  v_mfma_f32_16x16x32_bf16 v[96:99], a[0:3], v[212:215], v[96:99]
  v_exp_f32 v169, v169
  v_mfma_f32_16x16x32_bf16 v[100:103], a[4:7], v[212:215], v[100:103]
  v_exp_f32 v170, v170
  v_mfma_f32_16x16x32_bf16 v[104:107], a[8:11], v[212:215], v[104:107]
  v_exp_f32 v171, v171
  v_mfma_f32_16x16x32_bf16 v[108:111], a[12:15], v[212:215], v[108:111]
  v_exp_f32 v172, v172
  v_mfma_f32_16x16x32_bf16 v[112:115], a[16:19], v[212:215], v[112:115]
  v_exp_f32 v173, v173
  v_mfma_f32_16x16x32_bf16 v[116:119], a[20:23], v[212:215], v[116:119]
  v_exp_f32 v174, v174
  v_mfma_f32_16x16x32_bf16 v[120:123], a[24:27], v[212:215], v[120:123]
  v_exp_f32 v175, v175
  v_mfma_f32_16x16x32_bf16 v[124:127], a[28:31], v[212:215], v[124:127]
  v_cvt_pk_bf16_f32 v204, v168, v169
  v_cvt_pk_bf16_f32 v205, v170, v171
  v_mfma_f32_16x16x32_bf16 v[128:131], a[0:3], v[216:219], v[128:131]
  v_cvt_pk_bf16_f32 v206, v172, v173
  v_cvt_pk_bf16_f32 v207, v174, v175
  v_mfma_f32_16x16x32_bf16 v[132:135], a[4:7], v[216:219], v[132:135]
  buffer_load_dwordx4 v250, s[16:19], s44 offen offset:1024 nt lds
  v_xor_b32 v246, 32, v245
  v_mfma_f32_16x16x32_bf16 v[136:139], a[8:11], v[216:219], v[136:139]
  v_exp_f32 v176, v176
  v_mfma_f32_16x16x32_bf16 v[140:143], a[12:15], v[216:219], v[140:143]
  v_exp_f32 v177, v177
  v_mfma_f32_16x16x32_bf16 v[144:147], a[16:19], v[216:219], v[144:147]
  v_exp_f32 v178, v178
  v_mfma_f32_16x16x32_bf16 v[148:151], a[20:23], v[216:219], v[148:151]
  v_exp_f32 v179, v179
  v_mfma_f32_16x16x32_bf16 v[152:155], a[24:27], v[216:219], v[152:155]
  v_exp_f32 v180, v180
  v_mfma_f32_16x16x32_bf16 v[156:159], a[28:31], v[216:219], v[156:159]
  ds_read_b64_tr_b16 a[0:1], v245 offset:16384
  s_waitcnt lgkmcnt(1)
  v_mfma_f32_16x16x32_bf16 v[160:163], a[104:107], a[160:163], v[220:223]
  v_exp_f32 v181, v181
  v_mfma_f32_16x16x32_bf16 v[164:167], a[120:123], a[160:163], v[220:223]
  v_exp_f32 v182, v182
  v_mfma_f32_16x16x32_bf16 v[160:163], a[108:111], a[164:167], v[160:163]
  v_exp_f32 v183, v183
  v_mfma_f32_16x16x32_bf16 v[164:167], a[124:127], a[164:167], v[164:167]
  v_cvt_pk_bf16_f32 v208, v176, v177
  v_cvt_pk_bf16_f32 v209, v178, v179
  v_mfma_f32_16x16x32_bf16 v[160:163], a[112:115], a[168:171], v[160:163]
  v_cvt_pk_bf16_f32 v210, v180, v181
  v_cvt_pk_bf16_f32 v211, v182, v183
  v_mfma_f32_16x16x32_bf16 v[164:167], a[128:131], a[168:171], v[164:167]
  v_exp_f32 v184, v184
  v_mfma_f32_16x16x32_bf16 v[160:163], a[116:119], a[172:175], v[160:163]
  v_exp_f32 v185, v185
  v_mfma_f32_16x16x32_bf16 v[164:167], a[132:135], a[172:175], v[164:167]
  buffer_load_dwordx4 v249, s[16:19], s44 offen offset:2048 nt lds
  ds_read_b64_tr_b16 a[2:3], v245 offset:20480
  v_mfma_f32_16x16x32_bf16 v[168:171], a[104:107], a[176:179], v[224:227]
  v_exp_f32 v186, v186
  v_mfma_f32_16x16x32_bf16 v[172:175], a[120:123], a[176:179], v[224:227]
  v_exp_f32 v187, v187
  v_mfma_f32_16x16x32_bf16 v[168:171], a[108:111], a[180:183], v[168:171]
  v_exp_f32 v188, v188
  v_mfma_f32_16x16x32_bf16 v[172:175], a[124:127], a[180:183], v[172:175]
  v_exp_f32 v189, v189
  v_mfma_f32_16x16x32_bf16 v[168:171], a[112:115], a[184:187], v[168:171]
  v_exp_f32 v190, v190
  v_mfma_f32_16x16x32_bf16 v[172:175], a[128:131], a[184:187], v[172:175]
  v_exp_f32 v191, v191
  v_mfma_f32_16x16x32_bf16 v[168:171], a[116:119], a[188:191], v[168:171]
  v_cvt_pk_bf16_f32 v212, v184, v185
  v_cvt_pk_bf16_f32 v213, v186, v187
  v_mfma_f32_16x16x32_bf16 v[172:175], a[132:135], a[188:191], v[172:175]
  v_cvt_pk_bf16_f32 v214, v188, v189
  v_cvt_pk_bf16_f32 v215, v190, v191
  v_mfma_f32_16x16x32_bf16 v[176:179], a[104:107], a[192:195], v[228:231]
  v_exp_f32 v192, v192
  v_mfma_f32_16x16x32_bf16 v[180:183], a[120:123], a[192:195], v[228:231]
  v_exp_f32 v193, v193
  v_mfma_f32_16x16x32_bf16 v[176:179], a[108:111], a[196:199], v[176:179]
  v_exp_f32 v194, v194
  v_mfma_f32_16x16x32_bf16 v[180:183], a[124:127], a[196:199], v[180:183]
  v_exp_f32 v195, v195
  v_mfma_f32_16x16x32_bf16 v[176:179], a[112:115], a[200:203], v[176:179]
  v_exp_f32 v196, v196
  v_mfma_f32_16x16x32_bf16 v[180:183], a[128:131], a[200:203], v[180:183]
  buffer_load_dwordx4 v250, s[16:19], s44 offen offset:3072 nt lds
  ds_read_b64_tr_b16 a[4:5], v246 offset:16384
  v_mfma_f32_16x16x32_bf16 v[176:179], a[116:119], a[204:207], v[176:179]
  v_exp_f32 v197, v197
  v_mfma_f32_16x16x32_bf16 v[180:183], a[132:135], a[204:207], v[180:183]
  v_exp_f32 v198, v198
  v_mfma_f32_16x16x32_bf16 v[184:187], a[104:107], a[208:211], v[232:235]
  v_exp_f32 v199, v199
  v_mfma_f32_16x16x32_bf16 v[188:191], a[120:123], a[208:211], v[232:235]
  ds_read_b64_tr_b16 a[6:7], v246 offset:20480
  v_cvt_pk_bf16_f32 v216, v192, v193
  v_mfma_f32_16x16x32_bf16 v[184:187], a[108:111], a[212:215], v[184:187]
  ds_read_b64_tr_b16 a[8:9], v245 offset:16640
  v_cvt_pk_bf16_f32 v217, v194, v195
  v_mfma_f32_16x16x32_bf16 v[188:191], a[124:127], a[212:215], v[188:191]
  ds_read_b64_tr_b16 a[10:11], v245 offset:20736
  v_cvt_pk_bf16_f32 v218, v196, v197
  v_mfma_f32_16x16x32_bf16 v[184:187], a[112:115], a[216:219], v[184:187]
  ds_read_b64_tr_b16 a[12:13], v246 offset:16640
  v_cvt_pk_bf16_f32 v219, v198, v199
  v_mfma_f32_16x16x32_bf16 v[188:191], a[128:131], a[216:219], v[188:191]
  ds_read_b64_tr_b16 a[14:15], v246 offset:20736
  ds_read_b64_tr_b16 a[16:17], v245 offset:16896
  v_mfma_f32_16x16x32_bf16 v[184:187], a[116:119], a[220:223], v[184:187]
  ds_read_b64_tr_b16 a[18:19], v245 offset:20992
  ds_read_b64_tr_b16 a[20:21], v246 offset:16896
  v_mfma_f32_16x16x32_bf16 v[188:191], a[132:135], a[220:223], v[188:191]
  ds_read_b64_tr_b16 a[22:23], v246 offset:20992
  ds_read_b64_tr_b16 a[24:25], v245 offset:17152
  v_mfma_f32_16x16x32_bf16 v[192:195], a[104:107], a[224:227], v[236:239]
  v_lshrrev_b32 v242, 1, v251
  v_and_b32 v243, 1, v251
  v_mfma_f32_16x16x32_bf16 v[196:199], a[120:123], a[224:227], v[236:239]
  ds_read_b64_tr_b16 a[26:27], v245 offset:21248
  ds_read_b64_tr_b16 a[28:29], v246 offset:17152
  v_mfma_f32_16x16x32_bf16 v[192:195], a[108:111], a[228:231], v[192:195]
  v_lshlrev_b32 v242, 10, v242
  v_lshl_add_u32 v242, v243, 7, v242
  v_mfma_f32_16x16x32_bf16 v[196:199], a[124:127], a[228:231], v[196:199]
  s_waitcnt lgkmcnt(11)
  ds_read_b64_tr_b16 a[30:31], v246 offset:21248
  v_mfma_f32_16x16x32_bf16 v[192:195], a[112:115], a[232:235], v[192:195]
  s_lshl_b32 s45, s39, 20
  s_lshl_b32 s43, s48, 17
  v_mfma_f32_16x16x32_bf16 v[196:199], a[128:131], a[232:235], v[196:199]
  s_add_u32 s45, s45, s43
  s_lshl_b32 s43, s3, 15
  v_mfma_f32_16x16x32_bf16 v[192:195], a[116:119], a[236:239], v[192:195]
  s_add_u32 s45, s45, s43
  s_lshl_b32 s43, s49, 8
  v_mfma_f32_16x16x32_bf16 v[196:199], a[132:135], a[236:239], v[196:199]
  s_add_u32 s45, s45, s43
  buffer_load_dword a240, v242, s[20:23], s45 offen
  s_waitcnt vmcnt(21) lgkmcnt(0)
  s_barrier
  v_mfma_f32_16x16x32_bf16 a[136:139], a[156:159], v[200:203], a[136:139]
  v_max_f32 v240, v160, v161
  v_max_f32 v241, v162, v163
  v_mfma_f32_16x16x32_bf16 a[140:143], a[156:159], v[204:207], a[140:143]
  v_max3_f32 v240, v164, v165, v240
  v_max3_f32 v241, v166, v167, v241
  v_mfma_f32_16x16x32_bf16 a[144:147], a[156:159], v[208:211], a[144:147]
  v_max3_f32 v240, v168, v169, v240
  v_max3_f32 v241, v170, v171, v241
  v_mfma_f32_16x16x32_bf16 a[148:151], a[156:159], v[212:215], a[148:151]
  v_max3_f32 v240, v172, v173, v240
  v_max3_f32 v241, v174, v175, v241
  v_mfma_f32_16x16x32_bf16 a[152:155], a[156:159], v[216:219], a[152:155]
  v_max3_f32 v240, v176, v177, v240
  v_max3_f32 v241, v178, v179, v241
  v_mfma_f32_16x16x32_bf16 v[0:3], a[0:3], v[200:203], v[0:3]
  v_max3_f32 v240, v180, v181, v240
  v_max3_f32 v241, v182, v183, v241
  v_mfma_f32_16x16x32_bf16 v[4:7], a[4:7], v[200:203], v[4:7]
  v_max3_f32 v240, v184, v185, v240
  v_max3_f32 v241, v186, v187, v241
  v_mfma_f32_16x16x32_bf16 v[8:11], a[8:11], v[200:203], v[8:11]
  v_max3_f32 v240, v188, v189, v240
  v_max3_f32 v241, v190, v191, v241
  v_mfma_f32_16x16x32_bf16 v[12:15], a[12:15], v[200:203], v[12:15]
  v_max3_f32 v240, v192, v193, v240
  v_max3_f32 v241, v194, v195, v241
  v_mfma_f32_16x16x32_bf16 v[16:19], a[16:19], v[200:203], v[16:19]
  v_max3_f32 v240, v196, v197, v240
  v_max3_f32 v241, v198, v199, v241
  v_mfma_f32_16x16x32_bf16 v[20:23], a[20:23], v[200:203], v[20:23]
  v_max_f32 v240, v240, v241
  v_cmp_lt_f32 vcc, s41, v240
  v_mfma_f32_16x16x32_bf16 v[24:27], a[24:27], v[200:203], v[24:27]
  s_cbranch_vccnz L_stub12
L_ret12:
  v_mov_b32 v249, v252
  v_mfma_f32_16x16x32_bf16 v[28:31], a[28:31], v[200:203], v[28:31]
  v_xor_b32 v250, 32, v252
  s_add_u32 m0, s96, 32768
  v_mfma_f32_16x16x32_bf16 v[32:35], a[0:3], v[204:207], v[32:35]
  s_add_u32 s42, s68, 0
  buffer_load_dwordx4 v249, s[20:23], s42 offen offset:0 lds
  v_mfma_f32_16x16x32_bf16 v[36:39], a[4:7], v[204:207], v[36:39]
  v_exp_f32 v160, v160
  v_mfma_f32_16x16x32_bf16 v[40:43], a[8:11], v[204:207], v[40:43]
  v_exp_f32 v161, v161
  v_mfma_f32_16x16x32_bf16 v[44:47], a[12:15], v[204:207], v[44:47]
  v_exp_f32 v162, v162
  v_mfma_f32_16x16x32_bf16 v[48:51], a[16:19], v[204:207], v[48:51]
  v_exp_f32 v163, v163
  v_mfma_f32_16x16x32_bf16 v[52:55], a[20:23], v[204:207], v[52:55]
  s_add_u32 s42, s68, 3072
  v_add_u32 v244, 65536, v247
  v_mfma_f32_16x16x32_bf16 v[56:59], a[24:27], v[204:207], v[56:59]
  v_exp_f32 v164, v164
  v_mfma_f32_16x16x32_bf16 v[60:63], a[28:31], v[204:207], v[60:63]
  v_exp_f32 v165, v165
  v_mfma_f32_16x16x32_bf16 v[64:67], a[0:3], v[208:211], v[64:67]
  buffer_load_dwordx4 v250, s[20:23], s42 offen offset:1024 lds
  ds_read_b128 a[104:107], v244 offset:0
  v_mfma_f32_16x16x32_bf16 v[68:71], a[4:7], v[208:211], v[68:71]
  v_exp_f32 v166, v166
  v_mfma_f32_16x16x32_bf16 v[72:75], a[8:11], v[208:211], v[72:75]
  ds_read_b128 a[120:123], v244 offset:4096
  ds_read_b128 a[108:111], v244 offset:256
  v_mfma_f32_16x16x32_bf16 v[76:79], a[12:15], v[208:211], v[76:79]
  v_exp_f32 v167, v167
  v_mfma_f32_16x16x32_bf16 v[80:83], a[16:19], v[208:211], v[80:83]
  ds_read_b128 a[124:127], v244 offset:4352
  v_cvt_pk_bf16_f32 v200, v160, v161
  v_mfma_f32_16x16x32_bf16 v[84:87], a[20:23], v[208:211], v[84:87]
  ds_read_b128 a[112:115], v244 offset:512
  v_cvt_pk_bf16_f32 v201, v162, v163
  v_mfma_f32_16x16x32_bf16 v[88:91], a[24:27], v[208:211], v[88:91]
  s_add_u32 s42, s68, 6144
  ds_read_b128 a[128:131], v244 offset:4608
  v_mfma_f32_16x16x32_bf16 v[92:95], a[28:31], v[208:211], v[92:95]
  ds_read_b128 a[116:119], v244 offset:768
  v_cvt_pk_bf16_f32 v202, v164, v165
  v_mfma_f32_16x16x32_bf16 v[96:99], a[0:3], v[212:215], v[96:99]
  ds_read_b128 a[132:135], v244 offset:4864
  v_cvt_pk_bf16_f32 v203, v166, v167
  v_mfma_f32_16x16x32_bf16 v[100:103], a[4:7], v[212:215], v[100:103]
  buffer_load_dwordx4 v249, s[20:23], s42 offen offset:2048 lds
  v_add_u32 v245, 65536, v248
  v_mfma_f32_16x16x32_bf16 v[104:107], a[8:11], v[212:215], v[104:107]
  v_exp_f32 v168, v168
  v_mfma_f32_16x16x32_bf16 v[108:111], a[12:15], v[212:215], v[108:111]
  v_exp_f32 v169, v169
  v_mfma_f32_16x16x32_bf16 v[112:115], a[16:19], v[212:215], v[112:115]
  v_exp_f32 v170, v170
  v_mfma_f32_16x16x32_bf16 v[116:119], a[20:23], v[212:215], v[116:119]
  v_exp_f32 v171, v171
  v_mfma_f32_16x16x32_bf16 v[120:123], a[24:27], v[212:215], v[120:123]
  s_add_u32 s42, s68, 9216
  v_xor_b32 v246, 32, v245
  v_mfma_f32_16x16x32_bf16 v[124:127], a[28:31], v[212:215], v[124:127]
  v_exp_f32 v172, v172
  v_mfma_f32_16x16x32_bf16 v[128:131], a[0:3], v[216:219], v[128:131]
  v_exp_f32 v173, v173
  v_mfma_f32_16x16x32_bf16 v[132:135], a[4:7], v[216:219], v[132:135]
  buffer_load_dwordx4 v250, s[20:23], s42 offen offset:3072 lds
  ds_read_b64_tr_b16 a[0:1], v245 offset:16384
  v_mfma_f32_16x16x32_bf16 v[136:139], a[8:11], v[216:219], v[136:139]
  v_exp_f32 v174, v174
  v_mfma_f32_16x16x32_bf16 v[140:143], a[12:15], v[216:219], v[140:143]
  v_exp_f32 v175, v175
  v_mfma_f32_16x16x32_bf16 v[144:147], a[16:19], v[216:219], v[144:147]
  v_cvt_pk_bf16_f32 v204, v168, v169
  v_cvt_pk_bf16_f32 v205, v170, v171
  v_mfma_f32_16x16x32_bf16 v[148:151], a[20:23], v[216:219], v[148:151]
  v_cvt_pk_bf16_f32 v206, v172, v173
  v_cvt_pk_bf16_f32 v207, v174, v175
  v_mfma_f32_16x16x32_bf16 v[152:155], a[24:27], v[216:219], v[152:155]
  v_exp_f32 v176, v176
  v_mfma_f32_16x16x32_bf16 v[156:159], a[28:31], v[216:219], v[156:159]
  s_add_u32 m0, s96, 49152
  s_waitcnt lgkmcnt(1)
  v_mfma_f32_16x16x32_bf16 v[160:163], a[104:107], a[160:163], v[220:223]
  s_add_u32 s42, s68, 65536
  ds_read_b64_tr_b16 a[2:3], v245 offset:20480
  v_mfma_f32_16x16x32_bf16 v[164:167], a[120:123], a[160:163], v[220:223]
  v_exp_f32 v177, v177
  v_mfma_f32_16x16x32_bf16 v[160:163], a[108:111], a[164:167], v[160:163]
  v_exp_f32 v178, v178
  v_mfma_f32_16x16x32_bf16 v[164:167], a[124:127], a[164:167], v[164:167]
  v_exp_f32 v179, v179
  v_mfma_f32_16x16x32_bf16 v[160:163], a[112:115], a[168:171], v[160:163]
  v_exp_f32 v180, v180
  v_mfma_f32_16x16x32_bf16 v[164:167], a[128:131], a[168:171], v[164:167]
  buffer_load_dwordx4 v249, s[20:23], s42 offen offset:0 lds
  ds_read_b64_tr_b16 a[4:5], v246 offset:16384
  v_mfma_f32_16x16x32_bf16 v[160:163], a[116:119], a[172:175], v[160:163]
  v_exp_f32 v181, v181
  v_mfma_f32_16x16x32_bf16 v[164:167], a[132:135], a[172:175], v[164:167]
  v_exp_f32 v182, v182
  v_mfma_f32_16x16x32_bf16 v[168:171], a[104:107], a[176:179], v[224:227]
  v_exp_f32 v183, v183
  v_mfma_f32_16x16x32_bf16 v[172:175], a[120:123], a[176:179], v[224:227]
  v_cvt_pk_bf16_f32 v208, v176, v177
  v_cvt_pk_bf16_f32 v209, v178, v179
  v_mfma_f32_16x16x32_bf16 v[168:171], a[108:111], a[180:183], v[168:171]
  s_add_u32 s42, s68, 68608
  v_cvt_pk_bf16_f32 v210, v180, v181
  v_mfma_f32_16x16x32_bf16 v[172:175], a[124:127], a[180:183], v[172:175]
  buffer_load_dwordx4 v250, s[20:23], s42 offen offset:1024 lds
  v_cvt_pk_bf16_f32 v211, v182, v183
  v_mfma_f32_16x16x32_bf16 v[168:171], a[112:115], a[184:187], v[168:171]
  v_exp_f32 v184, v184
  v_mfma_f32_16x16x32_bf16 v[172:175], a[128:131], a[184:187], v[172:175]
  v_exp_f32 v185, v185
  v_mfma_f32_16x16x32_bf16 v[168:171], a[116:119], a[188:191], v[168:171]
  v_exp_f32 v186, v186
  v_mfma_f32_16x16x32_bf16 v[172:175], a[132:135], a[188:191], v[172:175]
  v_exp_f32 v187, v187
  v_mfma_f32_16x16x32_bf16 v[176:179], a[104:107], a[192:195], v[228:231]
  v_exp_f32 v188, v188
  v_mfma_f32_16x16x32_bf16 v[180:183], a[120:123], a[192:195], v[228:231]
  v_exp_f32 v189, v189
  v_mfma_f32_16x16x32_bf16 v[176:179], a[108:111], a[196:199], v[176:179]
  v_exp_f32 v190, v190
  v_mfma_f32_16x16x32_bf16 v[180:183], a[124:127], a[196:199], v[180:183]
  v_exp_f32 v191, v191
  s_add_u32 s42, s68, 71680
  v_mfma_f32_16x16x32_bf16 v[176:179], a[112:115], a[200:203], v[176:179]
  v_cvt_pk_bf16_f32 v212, v184, v185
  v_cvt_pk_bf16_f32 v213, v186, v187
  v_mfma_f32_16x16x32_bf16 v[180:183], a[128:131], a[200:203], v[180:183]
  v_cvt_pk_bf16_f32 v214, v188, v189
  v_cvt_pk_bf16_f32 v215, v190, v191
  v_mfma_f32_16x16x32_bf16 v[176:179], a[116:119], a[204:207], v[176:179]
  v_exp_f32 v192, v192
  v_mfma_f32_16x16x32_bf16 v[180:183], a[132:135], a[204:207], v[180:183]
  buffer_load_dwordx4 v249, s[20:23], s42 offen offset:2048 lds
  v_exp_f32 v193, v193
  v_mfma_f32_16x16x32_bf16 v[184:187], a[104:107], a[208:211], v[232:235]
  v_exp_f32 v194, v194
  v_mfma_f32_16x16x32_bf16 v[188:191], a[120:123], a[208:211], v[232:235]
  v_exp_f32 v195, v195
  v_mfma_f32_16x16x32_bf16 v[184:187], a[108:111], a[212:215], v[184:187]
  v_exp_f32 v196, v196
  v_mfma_f32_16x16x32_bf16 v[188:191], a[124:127], a[212:215], v[188:191]
  v_exp_f32 v197, v197
  s_add_u32 s42, s68, 74752
  v_mfma_f32_16x16x32_bf16 v[184:187], a[112:115], a[216:219], v[184:187]
  v_exp_f32 v198, v198
  v_mfma_f32_16x16x32_bf16 v[188:191], a[128:131], a[216:219], v[188:191]
  v_exp_f32 v199, v199
  v_mfma_f32_16x16x32_bf16 v[184:187], a[116:119], a[220:223], v[184:187]
  ds_read_b64_tr_b16 a[6:7], v246 offset:20480
  v_cvt_pk_bf16_f32 v216, v192, v193
  v_mfma_f32_16x16x32_bf16 v[188:191], a[132:135], a[220:223], v[188:191]
  ds_read_b64_tr_b16 a[8:9], v245 offset:16640
  buffer_load_dwordx4 v250, s[20:23], s42 offen offset:3072 lds
  v_cvt_pk_bf16_f32 v217, v194, v195
  v_cvt_pk_bf16_f32 v218, v196, v197
  v_cvt_pk_bf16_f32 v219, v198, v199
  v_mfma_f32_16x16x32_bf16 v[192:195], a[104:107], a[224:227], v[236:239]
  ds_read_b64_tr_b16 a[10:11], v245 offset:20736
  ds_read_b64_tr_b16 a[12:13], v246 offset:16640
  v_mfma_f32_16x16x32_bf16 v[196:199], a[120:123], a[224:227], v[236:239]
  ds_read_b64_tr_b16 a[14:15], v246 offset:20736
  ds_read_b64_tr_b16 a[16:17], v245 offset:16896
  v_mfma_f32_16x16x32_bf16 v[192:195], a[108:111], a[228:231], v[192:195]
  ds_read_b64_tr_b16 a[18:19], v245 offset:20992
  ds_read_b64_tr_b16 a[20:21], v246 offset:16896
  v_mfma_f32_16x16x32_bf16 v[196:199], a[124:127], a[228:231], v[196:199]
  ds_read_b64_tr_b16 a[22:23], v246 offset:20992
  ds_read_b64_tr_b16 a[24:25], v245 offset:17152
  ds_read_b64_tr_b16 a[26:27], v245 offset:21248
  ds_read_b64_tr_b16 a[28:29], v246 offset:17152
  s_waitcnt lgkmcnt(11)
  ds_read_b64_tr_b16 a[30:31], v246 offset:21248
  v_mfma_f32_16x16x32_bf16 v[192:195], a[112:115], a[232:235], v[192:195]
  v_mfma_f32_16x16x32_bf16 v[196:199], a[128:131], a[232:235], v[196:199]
  v_mfma_f32_16x16x32_bf16 v[192:195], a[116:119], a[236:239], v[192:195]
  v_mfma_f32_16x16x32_bf16 v[196:199], a[132:135], a[236:239], v[196:199]
  s_waitcnt vmcnt(21) lgkmcnt(0)
  s_barrier
  v_mfma_f32_16x16x32_bf16 a[136:139], a[156:159], v[200:203], a[136:139]
  v_max_f32 v240, v160, v161
  v_max_f32 v241, v162, v163
  v_mfma_f32_16x16x32_bf16 a[140:143], a[156:159], v[204:207], a[140:143]
  v_max3_f32 v240, v164, v165, v240
  v_max3_f32 v241, v166, v167, v241
  v_mfma_f32_16x16x32_bf16 a[144:147], a[156:159], v[208:211], a[144:147]
  v_max3_f32 v240, v168, v169, v240
  v_max3_f32 v241, v170, v171, v241
  v_mfma_f32_16x16x32_bf16 a[148:151], a[156:159], v[212:215], a[148:151]
  v_max3_f32 v240, v172, v173, v240
  v_max3_f32 v241, v174, v175, v241
  v_mfma_f32_16x16x32_bf16 a[152:155], a[156:159], v[216:219], a[152:155]
  v_max3_f32 v240, v176, v177, v240
  v_max3_f32 v241, v178, v179, v241
  v_mfma_f32_16x16x32_bf16 v[0:3], a[0:3], v[200:203], v[0:3]
  v_max3_f32 v240, v180, v181, v240
  v_max3_f32 v241, v182, v183, v241
  v_mfma_f32_16x16x32_bf16 v[4:7], a[4:7], v[200:203], v[4:7]
  v_max3_f32 v240, v184, v185, v240
  v_max3_f32 v241, v186, v187, v241
  v_mfma_f32_16x16x32_bf16 v[8:11], a[8:11], v[200:203], v[8:11]
  v_max3_f32 v240, v188, v189, v240
  v_max3_f32 v241, v190, v191, v241
  v_mfma_f32_16x16x32_bf16 v[12:15], a[12:15], v[200:203], v[12:15]
  v_max3_f32 v240, v192, v193, v240
  v_max3_f32 v241, v194, v195, v241
  v_mfma_f32_16x16x32_bf16 v[16:19], a[16:19], v[200:203], v[16:19]
  v_max3_f32 v240, v196, v197, v240
  v_max3_f32 v241, v198, v199, v241
  v_mfma_f32_16x16x32_bf16 v[20:23], a[20:23], v[200:203], v[20:23]
  v_max_f32 v240, v240, v241
  v_cmp_lt_f32 vcc, s41, v240
  v_mfma_f32_16x16x32_bf16 v[24:27], a[24:27], v[200:203], v[24:27]
  s_cbranch_vccnz L_stub13
L_ret13:
  s_add_u32 m0, s96, 65536
  v_mfma_f32_16x16x32_bf16 v[28:31], a[28:31], v[200:203], v[28:31]
  s_add_u32 s42, s68, 131072
  v_add_u32 v244, 98304, v247
  v_mfma_f32_16x16x32_bf16 v[32:35], a[0:3], v[204:207], v[32:35]
  buffer_load_dwordx4 v249, s[20:23], s42 offen offset:0 lds
  ds_read_b128 a[104:107], v244 offset:0
  v_mfma_f32_16x16x32_bf16 v[36:39], a[4:7], v[204:207], v[36:39]
  v_exp_f32 v160, v160
  v_mfma_f32_16x16x32_bf16 v[40:43], a[8:11], v[204:207], v[40:43]
  v_exp_f32 v161, v161
  v_mfma_f32_16x16x32_bf16 v[44:47], a[12:15], v[204:207], v[44:47]
  v_exp_f32 v162, v162
  v_mfma_f32_16x16x32_bf16 v[48:51], a[16:19], v[204:207], v[48:51]
  v_exp_f32 v163, v163
  v_mfma_f32_16x16x32_bf16 v[52:55], a[20:23], v[204:207], v[52:55]
  s_add_u32 s42, s68, 134144
  ds_read_b128 a[120:123], v244 offset:4096
  v_mfma_f32_16x16x32_bf16 v[56:59], a[24:27], v[204:207], v[56:59]
  v_exp_f32 v164, v164
  v_mfma_f32_16x16x32_bf16 v[60:63], a[28:31], v[204:207], v[60:63]
  v_exp_f32 v165, v165
  v_mfma_f32_16x16x32_bf16 v[64:67], a[0:3], v[208:211], v[64:67]
  buffer_load_dwordx4 v250, s[20:23], s42 offen offset:1024 lds
  ds_read_b128 a[108:111], v244 offset:256
  v_mfma_f32_16x16x32_bf16 v[68:71], a[4:7], v[208:211], v[68:71]
  v_exp_f32 v166, v166
  v_mfma_f32_16x16x32_bf16 v[72:75], a[8:11], v[208:211], v[72:75]
  v_exp_f32 v167, v167
  v_mfma_f32_16x16x32_bf16 v[76:79], a[12:15], v[208:211], v[76:79]
  ds_read_b128 a[124:127], v244 offset:4352
  v_cvt_pk_bf16_f32 v200, v160, v161
  v_mfma_f32_16x16x32_bf16 v[80:83], a[16:19], v[208:211], v[80:83]
  ds_read_b128 a[112:115], v244 offset:512
  v_cvt_pk_bf16_f32 v201, v162, v163
  v_mfma_f32_16x16x32_bf16 v[84:87], a[20:23], v[208:211], v[84:87]
  ds_read_b128 a[128:131], v244 offset:4608
  v_cvt_pk_bf16_f32 v202, v164, v165
  v_mfma_f32_16x16x32_bf16 v[88:91], a[24:27], v[208:211], v[88:91]
  s_add_u32 s42, s68, 137216
  ds_read_b128 a[116:119], v244 offset:768
  v_mfma_f32_16x16x32_bf16 v[92:95], a[28:31], v[208:211], v[92:95]
  ds_read_b128 a[132:135], v244 offset:4864
  v_cvt_pk_bf16_f32 v203, v166, v167
  v_mfma_f32_16x16x32_bf16 v[96:99], a[0:3], v[212:215], v[96:99]
  v_exp_f32 v168, v168
  v_mfma_f32_16x16x32_bf16 v[100:103], a[4:7], v[212:215], v[100:103]
  buffer_load_dwordx4 v249, s[20:23], s42 offen offset:2048 lds
  v_add_u32 v245, 98304, v248
  v_mfma_f32_16x16x32_bf16 v[104:107], a[8:11], v[212:215], v[104:107]
  v_exp_f32 v169, v169
  v_mfma_f32_16x16x32_bf16 v[108:111], a[12:15], v[212:215], v[108:111]
  v_exp_f32 v170, v170
  v_mfma_f32_16x16x32_bf16 v[112:115], a[16:19], v[212:215], v[112:115]
  v_exp_f32 v171, v171
  v_mfma_f32_16x16x32_bf16 v[116:119], a[20:23], v[212:215], v[116:119]
  v_exp_f32 v172, v172
  v_mfma_f32_16x16x32_bf16 v[120:123], a[24:27], v[212:215], v[120:123]
  s_add_u32 s42, s68, 140288
  v_xor_b32 v246, 32, v245
  v_mfma_f32_16x16x32_bf16 v[124:127], a[28:31], v[212:215], v[124:127]
  v_exp_f32 v173, v173
  v_mfma_f32_16x16x32_bf16 v[128:131], a[0:3], v[216:219], v[128:131]
  v_exp_f32 v174, v174
  v_mfma_f32_16x16x32_bf16 v[132:135], a[4:7], v[216:219], v[132:135]
  buffer_load_dwordx4 v250, s[20:23], s42 offen offset:3072 lds
  ds_read_b64_tr_b16 a[0:1], v245 offset:16384
  v_mfma_f32_16x16x32_bf16 v[136:139], a[8:11], v[216:219], v[136:139]
  v_exp_f32 v175, v175
  v_mfma_f32_16x16x32_bf16 v[140:143], a[12:15], v[216:219], v[140:143]
  v_cvt_pk_bf16_f32 v204, v168, v169
  v_cvt_pk_bf16_f32 v205, v170, v171
  v_mfma_f32_16x16x32_bf16 v[144:147], a[16:19], v[216:219], v[144:147]
  v_cvt_pk_bf16_f32 v206, v172, v173
  v_cvt_pk_bf16_f32 v207, v174, v175
  v_mfma_f32_16x16x32_bf16 v[148:151], a[20:23], v[216:219], v[148:151]
  v_exp_f32 v176, v176
  v_mfma_f32_16x16x32_bf16 v[152:155], a[24:27], v[216:219], v[152:155]
  v_exp_f32 v177, v177
  v_mfma_f32_16x16x32_bf16 v[156:159], a[28:31], v[216:219], v[156:159]
  s_add_u32 m0, s96, 81920
  s_waitcnt lgkmcnt(1)
  v_mfma_f32_16x16x32_bf16 v[160:163], a[104:107], a[160:163], v[220:223]
  s_add_u32 s42, s68, 196608
  ds_read_b64_tr_b16 a[2:3], v245 offset:20480
  v_mfma_f32_16x16x32_bf16 v[164:167], a[120:123], a[160:163], v[220:223]
  v_exp_f32 v178, v178
  v_mfma_f32_16x16x32_bf16 v[160:163], a[108:111], a[164:167], v[160:163]
  v_exp_f32 v179, v179
  v_mfma_f32_16x16x32_bf16 v[164:167], a[124:127], a[164:167], v[164:167]
  v_exp_f32 v180, v180
  v_mfma_f32_16x16x32_bf16 v[160:163], a[112:115], a[168:171], v[160:163]
  buffer_load_dwordx4 v249, s[20:23], s42 offen offset:0 lds
  ds_read_b64_tr_b16 a[4:5], v246 offset:16384
  v_mfma_f32_16x16x32_bf16 v[164:167], a[128:131], a[168:171], v[164:167]
  v_exp_f32 v181, v181
  v_mfma_f32_16x16x32_bf16 v[160:163], a[116:119], a[172:175], v[160:163]
  v_exp_f32 v182, v182
  v_mfma_f32_16x16x32_bf16 v[164:167], a[132:135], a[172:175], v[164:167]
  v_exp_f32 v183, v183
  v_mfma_f32_16x16x32_bf16 v[168:171], a[104:107], a[176:179], v[224:227]
  v_cvt_pk_bf16_f32 v208, v176, v177
  v_cvt_pk_bf16_f32 v209, v178, v179
  v_mfma_f32_16x16x32_bf16 v[172:175], a[120:123], a[176:179], v[224:227]
  s_add_u32 s42, s68, 199680
  v_cvt_pk_bf16_f32 v210, v180, v181
  v_mfma_f32_16x16x32_bf16 v[168:171], a[108:111], a[180:183], v[168:171]
  buffer_load_dwordx4 v250, s[20:23], s42 offen offset:1024 lds
  v_cvt_pk_bf16_f32 v211, v182, v183
  v_mfma_f32_16x16x32_bf16 v[172:175], a[124:127], a[180:183], v[172:175]
  v_exp_f32 v184, v184
  v_mfma_f32_16x16x32_bf16 v[168:171], a[112:115], a[184:187], v[168:171]
  v_exp_f32 v185, v185
  v_mfma_f32_16x16x32_bf16 v[172:175], a[128:131], a[184:187], v[172:175]
  v_exp_f32 v186, v186
  v_mfma_f32_16x16x32_bf16 v[168:171], a[116:119], a[188:191], v[168:171]
  v_exp_f32 v187, v187
  v_mfma_f32_16x16x32_bf16 v[172:175], a[132:135], a[188:191], v[172:175]
  v_exp_f32 v188, v188
  v_mfma_f32_16x16x32_bf16 v[176:179], a[104:107], a[192:195], v[228:231]
  v_exp_f32 v189, v189
  v_mfma_f32_16x16x32_bf16 v[180:183], a[120:123], a[192:195], v[228:231]
  v_exp_f32 v190, v190
  v_mfma_f32_16x16x32_bf16 v[176:179], a[108:111], a[196:199], v[176:179]
  v_exp_f32 v191, v191
  v_mfma_f32_16x16x32_bf16 v[180:183], a[124:127], a[196:199], v[180:183]
  s_add_u32 s42, s68, 202752
  v_cvt_pk_bf16_f32 v212, v184, v185
  v_mfma_f32_16x16x32_bf16 v[176:179], a[112:115], a[200:203], v[176:179]
  v_cvt_pk_bf16_f32 v213, v186, v187
  v_cvt_pk_bf16_f32 v214, v188, v189
  v_mfma_f32_16x16x32_bf16 v[180:183], a[128:131], a[200:203], v[180:183]
  buffer_load_dwordx4 v249, s[20:23], s42 offen offset:2048 lds
  v_cvt_pk_bf16_f32 v215, v190, v191
  v_mfma_f32_16x16x32_bf16 v[176:179], a[116:119], a[204:207], v[176:179]
  v_exp_f32 v192, v192
  v_mfma_f32_16x16x32_bf16 v[180:183], a[132:135], a[204:207], v[180:183]
  v_exp_f32 v193, v193
  v_mfma_f32_16x16x32_bf16 v[184:187], a[104:107], a[208:211], v[232:235]
  v_exp_f32 v194, v194
  v_mfma_f32_16x16x32_bf16 v[188:191], a[120:123], a[208:211], v[232:235]
  v_exp_f32 v195, v195
  v_mfma_f32_16x16x32_bf16 v[184:187], a[108:111], a[212:215], v[184:187]
  v_exp_f32 v196, v196
  v_mfma_f32_16x16x32_bf16 v[188:191], a[124:127], a[212:215], v[188:191]
  v_exp_f32 v197, v197
  s_add_u32 s42, s68, 205824
  v_mfma_f32_16x16x32_bf16 v[184:187], a[112:115], a[216:219], v[184:187]
  v_exp_f32 v198, v198
  v_mfma_f32_16x16x32_bf16 v[188:191], a[128:131], a[216:219], v[188:191]
  v_exp_f32 v199, v199
  v_mfma_f32_16x16x32_bf16 v[184:187], a[116:119], a[220:223], v[184:187]
  ds_read_b64_tr_b16 a[6:7], v246 offset:20480
  v_cvt_pk_bf16_f32 v216, v192, v193
  v_mfma_f32_16x16x32_bf16 v[188:191], a[132:135], a[220:223], v[188:191]
  ds_read_b64_tr_b16 a[8:9], v245 offset:16640
  buffer_load_dwordx4 v250, s[20:23], s42 offen offset:3072 lds
  v_cvt_pk_bf16_f32 v217, v194, v195
  v_cvt_pk_bf16_f32 v218, v196, v197
  v_cvt_pk_bf16_f32 v219, v198, v199
  v_mfma_f32_16x16x32_bf16 v[192:195], a[104:107], a[224:227], v[236:239]
  ds_read_b64_tr_b16 a[10:11], v245 offset:20736
  ds_read_b64_tr_b16 a[12:13], v246 offset:16640
  v_mfma_f32_16x16x32_bf16 v[196:199], a[120:123], a[224:227], v[236:239]
  ds_read_b64_tr_b16 a[14:15], v246 offset:20736
  ds_read_b64_tr_b16 a[16:17], v245 offset:16896
  v_mfma_f32_16x16x32_bf16 v[192:195], a[108:111], a[228:231], v[192:195]
  ds_read_b64_tr_b16 a[18:19], v245 offset:20992
  ds_read_b64_tr_b16 a[20:21], v246 offset:16896
  v_mfma_f32_16x16x32_bf16 v[196:199], a[124:127], a[228:231], v[196:199]
  ds_read_b64_tr_b16 a[22:23], v246 offset:20992
  ds_read_b64_tr_b16 a[24:25], v245 offset:17152
  ds_read_b64_tr_b16 a[26:27], v245 offset:21248
  ds_read_b64_tr_b16 a[28:29], v246 offset:17152
  s_waitcnt lgkmcnt(11)
  ds_read_b64_tr_b16 a[30:31], v246 offset:21248
  v_mfma_f32_16x16x32_bf16 v[192:195], a[112:115], a[232:235], v[192:195]
  v_mfma_f32_16x16x32_bf16 v[196:199], a[128:131], a[232:235], v[196:199]
  v_mfma_f32_16x16x32_bf16 v[192:195], a[116:119], a[236:239], v[192:195]
  v_mfma_f32_16x16x32_bf16 v[196:199], a[132:135], a[236:239], v[196:199]
  s_waitcnt vmcnt(21) lgkmcnt(0)
  s_barrier
  v_mfma_f32_16x16x32_bf16 a[136:139], a[156:159], v[200:203], a[136:139]
  v_max_f32 v240, v160, v161
  v_max_f32 v241, v162, v163
  v_mfma_f32_16x16x32_bf16 a[140:143], a[156:159], v[204:207], a[140:143]
  v_max3_f32 v240, v164, v165, v240
  v_max3_f32 v241, v166, v167, v241
  v_mfma_f32_16x16x32_bf16 a[144:147], a[156:159], v[208:211], a[144:147]
  v_max3_f32 v240, v168, v169, v240
  v_max3_f32 v241, v170, v171, v241
  v_mfma_f32_16x16x32_bf16 a[148:151], a[156:159], v[212:215], a[148:151]
  v_max3_f32 v240, v172, v173, v240
  v_max3_f32 v241, v174, v175, v241
  v_mfma_f32_16x16x32_bf16 a[152:155], a[156:159], v[216:219], a[152:155]
  v_max3_f32 v240, v176, v177, v240
  v_max3_f32 v241, v178, v179, v241
  v_mfma_f32_16x16x32_bf16 v[0:3], a[0:3], v[200:203], v[0:3]
  v_max3_f32 v240, v180, v181, v240
  v_max3_f32 v241, v182, v183, v241
  v_mfma_f32_16x16x32_bf16 v[4:7], a[4:7], v[200:203], v[4:7]
  v_max3_f32 v240, v184, v185, v240
  v_max3_f32 v241, v186, v187, v241
  v_mfma_f32_16x16x32_bf16 v[8:11], a[8:11], v[200:203], v[8:11]
  v_max3_f32 v240, v188, v189, v240
  v_max3_f32 v241, v190, v191, v241
  v_mfma_f32_16x16x32_bf16 v[12:15], a[12:15], v[200:203], v[12:15]
  v_max3_f32 v240, v192, v193, v240
  v_max3_f32 v241, v194, v195, v241
  v_mfma_f32_16x16x32_bf16 v[16:19], a[16:19], v[200:203], v[16:19]
  v_max3_f32 v240, v196, v197, v240
  v_max3_f32 v241, v198, v199, v241
  v_mfma_f32_16x16x32_bf16 v[20:23], a[20:23], v[200:203], v[20:23]
  v_max_f32 v240, v240, v241
  v_cmp_lt_f32 vcc, s41, v240
  v_mfma_f32_16x16x32_bf16 v[24:27], a[24:27], v[200:203], v[24:27]
  s_cbranch_vccnz L_stub14
L_ret14:
  v_add_u32 v244, 131072, v247
  v_mfma_f32_16x16x32_bf16 v[28:31], a[28:31], v[200:203], v[28:31]
  v_exp_f32 v160, v160
  v_mfma_f32_16x16x32_bf16 v[32:35], a[0:3], v[204:207], v[32:35]
  v_exp_f32 v161, v161
  v_mfma_f32_16x16x32_bf16 v[36:39], a[4:7], v[204:207], v[36:39]
  v_exp_f32 v162, v162
  v_mfma_f32_16x16x32_bf16 v[40:43], a[8:11], v[204:207], v[40:43]
  v_exp_f32 v163, v163
  v_mfma_f32_16x16x32_bf16 v[44:47], a[12:15], v[204:207], v[44:47]
  v_exp_f32 v164, v164
  v_mfma_f32_16x16x32_bf16 v[48:51], a[16:19], v[204:207], v[48:51]
  v_exp_f32 v165, v165
  v_mfma_f32_16x16x32_bf16 v[52:55], a[20:23], v[204:207], v[52:55]
  v_exp_f32 v166, v166
  v_mfma_f32_16x16x32_bf16 v[56:59], a[24:27], v[204:207], v[56:59]
  ds_read_b128 a[104:107], v244 offset:0
  ds_read_b128 a[120:123], v244 offset:4096
  v_mfma_f32_16x16x32_bf16 v[60:63], a[28:31], v[204:207], v[60:63]
  v_exp_f32 v167, v167
  v_mfma_f32_16x16x32_bf16 v[64:67], a[0:3], v[208:211], v[64:67]
  ds_read_b128 a[108:111], v244 offset:256
  ds_read_b128 a[124:127], v244 offset:4352
  v_mfma_f32_16x16x32_bf16 v[68:71], a[4:7], v[208:211], v[68:71]
  ds_read_b128 a[112:115], v244 offset:512
  v_cvt_pk_bf16_f32 v200, v160, v161
  v_mfma_f32_16x16x32_bf16 v[72:75], a[8:11], v[208:211], v[72:75]
  ds_read_b128 a[128:131], v244 offset:4608
  v_cvt_pk_bf16_f32 v201, v162, v163
  v_mfma_f32_16x16x32_bf16 v[76:79], a[12:15], v[208:211], v[76:79]
  ds_read_b128 a[116:119], v244 offset:768
  v_cvt_pk_bf16_f32 v202, v164, v165
  v_mfma_f32_16x16x32_bf16 v[80:83], a[16:19], v[208:211], v[80:83]
  ds_read_b128 a[132:135], v244 offset:4864
  v_cvt_pk_bf16_f32 v203, v166, v167
  v_mfma_f32_16x16x32_bf16 v[84:87], a[20:23], v[208:211], v[84:87]
  v_exp_f32 v168, v168
  v_mfma_f32_16x16x32_bf16 v[88:91], a[24:27], v[208:211], v[88:91]
  v_exp_f32 v169, v169
  v_mfma_f32_16x16x32_bf16 v[92:95], a[28:31], v[208:211], v[92:95]
  v_exp_f32 v170, v170
  v_mfma_f32_16x16x32_bf16 v[96:99], a[0:3], v[212:215], v[96:99]
  v_exp_f32 v171, v171
  v_mfma_f32_16x16x32_bf16 v[100:103], a[4:7], v[212:215], v[100:103]
  v_exp_f32 v172, v172
  v_mfma_f32_16x16x32_bf16 v[104:107], a[8:11], v[212:215], v[104:107]
  v_exp_f32 v173, v173
  v_mfma_f32_16x16x32_bf16 v[108:111], a[12:15], v[212:215], v[108:111]
  v_exp_f32 v174, v174
  v_mfma_f32_16x16x32_bf16 v[112:115], a[16:19], v[212:215], v[112:115]
  v_exp_f32 v175, v175
  v_mfma_f32_16x16x32_bf16 v[116:119], a[20:23], v[212:215], v[116:119]
  v_cvt_pk_bf16_f32 v204, v168, v169
  v_cvt_pk_bf16_f32 v205, v170, v171
  v_mfma_f32_16x16x32_bf16 v[120:123], a[24:27], v[212:215], v[120:123]
  v_cvt_pk_bf16_f32 v206, v172, v173
  v_cvt_pk_bf16_f32 v207, v174, v175
  v_mfma_f32_16x16x32_bf16 v[124:127], a[28:31], v[212:215], v[124:127]
  v_exp_f32 v176, v176
  v_mfma_f32_16x16x32_bf16 v[128:131], a[0:3], v[216:219], v[128:131]
  v_exp_f32 v177, v177
  v_mfma_f32_16x16x32_bf16 v[132:135], a[4:7], v[216:219], v[132:135]
  v_exp_f32 v178, v178
  v_mfma_f32_16x16x32_bf16 v[136:139], a[8:11], v[216:219], v[136:139]
  v_exp_f32 v179, v179
  v_mfma_f32_16x16x32_bf16 v[140:143], a[12:15], v[216:219], v[140:143]
  v_exp_f32 v180, v180
  v_mfma_f32_16x16x32_bf16 v[144:147], a[16:19], v[216:219], v[144:147]
  v_exp_f32 v181, v181
  v_mfma_f32_16x16x32_bf16 v[148:151], a[20:23], v[216:219], v[148:151]
  v_exp_f32 v182, v182
  v_mfma_f32_16x16x32_bf16 v[152:155], a[24:27], v[216:219], v[152:155]
  v_exp_f32 v183, v183
  v_mfma_f32_16x16x32_bf16 v[156:159], a[28:31], v[216:219], v[156:159]
  v_cvt_pk_bf16_f32 v208, v176, v177
  s_waitcnt lgkmcnt(0)
  v_mfma_f32_16x16x32_bf16 v[160:163], a[104:107], a[160:163], v[220:223]
  v_cvt_pk_bf16_f32 v209, v178, v179
  v_cvt_pk_bf16_f32 v210, v180, v181
  v_mfma_f32_16x16x32_bf16 v[164:167], a[120:123], a[160:163], v[220:223]
  v_cvt_pk_bf16_f32 v211, v182, v183
  v_add_u32 v245, 131072, v248
  v_mfma_f32_16x16x32_bf16 v[160:163], a[108:111], a[164:167], v[160:163]
  v_exp_f32 v184, v184
  v_mfma_f32_16x16x32_bf16 v[164:167], a[124:127], a[164:167], v[164:167]
  v_exp_f32 v185, v185
  v_mfma_f32_16x16x32_bf16 v[160:163], a[112:115], a[168:171], v[160:163]
  v_exp_f32 v186, v186
  v_mfma_f32_16x16x32_bf16 v[164:167], a[128:131], a[168:171], v[164:167]
  v_exp_f32 v187, v187
  v_mfma_f32_16x16x32_bf16 v[160:163], a[116:119], a[172:175], v[160:163]
  ds_read_b64_tr_b16 a[0:1], v245 offset:16384
  v_xor_b32 v246, 32, v245
  v_mfma_f32_16x16x32_bf16 v[164:167], a[132:135], a[172:175], v[164:167]
  v_exp_f32 v188, v188
  v_mfma_f32_16x16x32_bf16 v[168:171], a[104:107], a[176:179], v[224:227]
  v_exp_f32 v189, v189
  v_mfma_f32_16x16x32_bf16 v[172:175], a[120:123], a[176:179], v[224:227]
  v_exp_f32 v190, v190
  v_mfma_f32_16x16x32_bf16 v[168:171], a[108:111], a[180:183], v[168:171]
  v_exp_f32 v191, v191
  v_mfma_f32_16x16x32_bf16 v[172:175], a[124:127], a[180:183], v[172:175]
  v_cvt_pk_bf16_f32 v212, v184, v185
  v_cvt_pk_bf16_f32 v213, v186, v187
  v_mfma_f32_16x16x32_bf16 v[168:171], a[112:115], a[184:187], v[168:171]
  v_cvt_pk_bf16_f32 v214, v188, v189
  v_cvt_pk_bf16_f32 v215, v190, v191
  v_mfma_f32_16x16x32_bf16 v[172:175], a[128:131], a[184:187], v[172:175]
  v_exp_f32 v192, v192
  v_mfma_f32_16x16x32_bf16 v[168:171], a[116:119], a[188:191], v[168:171]
  v_exp_f32 v193, v193
  v_mfma_f32_16x16x32_bf16 v[172:175], a[132:135], a[188:191], v[172:175]
  v_exp_f32 v194, v194
  v_mfma_f32_16x16x32_bf16 v[176:179], a[104:107], a[192:195], v[228:231]
  v_exp_f32 v195, v195
  v_mfma_f32_16x16x32_bf16 v[180:183], a[120:123], a[192:195], v[228:231]
  v_exp_f32 v196, v196
  v_mfma_f32_16x16x32_bf16 v[176:179], a[108:111], a[196:199], v[176:179]
  v_exp_f32 v197, v197
  v_mfma_f32_16x16x32_bf16 v[180:183], a[124:127], a[196:199], v[180:183]
  v_exp_f32 v198, v198
  v_mfma_f32_16x16x32_bf16 v[176:179], a[112:115], a[200:203], v[176:179]
  ds_read_b64_tr_b16 a[2:3], v245 offset:20480
  ds_read_b64_tr_b16 a[4:5], v246 offset:16384
  v_mfma_f32_16x16x32_bf16 v[180:183], a[128:131], a[200:203], v[180:183]
  v_exp_f32 v199, v199
  v_mfma_f32_16x16x32_bf16 v[176:179], a[116:119], a[204:207], v[176:179]
  ds_read_b64_tr_b16 a[6:7], v246 offset:20480
  v_cvt_pk_bf16_f32 v216, v192, v193
  v_mfma_f32_16x16x32_bf16 v[180:183], a[132:135], a[204:207], v[180:183]
  ds_read_b64_tr_b16 a[8:9], v245 offset:16640
  v_cvt_pk_bf16_f32 v217, v194, v195
  v_mfma_f32_16x16x32_bf16 v[184:187], a[104:107], a[208:211], v[232:235]
  ds_read_b64_tr_b16 a[10:11], v245 offset:20736
  v_cvt_pk_bf16_f32 v218, v196, v197
  v_mfma_f32_16x16x32_bf16 v[188:191], a[120:123], a[208:211], v[232:235]
  ds_read_b64_tr_b16 a[12:13], v246 offset:16640
  v_cvt_pk_bf16_f32 v219, v198, v199
  v_mfma_f32_16x16x32_bf16 v[184:187], a[108:111], a[212:215], v[184:187]
  ds_read_b64_tr_b16 a[14:15], v246 offset:20736
  ds_read_b64_tr_b16 a[16:17], v245 offset:16896
  v_mfma_f32_16x16x32_bf16 v[188:191], a[124:127], a[212:215], v[188:191]
  ds_read_b64_tr_b16 a[18:19], v245 offset:20992
  ds_read_b64_tr_b16 a[20:21], v246 offset:16896
  v_mfma_f32_16x16x32_bf16 v[184:187], a[112:115], a[216:219], v[184:187]
  ds_read_b64_tr_b16 a[22:23], v246 offset:20992
  ds_read_b64_tr_b16 a[24:25], v245 offset:17152
  v_mfma_f32_16x16x32_bf16 v[188:191], a[128:131], a[216:219], v[188:191]
  ds_read_b64_tr_b16 a[26:27], v245 offset:21248
  ds_read_b64_tr_b16 a[28:29], v246 offset:17152
  v_mfma_f32_16x16x32_bf16 v[184:187], a[116:119], a[220:223], v[184:187]
  s_waitcnt lgkmcnt(11)
  ds_read_b64_tr_b16 a[30:31], v246 offset:21248
  v_mfma_f32_16x16x32_bf16 v[188:191], a[132:135], a[220:223], v[188:191]
  v_mfma_f32_16x16x32_bf16 v[192:195], a[104:107], a[224:227], v[236:239]
  v_mfma_f32_16x16x32_bf16 v[196:199], a[120:123], a[224:227], v[236:239]
  v_mfma_f32_16x16x32_bf16 v[192:195], a[108:111], a[228:231], v[192:195]
  v_mfma_f32_16x16x32_bf16 v[196:199], a[124:127], a[228:231], v[196:199]
  v_mfma_f32_16x16x32_bf16 v[192:195], a[112:115], a[232:235], v[192:195]
  v_mfma_f32_16x16x32_bf16 v[196:199], a[128:131], a[232:235], v[196:199]
  v_mfma_f32_16x16x32_bf16 v[192:195], a[116:119], a[236:239], v[192:195]
  v_mfma_f32_16x16x32_bf16 v[196:199], a[132:135], a[236:239], v[196:199]
  s_waitcnt vmcnt(0) lgkmcnt(0)
  s_barrier
L_tail:
  s_mov_b64 s[16:17], s[100:101]
  v_mfma_f32_16x16x32_bf16 a[136:139], a[156:159], v[200:203], a[136:139]
  v_max_f32 v240, v160, v161
  v_max_f32 v241, v162, v163
  v_max3_f32 v240, v164, v165, v240
  v_max3_f32 v241, v166, v167, v241
  v_mfma_f32_16x16x32_bf16 a[140:143], a[156:159], v[204:207], a[140:143]
  v_max3_f32 v240, v168, v169, v240
  v_max3_f32 v241, v170, v171, v241
  v_max3_f32 v240, v172, v173, v240
  v_max3_f32 v241, v174, v175, v241
  v_mfma_f32_16x16x32_bf16 a[144:147], a[156:159], v[208:211], a[144:147]
  v_max3_f32 v240, v176, v177, v240
  v_max3_f32 v241, v178, v179, v241
  v_max3_f32 v240, v180, v181, v240
  v_max3_f32 v241, v182, v183, v241
  v_mfma_f32_16x16x32_bf16 a[148:151], a[156:159], v[212:215], a[148:151]
  v_max3_f32 v240, v184, v185, v240
  v_max3_f32 v241, v186, v187, v241
  v_max3_f32 v240, v188, v189, v240
  v_max3_f32 v241, v190, v191, v241
  v_mfma_f32_16x16x32_bf16 a[152:155], a[156:159], v[216:219], a[152:155]
  v_max3_f32 v240, v192, v193, v240
  v_max3_f32 v241, v194, v195, v241
  v_max3_f32 v240, v196, v197, v240
  v_max3_f32 v241, v198, v199, v241
  v_mfma_f32_16x16x32_bf16 v[0:3], a[0:3], v[200:203], v[0:3]
  v_max_f32 v240, v240, v241
  v_cmp_lt_f32 vcc, s41, v240
  v_add_u32 v245, 0, v248
  v_xor_b32 v246, 32, v245
  v_mfma_f32_16x16x32_bf16 v[4:7], a[4:7], v[200:203], v[4:7]
  v_lshlrev_b32 v254, 4, v251
  s_lshl_b32 s43, s3, 14
  s_add_u32 s43, s43, 98304
  v_add_u32 v247, s43, v254
  v_mfma_f32_16x16x32_bf16 v[8:11], a[8:11], v[200:203], v[8:11]
  ds_read_b64_tr_b16 a[104:105], v245 offset:16384
  ds_read_b64_tr_b16 a[106:107], v245 offset:20480
  ds_read_b64_tr_b16 a[108:109], v246 offset:16384
  v_add_u32 v248, s96, v254
  v_mfma_f32_16x16x32_bf16 v[12:15], a[12:15], v[200:203], v[12:15]
  ds_read_b64_tr_b16 a[110:111], v246 offset:20480
  ds_read_b64_tr_b16 a[112:113], v245 offset:16640
  ds_read_b64_tr_b16 a[114:115], v245 offset:20736
  ds_read_b64_tr_b16 a[116:117], v246 offset:16640
  v_mfma_f32_16x16x32_bf16 v[16:19], a[16:19], v[200:203], v[16:19]
  ds_read_b64_tr_b16 a[118:119], v246 offset:20736
  ds_read_b64_tr_b16 a[120:121], v245 offset:16896
  ds_read_b64_tr_b16 a[122:123], v245 offset:20992
  ds_read_b64_tr_b16 a[124:125], v246 offset:16896
  v_mfma_f32_16x16x32_bf16 v[20:23], a[20:23], v[200:203], v[20:23]
  ds_read_b64_tr_b16 a[126:127], v246 offset:20992
  ds_read_b64_tr_b16 a[128:129], v245 offset:17152
  ds_read_b64_tr_b16 a[130:131], v245 offset:21248
  ds_read_b64_tr_b16 a[132:133], v246 offset:17152
  v_mfma_f32_16x16x32_bf16 v[24:27], a[24:27], v[200:203], v[24:27]
  s_cbranch_vccnz L_stub15
L_ret15:
  s_waitcnt lgkmcnt(11)
  ds_read_b64_tr_b16 a[134:135], v246 offset:21248
  v_exp_f32 v160, v160
  v_mfma_f32_16x16x32_bf16 v[28:31], a[28:31], v[200:203], v[28:31]
  v_exp_f32 v161, v161
  v_exp_f32 v162, v162
  v_mfma_f32_16x16x32_bf16 v[32:35], a[0:3], v[204:207], v[32:35]
  v_exp_f32 v163, v163
  v_exp_f32 v164, v164
  v_mfma_f32_16x16x32_bf16 v[36:39], a[4:7], v[204:207], v[36:39]
  v_exp_f32 v165, v165
  v_exp_f32 v166, v166
  v_mfma_f32_16x16x32_bf16 v[40:43], a[8:11], v[204:207], v[40:43]
  v_exp_f32 v167, v167
  v_cvt_pk_bf16_f32 v200, v160, v161
  v_cvt_pk_bf16_f32 v201, v162, v163
  v_mfma_f32_16x16x32_bf16 v[44:47], a[12:15], v[204:207], v[44:47]
  v_cvt_pk_bf16_f32 v202, v164, v165
  v_cvt_pk_bf16_f32 v203, v166, v167
  v_exp_f32 v168, v168
  v_mfma_f32_16x16x32_bf16 v[48:51], a[16:19], v[204:207], v[48:51]
  v_exp_f32 v169, v169
  v_exp_f32 v170, v170
  v_mfma_f32_16x16x32_bf16 v[52:55], a[20:23], v[204:207], v[52:55]
  v_exp_f32 v171, v171
  v_exp_f32 v172, v172
  v_mfma_f32_16x16x32_bf16 v[56:59], a[24:27], v[204:207], v[56:59]
  v_exp_f32 v173, v173
  v_exp_f32 v174, v174
  v_mfma_f32_16x16x32_bf16 v[60:63], a[28:31], v[204:207], v[60:63]
  v_exp_f32 v175, v175
  v_cvt_pk_bf16_f32 v204, v168, v169
  v_cvt_pk_bf16_f32 v205, v170, v171
  v_mfma_f32_16x16x32_bf16 v[64:67], a[0:3], v[208:211], v[64:67]
  v_cvt_pk_bf16_f32 v206, v172, v173
  v_cvt_pk_bf16_f32 v207, v174, v175
  v_exp_f32 v176, v176
  v_mfma_f32_16x16x32_bf16 v[68:71], a[4:7], v[208:211], v[68:71]
  v_exp_f32 v177, v177
  v_exp_f32 v178, v178
  v_mfma_f32_16x16x32_bf16 v[72:75], a[8:11], v[208:211], v[72:75]
  v_exp_f32 v179, v179
  v_exp_f32 v180, v180
  v_mfma_f32_16x16x32_bf16 v[76:79], a[12:15], v[208:211], v[76:79]
  v_exp_f32 v181, v181
  v_exp_f32 v182, v182
  v_mfma_f32_16x16x32_bf16 v[80:83], a[16:19], v[208:211], v[80:83]
  v_exp_f32 v183, v183
  s_lshl_b32 s43, s28, 15
  s_add_u32 s43, s43, 32768
  v_mfma_f32_16x16x32_bf16 v[84:87], a[20:23], v[208:211], v[84:87]
  v_add_u32 v245, s43, v253
  ds_read_b64_tr_b16 a[160:161], v245 offset:0
  ds_read_b64_tr_b16 a[162:163], v245 offset:4096
  v_xor_b32 v246, 32, v245
  v_mfma_f32_16x16x32_bf16 v[88:91], a[24:27], v[208:211], v[88:91]
  ds_read_b64_tr_b16 a[164:165], v246 offset:0
  s_waitcnt lgkmcnt(11)
  ds_read_b64_tr_b16 a[166:167], v246 offset:4096
  ds_read_b64_tr_b16 a[168:169], v245 offset:256
  ds_read_b64_tr_b16 a[170:171], v245 offset:4352
  v_mfma_f32_16x16x32_bf16 v[92:95], a[28:31], v[208:211], v[92:95]
  v_cvt_pk_bf16_f32 v208, v176, v177
  v_cvt_pk_bf16_f32 v209, v178, v179
  v_cvt_pk_bf16_f32 v210, v180, v181
  v_cvt_pk_bf16_f32 v211, v182, v183
  v_mfma_f32_16x16x32_bf16 v[96:99], a[0:3], v[212:215], v[96:99]
  ds_read_b64_tr_b16 a[172:173], v246 offset:256
  s_waitcnt lgkmcnt(11)
  ds_read_b64_tr_b16 a[174:175], v246 offset:4352
  ds_read_b64_tr_b16 a[176:177], v245 offset:8192
  ds_read_b64_tr_b16 a[178:179], v245 offset:12288
  v_mfma_f32_16x16x32_bf16 v[100:103], a[4:7], v[212:215], v[100:103]
  ds_read_b64_tr_b16 a[180:181], v246 offset:8192
  s_waitcnt lgkmcnt(11)
  ds_read_b64_tr_b16 a[182:183], v246 offset:12288
  v_exp_f32 v184, v184
  v_mfma_f32_16x16x32_bf16 v[104:107], a[8:11], v[212:215], v[104:107]
  ds_read_b64_tr_b16 a[184:185], v245 offset:8448
  ds_read_b64_tr_b16 a[186:187], v245 offset:12544
  v_exp_f32 v185, v185
  v_mfma_f32_16x16x32_bf16 v[108:111], a[12:15], v[212:215], v[108:111]
  ds_read_b64_tr_b16 a[188:189], v246 offset:8448
  s_waitcnt lgkmcnt(11)
  ds_read_b64_tr_b16 a[190:191], v246 offset:12544
  v_exp_f32 v186, v186
  v_mfma_f32_16x16x32_bf16 v[112:115], a[16:19], v[212:215], v[112:115]
  ds_read_b64_tr_b16 a[192:193], v245 offset:16384
  ds_read_b64_tr_b16 a[194:195], v245 offset:20480
  v_exp_f32 v187, v187
  v_mfma_f32_16x16x32_bf16 v[116:119], a[20:23], v[212:215], v[116:119]
  ds_read_b64_tr_b16 a[196:197], v246 offset:16384
  s_waitcnt lgkmcnt(11)
  ds_read_b64_tr_b16 a[198:199], v246 offset:20480
  v_exp_f32 v188, v188
  v_mfma_f32_16x16x32_bf16 v[120:123], a[24:27], v[212:215], v[120:123]
  ds_read_b64_tr_b16 a[200:201], v245 offset:16640
  ds_read_b64_tr_b16 a[202:203], v245 offset:20736
  v_exp_f32 v189, v189
  v_mfma_f32_16x16x32_bf16 v[124:127], a[28:31], v[212:215], v[124:127]
  ds_read_b64_tr_b16 a[204:205], v246 offset:16640
  s_waitcnt lgkmcnt(11)
  ds_read_b64_tr_b16 a[206:207], v246 offset:20736
  v_exp_f32 v190, v190
  v_mfma_f32_16x16x32_bf16 v[128:131], a[0:3], v[216:219], v[128:131]
  ds_read_b64_tr_b16 a[208:209], v245 offset:24576
  ds_read_b64_tr_b16 a[210:211], v245 offset:28672
  v_exp_f32 v191, v191
  v_mfma_f32_16x16x32_bf16 v[132:135], a[4:7], v[216:219], v[132:135]
  ds_read_b64_tr_b16 a[212:213], v246 offset:24576
  s_waitcnt lgkmcnt(11)
  ds_read_b64_tr_b16 a[214:215], v246 offset:28672
  ds_read_b64_tr_b16 a[216:217], v245 offset:24832
  v_cvt_pk_bf16_f32 v212, v184, v185
  v_mfma_f32_16x16x32_bf16 v[136:139], a[8:11], v[216:219], v[136:139]
  ds_read_b64_tr_b16 a[218:219], v245 offset:28928
  ds_read_b64_tr_b16 a[220:221], v246 offset:24832
  v_cvt_pk_bf16_f32 v213, v186, v187
  v_cvt_pk_bf16_f32 v214, v188, v189
  v_mfma_f32_16x16x32_bf16 v[140:143], a[12:15], v[216:219], v[140:143]
  s_waitcnt lgkmcnt(11)
  ds_read_b64_tr_b16 a[222:223], v246 offset:28928
  v_cvt_pk_bf16_f32 v215, v190, v191
  v_exp_f32 v192, v192
  v_mfma_f32_16x16x32_bf16 v[144:147], a[16:19], v[216:219], v[144:147]
  v_exp_f32 v193, v193
  v_exp_f32 v194, v194
  v_mfma_f32_16x16x32_bf16 v[148:151], a[20:23], v[216:219], v[148:151]
  v_exp_f32 v195, v195
  v_exp_f32 v196, v196
  v_mfma_f32_16x16x32_bf16 v[152:155], a[24:27], v[216:219], v[152:155]
  v_exp_f32 v197, v197
  v_exp_f32 v198, v198
  v_mfma_f32_16x16x32_bf16 v[156:159], a[28:31], v[216:219], v[156:159]
  v_exp_f32 v199, v199
  v_cvt_pk_bf16_f32 v216, v192, v193
  v_mfma_f32_16x16x32_bf16 a[136:139], a[156:159], v[200:203], a[136:139]
  v_cvt_pk_bf16_f32 v217, v194, v195
  v_cvt_pk_bf16_f32 v218, v196, v197
  v_cvt_pk_bf16_f32 v219, v198, v199
  v_mfma_f32_16x16x32_bf16 v[0:3], a[104:107], v[200:203], v[0:3]
  v_mfma_f32_16x16x32_bf16 v[4:7], a[108:111], v[200:203], v[4:7]
  v_mfma_f32_16x16x32_bf16 v[8:11], a[112:115], v[200:203], v[8:11]
  v_mfma_f32_16x16x32_bf16 v[12:15], a[116:119], v[200:203], v[12:15]
  v_mfma_f32_16x16x32_bf16 v[16:19], a[120:123], v[200:203], v[16:19]
  v_mfma_f32_16x16x32_bf16 v[20:23], a[124:127], v[200:203], v[20:23]
  v_mfma_f32_16x16x32_bf16 v[24:27], a[128:131], v[200:203], v[24:27]
  v_mfma_f32_16x16x32_bf16 v[28:31], a[132:135], v[200:203], v[28:31]
  v_mfma_f32_16x16x32_bf16 a[140:143], a[156:159], v[204:207], a[140:143]
  v_mfma_f32_16x16x32_bf16 v[32:35], a[104:107], v[204:207], v[32:35]
  v_accvgpr_read_b32 v240, a136
  v_rcp_f32 v240, v240
  s_nop 0
  v_pk_mul_f32 v[0:1], v[0:1], v[240:241] op_sel:[0,0] op_sel_hi:[1,0]
  v_mfma_f32_16x16x32_bf16 v[36:39], a[108:111], v[204:207], v[36:39]
  v_pk_mul_f32 v[2:3], v[2:3], v[240:241] op_sel:[0,0] op_sel_hi:[1,0]
  v_pk_mul_f32 v[4:5], v[4:5], v[240:241] op_sel:[0,0] op_sel_hi:[1,0]
  v_pk_mul_f32 v[6:7], v[6:7], v[240:241] op_sel:[0,0] op_sel_hi:[1,0]
  v_cvt_pk_bf16_f32 v220, v0, v1
  v_mfma_f32_16x16x32_bf16 v[40:43], a[112:115], v[204:207], v[40:43]
  v_cvt_pk_bf16_f32 v221, v2, v3
  v_cvt_pk_bf16_f32 v222, v4, v5
  v_cvt_pk_bf16_f32 v223, v6, v7
  v_mfma_f32_16x16x32_bf16 v[44:47], a[116:119], v[204:207], v[44:47]
  s_add_u32 s43, s95, 0
  buffer_store_dwordx4 v[220:223], v254, s[76:79], s43 offen sc1
  ds_write_b128 v247, v[220:223] offset:0
  v_pk_mul_f32 v[8:9], v[8:9], v[240:241] op_sel:[0,0] op_sel_hi:[1,0]
  v_mfma_f32_16x16x32_bf16 v[48:51], a[120:123], v[204:207], v[48:51]
  v_pk_mul_f32 v[10:11], v[10:11], v[240:241] op_sel:[0,0] op_sel_hi:[1,0]
  v_pk_mul_f32 v[12:13], v[12:13], v[240:241] op_sel:[0,0] op_sel_hi:[1,0]
  v_pk_mul_f32 v[14:15], v[14:15], v[240:241] op_sel:[0,0] op_sel_hi:[1,0]
  v_cvt_pk_bf16_f32 v224, v8, v9
  v_mfma_f32_16x16x32_bf16 v[52:55], a[124:127], v[204:207], v[52:55]
  v_cvt_pk_bf16_f32 v225, v10, v11
  v_cvt_pk_bf16_f32 v226, v12, v13
  v_cvt_pk_bf16_f32 v227, v14, v15
  v_mfma_f32_16x16x32_bf16 v[56:59], a[128:131], v[204:207], v[56:59]
  s_add_u32 s43, s95, 5120
  buffer_store_dwordx4 v[224:227], v254, s[76:79], s43 offen sc1
  ds_write_b128 v247, v[224:227] offset:5120
  v_pk_mul_f32 v[16:17], v[16:17], v[240:241] op_sel:[0,0] op_sel_hi:[1,0]
  v_mfma_f32_16x16x32_bf16 v[60:63], a[132:135], v[204:207], v[60:63]
  v_pk_mul_f32 v[18:19], v[18:19], v[240:241] op_sel:[0,0] op_sel_hi:[1,0]
  v_pk_mul_f32 v[20:21], v[20:21], v[240:241] op_sel:[0,0] op_sel_hi:[1,0]
  v_pk_mul_f32 v[22:23], v[22:23], v[240:241] op_sel:[0,0] op_sel_hi:[1,0]
  v_cvt_pk_bf16_f32 v228, v16, v17
  v_mfma_f32_16x16x32_bf16 a[144:147], a[156:159], v[208:211], a[144:147]
  v_cvt_pk_bf16_f32 v229, v18, v19
  v_cvt_pk_bf16_f32 v230, v20, v21
  v_cvt_pk_bf16_f32 v231, v22, v23
  v_mfma_f32_16x16x32_bf16 v[64:67], a[104:107], v[208:211], v[64:67]
  s_add_u32 s43, s95, 20480
  buffer_store_dwordx4 v[228:231], v254, s[76:79], s43 offen sc1
  ds_write_b128 v247, v[228:231] offset:10240
  v_pk_mul_f32 v[24:25], v[24:25], v[240:241] op_sel:[0,0] op_sel_hi:[1,0]
  v_mfma_f32_16x16x32_bf16 v[68:71], a[108:111], v[208:211], v[68:71]
  v_pk_mul_f32 v[26:27], v[26:27], v[240:241] op_sel:[0,0] op_sel_hi:[1,0]
  v_pk_mul_f32 v[28:29], v[28:29], v[240:241] op_sel:[0,0] op_sel_hi:[1,0]
  v_pk_mul_f32 v[30:31], v[30:31], v[240:241] op_sel:[0,0] op_sel_hi:[1,0]
  v_cvt_pk_bf16_f32 v232, v24, v25
  v_mfma_f32_16x16x32_bf16 v[72:75], a[112:115], v[208:211], v[72:75]
  v_cvt_pk_bf16_f32 v233, v26, v27
  v_cvt_pk_bf16_f32 v234, v28, v29
  v_cvt_pk_bf16_f32 v235, v30, v31
  v_mfma_f32_16x16x32_bf16 v[76:79], a[116:119], v[208:211], v[76:79]
  s_add_u32 s43, s95, 25600
  buffer_store_dwordx4 v[232:235], v254, s[76:79], s43 offen sc1
  s_waitcnt lgkmcnt(11)
  ds_write_b128 v247, v[232:235] offset:15360
  v_xor_b32 v16, 0x4000, v247
  v_mfma_f32_16x16x32_bf16 v[80:83], a[120:123], v[208:211], v[80:83]
  v_xor_b32 v17, 0x1000, v248
  s_mul_i32 s43, s29, 10240
  s_add_u32 s43, s43, 65536
  v_add_u32 v18, s43, v254
  v_mfma_f32_16x16x32_bf16 v[84:87], a[124:127], v[208:211], v[84:87]
  v_add_u32 v19, 40960, v18
  v_mov_b32 v22, v253
  v_xor_b32 v23, 32, v253
  v_mfma_f32_16x16x32_bf16 v[88:91], a[128:131], v[208:211], v[88:91]
  s_add_u32 s43, s72, 32
  v_mov_b32 v21, s43
  v_add_u32 v24, s49, v251
  v_and_b32 v24, 3, v24
  v_mfma_f32_16x16x32_bf16 v[92:95], a[132:135], v[208:211], v[92:95]
  v_lshlrev_b32 v24, 2, v24
  v_accvgpr_read_b32 v241, a140
  v_rcp_f32 v241, v241
  v_mfma_f32_16x16x32_bf16 a[148:151], a[156:159], v[212:215], a[148:151]
  v_pk_mul_f32 v[32:33], v[32:33], v[240:241] op_sel:[0,1] op_sel_hi:[1,1]
  v_pk_mul_f32 v[34:35], v[34:35], v[240:241] op_sel:[0,1] op_sel_hi:[1,1]
  v_pk_mul_f32 v[36:37], v[36:37], v[240:241] op_sel:[0,1] op_sel_hi:[1,1]
  v_pk_mul_f32 v[38:39], v[38:39], v[240:241] op_sel:[0,1] op_sel_hi:[1,1]
  v_mfma_f32_16x16x32_bf16 v[96:99], a[104:107], v[212:215], v[96:99]
  v_cvt_pk_bf16_f32 v236, v32, v33
  v_cvt_pk_bf16_f32 v237, v34, v35
  v_cvt_pk_bf16_f32 v238, v36, v37
  v_cvt_pk_bf16_f32 v239, v38, v39
  v_mfma_f32_16x16x32_bf16 v[100:103], a[108:111], v[212:215], v[100:103]
  s_add_u32 s43, s95, 1024
  buffer_store_dwordx4 v[236:239], v254, s[76:79], s43 offen sc1
  ds_write_b128 v247, v[236:239] offset:1024
  v_pk_mul_f32 v[40:41], v[40:41], v[240:241] op_sel:[0,1] op_sel_hi:[1,1]
  s_barrier
  s_add_u32 m0, s96, 16384
  s_add_u32 s42, s69, 0
  v_mfma_f32_16x16x32_bf16 v[104:107], a[112:115], v[212:215], v[104:107]
  v_pk_mul_f32 v[42:43], v[42:43], v[240:241] op_sel:[0,1] op_sel_hi:[1,1]
  v_pk_mul_f32 v[44:45], v[44:45], v[240:241] op_sel:[0,1] op_sel_hi:[1,1]
  v_pk_mul_f32 v[46:47], v[46:47], v[240:241] op_sel:[0,1] op_sel_hi:[1,1]
  v_cvt_pk_bf16_f32 v160, v40, v41
  v_mfma_f32_16x16x32_bf16 v[108:111], a[116:119], v[212:215], v[108:111]
  buffer_load_dwordx4 v249, s[20:23], s42 offen offset:0 lds
  v_cvt_pk_bf16_f32 v161, v42, v43
  v_cvt_pk_bf16_f32 v162, v44, v45
  v_cvt_pk_bf16_f32 v163, v46, v47
  v_mfma_f32_16x16x32_bf16 v[112:115], a[120:123], v[212:215], v[112:115]
  s_add_u32 s43, s95, 6144
  buffer_store_dwordx4 v[160:163], v254, s[76:79], s43 offen sc1
  ds_write_b128 v247, v[160:163] offset:6144
  v_pk_mul_f32 v[48:49], v[48:49], v[240:241] op_sel:[0,1] op_sel_hi:[1,1]
  v_mfma_f32_16x16x32_bf16 v[116:119], a[124:127], v[212:215], v[116:119]
  v_pk_mul_f32 v[50:51], v[50:51], v[240:241] op_sel:[0,1] op_sel_hi:[1,1]
  v_pk_mul_f32 v[52:53], v[52:53], v[240:241] op_sel:[0,1] op_sel_hi:[1,1]
  v_pk_mul_f32 v[54:55], v[54:55], v[240:241] op_sel:[0,1] op_sel_hi:[1,1]
  v_cvt_pk_bf16_f32 v164, v48, v49
  s_add_u32 s42, s69, 3072
  v_mfma_f32_16x16x32_bf16 v[120:123], a[128:131], v[212:215], v[120:123]
  buffer_load_dwordx4 v250, s[20:23], s42 offen offset:1024 lds
  v_cvt_pk_bf16_f32 v165, v50, v51
  v_cvt_pk_bf16_f32 v166, v52, v53
  v_cvt_pk_bf16_f32 v167, v54, v55
  v_mfma_f32_16x16x32_bf16 v[124:127], a[132:135], v[212:215], v[124:127]
  s_add_u32 s43, s95, 21504
  buffer_store_dwordx4 v[164:167], v254, s[76:79], s43 offen sc1
  ds_write_b128 v247, v[164:167] offset:11264
  v_pk_mul_f32 v[56:57], v[56:57], v[240:241] op_sel:[0,1] op_sel_hi:[1,1]
  v_mfma_f32_16x16x32_bf16 a[152:155], a[156:159], v[216:219], a[152:155]
  v_pk_mul_f32 v[58:59], v[58:59], v[240:241] op_sel:[0,1] op_sel_hi:[1,1]
  v_pk_mul_f32 v[60:61], v[60:61], v[240:241] op_sel:[0,1] op_sel_hi:[1,1]
  v_pk_mul_f32 v[62:63], v[62:63], v[240:241] op_sel:[0,1] op_sel_hi:[1,1]
  v_cvt_pk_bf16_f32 v168, v56, v57
  v_mfma_f32_16x16x32_bf16 v[128:131], a[104:107], v[216:219], v[128:131]
  v_cvt_pk_bf16_f32 v169, v58, v59
  v_cvt_pk_bf16_f32 v170, v60, v61
  v_cvt_pk_bf16_f32 v171, v62, v63
  s_add_u32 s42, s69, 6144
  v_mfma_f32_16x16x32_bf16 v[132:135], a[108:111], v[216:219], v[132:135]
  s_add_u32 s43, s95, 26624
  buffer_store_dwordx4 v[168:171], v254, s[76:79], s43 offen sc1
  s_waitcnt lgkmcnt(11)
  ds_write_b128 v248, v[168:171] offset:0
  v_accvgpr_read_b32 v242, a144
  v_mfma_f32_16x16x32_bf16 v[136:139], a[112:115], v[216:219], v[136:139]
  v_rcp_f32 v242, v242
  s_nop 0
  v_pk_mul_f32 v[64:65], v[64:65], v[242:243] op_sel:[0,0] op_sel_hi:[1,0]
  v_pk_mul_f32 v[66:67], v[66:67], v[242:243] op_sel:[0,0] op_sel_hi:[1,0]
  v_mfma_f32_16x16x32_bf16 v[140:143], a[116:119], v[216:219], v[140:143]
  v_pk_mul_f32 v[68:69], v[68:69], v[242:243] op_sel:[0,0] op_sel_hi:[1,0]
  v_pk_mul_f32 v[70:71], v[70:71], v[242:243] op_sel:[0,0] op_sel_hi:[1,0]
  v_cvt_pk_bf16_f32 v172, v64, v65
  v_cvt_pk_bf16_f32 v173, v66, v67
  v_mfma_f32_16x16x32_bf16 v[144:147], a[120:123], v[216:219], v[144:147]
  v_cvt_pk_bf16_f32 v174, v68, v69
  v_cvt_pk_bf16_f32 v175, v70, v71
  s_add_u32 s43, s95, 2048
  buffer_store_dwordx4 v[172:175], v254, s[76:79], s43 offen sc1
  buffer_load_dwordx4 v249, s[20:23], s42 offen offset:2048 lds
  s_add_u32 s42, s69, 9216
  v_mfma_f32_16x16x32_bf16 v[148:151], a[124:127], v[216:219], v[148:151]
  ds_write_b128 v247, v[172:175] offset:2048
  v_pk_mul_f32 v[72:73], v[72:73], v[242:243] op_sel:[0,0] op_sel_hi:[1,0]
  v_pk_mul_f32 v[74:75], v[74:75], v[242:243] op_sel:[0,0] op_sel_hi:[1,0]
  v_pk_mul_f32 v[76:77], v[76:77], v[242:243] op_sel:[0,0] op_sel_hi:[1,0]
  v_mfma_f32_16x16x32_bf16 v[152:155], a[128:131], v[216:219], v[152:155]
  v_pk_mul_f32 v[78:79], v[78:79], v[242:243] op_sel:[0,0] op_sel_hi:[1,0]
  v_cvt_pk_bf16_f32 v176, v72, v73
  v_cvt_pk_bf16_f32 v177, v74, v75
  v_cvt_pk_bf16_f32 v178, v76, v77
  v_mfma_f32_16x16x32_bf16 v[156:159], a[132:135], v[216:219], v[156:159]
  v_cvt_pk_bf16_f32 v179, v78, v79
  s_add_u32 s43, s95, 7168
  buffer_store_dwordx4 v[176:179], v254, s[76:79], s43 offen sc1
  s_waitcnt lgkmcnt(9)
  v_mfma_f32_16x16x32_bf16 v[0:3], a[160:163], v[220:223], 0
  ds_write_b128 v247, v[176:179] offset:7168
  buffer_load_dwordx4 v250, s[20:23], s42 offen offset:3072 lds
  v_pk_mul_f32 v[80:81], v[80:81], v[242:243] op_sel:[0,0] op_sel_hi:[1,0]
  v_pk_mul_f32 v[82:83], v[82:83], v[242:243] op_sel:[0,0] op_sel_hi:[1,0]
  v_pk_mul_f32 v[84:85], v[84:85], v[242:243] op_sel:[0,0] op_sel_hi:[1,0]
  v_mfma_f32_16x16x32_bf16 v[4:7], a[164:167], v[220:223], 0
  v_pk_mul_f32 v[86:87], v[86:87], v[242:243] op_sel:[0,0] op_sel_hi:[1,0]
  v_cvt_pk_bf16_f32 v180, v80, v81
  v_cvt_pk_bf16_f32 v181, v82, v83
  v_cvt_pk_bf16_f32 v182, v84, v85
  v_mfma_f32_16x16x32_bf16 v[8:11], a[168:171], v[220:223], 0
  v_cvt_pk_bf16_f32 v183, v86, v87
  s_add_u32 s43, s95, 22528
  buffer_store_dwordx4 v[180:183], v254, s[76:79], s43 offen sc1
  ds_write_b128 v247, v[180:183] offset:12288
  v_mfma_f32_16x16x32_bf16 v[12:15], a[172:175], v[220:223], 0
  v_pk_mul_f32 v[88:89], v[88:89], v[242:243] op_sel:[0,0] op_sel_hi:[1,0]
  v_pk_mul_f32 v[90:91], v[90:91], v[242:243] op_sel:[0,0] op_sel_hi:[1,0]
  v_pk_mul_f32 v[92:93], v[92:93], v[242:243] op_sel:[0,0] op_sel_hi:[1,0]
  v_pk_mul_f32 v[94:95], v[94:95], v[242:243] op_sel:[0,0] op_sel_hi:[1,0]
  v_mfma_f32_16x16x32_bf16 v[0:3], a[176:179], v[224:227], v[0:3]
  v_cvt_pk_bf16_f32 v184, v88, v89
  v_cvt_pk_bf16_f32 v185, v90, v91
  v_cvt_pk_bf16_f32 v186, v92, v93
  v_cvt_pk_bf16_f32 v187, v94, v95
  v_mfma_f32_16x16x32_bf16 v[4:7], a[180:183], v[224:227], v[4:7]
  s_add_u32 s43, s95, 27648
  buffer_store_dwordx4 v[184:187], v254, s[76:79], s43 offen sc1
  ds_write_b128 v248, v[184:187] offset:1024
  v_accvgpr_read_b32 v243, a148
  v_mfma_f32_16x16x32_bf16 v[8:11], a[184:187], v[224:227], v[8:11]
  v_rcp_f32 v243, v243
  s_nop 0
  v_pk_mul_f32 v[96:97], v[96:97], v[242:243] op_sel:[0,1] op_sel_hi:[1,1]
  v_pk_mul_f32 v[98:99], v[98:99], v[242:243] op_sel:[0,1] op_sel_hi:[1,1]
  v_mfma_f32_16x16x32_bf16 v[12:15], a[188:191], v[224:227], v[12:15]
  v_pk_mul_f32 v[100:101], v[100:101], v[242:243] op_sel:[0,1] op_sel_hi:[1,1]
  v_pk_mul_f32 v[102:103], v[102:103], v[242:243] op_sel:[0,1] op_sel_hi:[1,1]
  v_cvt_pk_bf16_f32 v188, v96, v97
  v_cvt_pk_bf16_f32 v189, v98, v99
  v_mfma_f32_16x16x32_bf16 v[0:3], a[192:195], v[228:231], v[0:3]
  v_cvt_pk_bf16_f32 v190, v100, v101
  v_cvt_pk_bf16_f32 v191, v102, v103
  s_add_u32 s43, s95, 3072
  buffer_store_dwordx4 v[188:191], v254, s[76:79], s43 offen sc1
  v_mfma_f32_16x16x32_bf16 v[4:7], a[196:199], v[228:231], v[4:7]
  ds_write_b128 v247, v[188:191] offset:3072
  v_pk_mul_f32 v[104:105], v[104:105], v[242:243] op_sel:[0,1] op_sel_hi:[1,1]
  v_pk_mul_f32 v[106:107], v[106:107], v[242:243] op_sel:[0,1] op_sel_hi:[1,1]
  v_pk_mul_f32 v[108:109], v[108:109], v[242:243] op_sel:[0,1] op_sel_hi:[1,1]
  v_pk_mul_f32 v[110:111], v[110:111], v[242:243] op_sel:[0,1] op_sel_hi:[1,1]
  v_cvt_pk_bf16_f32 v192, v104, v105
  v_cvt_pk_bf16_f32 v193, v106, v107
  v_cvt_pk_bf16_f32 v194, v108, v109
  v_cvt_pk_bf16_f32 v195, v110, v111
  s_add_u32 s43, s95, 8192
  buffer_store_dwordx4 v[192:195], v254, s[76:79], s43 offen sc1
  ds_write_b128 v247, v[192:195] offset:8192
  v_pk_mul_f32 v[112:113], v[112:113], v[242:243] op_sel:[0,1] op_sel_hi:[1,1]
  v_pk_mul_f32 v[114:115], v[114:115], v[242:243] op_sel:[0,1] op_sel_hi:[1,1]
  v_pk_mul_f32 v[116:117], v[116:117], v[242:243] op_sel:[0,1] op_sel_hi:[1,1]
  v_pk_mul_f32 v[118:119], v[118:119], v[242:243] op_sel:[0,1] op_sel_hi:[1,1]
  v_cvt_pk_bf16_f32 v196, v112, v113
  v_cvt_pk_bf16_f32 v197, v114, v115
  v_cvt_pk_bf16_f32 v198, v116, v117
  v_cvt_pk_bf16_f32 v199, v118, v119
  s_add_u32 s43, s95, 23552
  buffer_store_dwordx4 v[196:199], v254, s[76:79], s43 offen sc1
  ds_write_b128 v247, v[196:199] offset:13312
  v_pk_mul_f32 v[120:121], v[120:121], v[242:243] op_sel:[0,1] op_sel_hi:[1,1]
  v_pk_mul_f32 v[122:123], v[122:123], v[242:243] op_sel:[0,1] op_sel_hi:[1,1]
  v_pk_mul_f32 v[124:125], v[124:125], v[242:243] op_sel:[0,1] op_sel_hi:[1,1]
  v_pk_mul_f32 v[126:127], v[126:127], v[242:243] op_sel:[0,1] op_sel_hi:[1,1]
  v_cvt_pk_bf16_f32 v200, v120, v121
  v_cvt_pk_bf16_f32 v201, v122, v123
  v_cvt_pk_bf16_f32 v202, v124, v125
  v_cvt_pk_bf16_f32 v203, v126, v127
  s_add_u32 s43, s95, 28672
  buffer_store_dwordx4 v[200:203], v254, s[76:79], s43 offen sc1
  s_waitcnt lgkmcnt(11)
  ds_write_b128 v248, v[200:203] offset:2048
  v_accvgpr_read_b32 v244, a152
  v_mfma_f32_16x16x32_bf16 v[8:11], a[200:203], v[228:231], v[8:11]
  v_rcp_f32 v244, v244
  s_nop 0
  v_pk_mul_f32 v[128:129], v[128:129], v[244:245] op_sel:[0,0] op_sel_hi:[1,0]
  v_pk_mul_f32 v[130:131], v[130:131], v[244:245] op_sel:[0,0] op_sel_hi:[1,0]
  v_mfma_f32_16x16x32_bf16 v[12:15], a[204:207], v[228:231], v[12:15]
  v_pk_mul_f32 v[132:133], v[132:133], v[244:245] op_sel:[0,0] op_sel_hi:[1,0]
  v_pk_mul_f32 v[134:135], v[134:135], v[244:245] op_sel:[0,0] op_sel_hi:[1,0]
  v_cvt_pk_bf16_f32 v204, v128, v129
  v_cvt_pk_bf16_f32 v205, v130, v131
  v_mfma_f32_16x16x32_bf16 v[0:3], a[208:211], v[232:235], v[0:3]
  v_cvt_pk_bf16_f32 v206, v132, v133
  v_cvt_pk_bf16_f32 v207, v134, v135
  s_add_u32 s43, s95, 4096
  buffer_store_dwordx4 v[204:207], v254, s[76:79], s43 offen sc1
  v_mfma_f32_16x16x32_bf16 v[4:7], a[212:215], v[232:235], v[4:7]
  ds_write_b128 v247, v[204:207] offset:4096
  v_pk_mul_f32 v[136:137], v[136:137], v[244:245] op_sel:[0,0] op_sel_hi:[1,0]
  v_pk_mul_f32 v[138:139], v[138:139], v[244:245] op_sel:[0,0] op_sel_hi:[1,0]
  v_pk_mul_f32 v[140:141], v[140:141], v[244:245] op_sel:[0,0] op_sel_hi:[1,0]
  v_mfma_f32_16x16x32_bf16 v[8:11], a[216:219], v[232:235], v[8:11]
  v_pk_mul_f32 v[142:143], v[142:143], v[244:245] op_sel:[0,0] op_sel_hi:[1,0]
  v_cvt_pk_bf16_f32 v208, v136, v137
  v_cvt_pk_bf16_f32 v209, v138, v139
  v_cvt_pk_bf16_f32 v210, v140, v141
  v_mfma_f32_16x16x32_bf16 v[12:15], a[220:223], v[232:235], v[12:15]
  v_cvt_pk_bf16_f32 v211, v142, v143
  s_add_u32 s43, s95, 9216
  buffer_store_dwordx4 v[208:211], v254, s[76:79], s43 offen sc1
  ds_write_b128 v247, v[208:211] offset:9216
  v_pk_mul_f32 v[144:145], v[144:145], v[244:245] op_sel:[0,0] op_sel_hi:[1,0]
  v_pk_mul_f32 v[146:147], v[146:147], v[244:245] op_sel:[0,0] op_sel_hi:[1,0]
  v_pk_mul_f32 v[148:149], v[148:149], v[244:245] op_sel:[0,0] op_sel_hi:[1,0]
  v_pk_mul_f32 v[150:151], v[150:151], v[244:245] op_sel:[0,0] op_sel_hi:[1,0]
  v_cvt_pk_bf16_f32 v212, v144, v145
  v_cvt_pk_bf16_f32 v213, v146, v147
  v_cvt_pk_bf16_f32 v214, v148, v149
  v_cvt_pk_bf16_f32 v215, v150, v151
  s_add_u32 s43, s95, 24576
  buffer_store_dwordx4 v[212:215], v254, s[76:79], s43 offen sc1
  ds_write_b128 v247, v[212:215] offset:14336
  v_pk_mul_f32 v[152:153], v[152:153], v[244:245] op_sel:[0,0] op_sel_hi:[1,0]
  v_pk_mul_f32 v[154:155], v[154:155], v[244:245] op_sel:[0,0] op_sel_hi:[1,0]
  v_pk_mul_f32 v[156:157], v[156:157], v[244:245] op_sel:[0,0] op_sel_hi:[1,0]
  v_pk_mul_f32 v[158:159], v[158:159], v[244:245] op_sel:[0,0] op_sel_hi:[1,0]
  v_cvt_pk_bf16_f32 v216, v152, v153
  v_cvt_pk_bf16_f32 v217, v154, v155
  v_cvt_pk_bf16_f32 v218, v156, v157
  v_cvt_pk_bf16_f32 v219, v158, v159
  s_add_u32 s43, s95, 29696
  buffer_store_dwordx4 v[216:219], v254, s[76:79], s43 offen sc1
  s_waitcnt lgkmcnt(11)
  ds_write_b128 v248, v[216:219] offset:3072
  v_mfma_f32_16x16x32_bf16 v[32:35], a[160:163], v[236:239], 0
  s_waitcnt lgkmcnt(0)
  s_barrier
  v_xor_b32 v245, 0x18000, v245
  v_xor_b32 v246, 0x18000, v246
  v_mfma_f32_16x16x32_bf16 v[36:39], a[164:167], v[236:239], 0
  ds_read_b64_tr_b16 a[80:81], v245 offset:0
  ds_read_b64_tr_b16 a[82:83], v245 offset:4096
  ds_read_b64_tr_b16 a[84:85], v246 offset:0
  ds_read_b64_tr_b16 a[86:87], v246 offset:4096
  v_mfma_f32_16x16x32_bf16 v[40:43], a[168:171], v[236:239], 0
  ds_read_b64_tr_b16 a[88:89], v245 offset:256
  ds_read_b64_tr_b16 a[90:91], v245 offset:4352
  ds_read_b64_tr_b16 a[92:93], v246 offset:256
  ds_read_b64_tr_b16 a[94:95], v246 offset:4352
  v_mfma_f32_16x16x32_bf16 v[44:47], a[172:175], v[236:239], 0
  ds_read_b64_tr_b16 a[96:97], v245 offset:8192
  ds_read_b64_tr_b16 a[98:99], v245 offset:12288
  ds_read_b64_tr_b16 a[100:101], v246 offset:8192
  ds_read_b64_tr_b16 a[102:103], v246 offset:12288
  v_mfma_f32_16x16x32_bf16 v[32:35], a[176:179], v[160:163], v[32:35]
  ds_read_b64_tr_b16 a[104:105], v245 offset:8448
  ds_read_b128 a[0:3], v16 offset:0
  ds_read_b64_tr_b16 a[106:107], v245 offset:12544
  s_waitcnt lgkmcnt(11)
  ds_read_b128 a[4:7], v16 offset:1024
  v_mfma_f32_16x16x32_bf16 v[36:39], a[180:183], v[160:163], v[36:39]
  ds_read_b64_tr_b16 a[108:109], v246 offset:8448
  ds_read_b128 a[8:11], v16 offset:2048
  ds_read_b64_tr_b16 a[110:111], v246 offset:12544
  s_waitcnt lgkmcnt(11)
  ds_read_b128 a[12:15], v16 offset:3072
  v_mfma_f32_16x16x32_bf16 v[40:43], a[184:187], v[160:163], v[40:43]
  ds_read_b64_tr_b16 a[112:113], v245 offset:16384
  ds_read_b128 a[16:19], v16 offset:4096
  ds_read_b64_tr_b16 a[114:115], v245 offset:20480
  s_waitcnt lgkmcnt(11)
  ds_read_b128 a[20:23], v16 offset:5120
  v_mfma_f32_16x16x32_bf16 v[44:47], a[188:191], v[160:163], v[44:47]
  ds_read_b64_tr_b16 a[116:117], v246 offset:16384
  ds_read_b128 a[24:27], v16 offset:6144
  ds_read_b64_tr_b16 a[118:119], v246 offset:20480
  s_waitcnt lgkmcnt(11)
  ds_read_b128 a[28:31], v16 offset:7168
  v_mfma_f32_16x16x32_bf16 v[32:35], a[192:195], v[164:167], v[32:35]
  ds_read_b64_tr_b16 a[120:121], v245 offset:16640
  ds_read_b128 a[32:35], v16 offset:8192
  ds_read_b64_tr_b16 a[122:123], v245 offset:20736
  s_waitcnt lgkmcnt(11)
  ds_read_b128 a[36:39], v16 offset:9216
  v_mfma_f32_16x16x32_bf16 v[36:39], a[196:199], v[164:167], v[36:39]
  ds_read_b64_tr_b16 a[124:125], v246 offset:16640
  ds_read_b128 a[40:43], v16 offset:10240
  ds_read_b64_tr_b16 a[126:127], v246 offset:20736
  s_waitcnt lgkmcnt(11)
  ds_read_b128 a[44:47], v16 offset:11264
  v_mfma_f32_16x16x32_bf16 v[40:43], a[200:203], v[164:167], v[40:43]
  ds_read_b64_tr_b16 a[128:129], v245 offset:24576
  ds_read_b128 a[48:51], v16 offset:12288
  ds_read_b64_tr_b16 a[130:131], v245 offset:28672
  s_waitcnt lgkmcnt(11)
  ds_read_b128 a[52:55], v16 offset:13312
  v_mfma_f32_16x16x32_bf16 v[44:47], a[204:207], v[164:167], v[44:47]
  ds_read_b64_tr_b16 a[132:133], v246 offset:24576
  ds_read_b128 a[56:59], v16 offset:14336
  ds_read_b64_tr_b16 a[134:135], v246 offset:28672
  s_waitcnt lgkmcnt(11)
  ds_read_b128 a[60:63], v16 offset:15360
  v_mfma_f32_16x16x32_bf16 v[32:35], a[208:211], v[168:171], v[32:35]
  ds_read_b64_tr_b16 a[136:137], v245 offset:24832
  ds_read_b128 a[64:67], v17 offset:0
  ds_read_b64_tr_b16 a[138:139], v245 offset:28928
  s_waitcnt lgkmcnt(11)
  ds_read_b128 a[68:71], v17 offset:1024
  v_mfma_f32_16x16x32_bf16 v[36:39], a[212:215], v[168:171], v[36:39]
  ds_read_b64_tr_b16 a[140:141], v246 offset:24832
  ds_read_b128 a[72:75], v17 offset:2048
  ds_read_b64_tr_b16 a[142:143], v246 offset:28928
  s_waitcnt lgkmcnt(11)
  ds_read_b128 a[76:79], v17 offset:3072
  v_mfma_f32_16x16x32_bf16 v[40:43], a[216:219], v[168:171], v[40:43]
  v_mfma_f32_16x16x32_bf16 v[44:47], a[220:223], v[168:171], v[44:47]
  v_mfma_f32_16x16x32_bf16 v[64:67], a[160:163], v[172:175], 0
  v_mfma_f32_16x16x32_bf16 v[68:71], a[164:167], v[172:175], 0
  v_mfma_f32_16x16x32_bf16 v[72:75], a[168:171], v[172:175], 0
  v_mfma_f32_16x16x32_bf16 v[76:79], a[172:175], v[172:175], 0
  v_mfma_f32_16x16x32_bf16 v[64:67], a[176:179], v[176:179], v[64:67]
  v_mfma_f32_16x16x32_bf16 v[68:71], a[180:183], v[176:179], v[68:71]
  v_mfma_f32_16x16x32_bf16 v[72:75], a[184:187], v[176:179], v[72:75]
  v_mfma_f32_16x16x32_bf16 v[76:79], a[188:191], v[176:179], v[76:79]
  v_mfma_f32_16x16x32_bf16 v[64:67], a[192:195], v[180:183], v[64:67]
  v_mfma_f32_16x16x32_bf16 v[68:71], a[196:199], v[180:183], v[68:71]
  v_mfma_f32_16x16x32_bf16 v[72:75], a[200:203], v[180:183], v[72:75]
  v_mfma_f32_16x16x32_bf16 v[76:79], a[204:207], v[180:183], v[76:79]
  v_mfma_f32_16x16x32_bf16 v[64:67], a[208:211], v[184:187], v[64:67]
  v_mfma_f32_16x16x32_bf16 v[68:71], a[212:215], v[184:187], v[68:71]
  v_mfma_f32_16x16x32_bf16 v[72:75], a[216:219], v[184:187], v[72:75]
  v_mfma_f32_16x16x32_bf16 v[76:79], a[220:223], v[184:187], v[76:79]
  v_mfma_f32_16x16x32_bf16 v[96:99], a[160:163], v[188:191], 0
  v_mfma_f32_16x16x32_bf16 v[100:103], a[164:167], v[188:191], 0
  v_mfma_f32_16x16x32_bf16 v[104:107], a[168:171], v[188:191], 0
  v_mfma_f32_16x16x32_bf16 v[108:111], a[172:175], v[188:191], 0
  v_mfma_f32_16x16x32_bf16 v[96:99], a[176:179], v[192:195], v[96:99]
  v_mfma_f32_16x16x32_bf16 v[100:103], a[180:183], v[192:195], v[100:103]
  v_mfma_f32_16x16x32_bf16 v[104:107], a[184:187], v[192:195], v[104:107]
  v_mfma_f32_16x16x32_bf16 v[108:111], a[188:191], v[192:195], v[108:111]
  v_mfma_f32_16x16x32_bf16 v[96:99], a[192:195], v[196:199], v[96:99]
  v_mfma_f32_16x16x32_bf16 v[100:103], a[196:199], v[196:199], v[100:103]
  v_mfma_f32_16x16x32_bf16 v[104:107], a[200:203], v[196:199], v[104:107]
  v_mfma_f32_16x16x32_bf16 v[108:111], a[204:207], v[196:199], v[108:111]
  v_mfma_f32_16x16x32_bf16 v[96:99], a[208:211], v[200:203], v[96:99]
  v_mfma_f32_16x16x32_bf16 v[100:103], a[212:215], v[200:203], v[100:103]
  v_mfma_f32_16x16x32_bf16 v[104:107], a[216:219], v[200:203], v[104:107]
  v_mfma_f32_16x16x32_bf16 v[108:111], a[220:223], v[200:203], v[108:111]
  v_mfma_f32_16x16x32_bf16 v[128:131], a[160:163], v[204:207], 0
  v_mfma_f32_16x16x32_bf16 v[132:135], a[164:167], v[204:207], 0
  v_mfma_f32_16x16x32_bf16 v[136:139], a[168:171], v[204:207], 0
  v_mfma_f32_16x16x32_bf16 v[140:143], a[172:175], v[204:207], 0
  v_mfma_f32_16x16x32_bf16 v[128:131], a[176:179], v[208:211], v[128:131]
  v_mfma_f32_16x16x32_bf16 v[132:135], a[180:183], v[208:211], v[132:135]
  v_mfma_f32_16x16x32_bf16 v[136:139], a[184:187], v[208:211], v[136:139]
  v_mfma_f32_16x16x32_bf16 v[140:143], a[188:191], v[208:211], v[140:143]
  v_mfma_f32_16x16x32_bf16 v[128:131], a[192:195], v[212:215], v[128:131]
  v_mfma_f32_16x16x32_bf16 v[132:135], a[196:199], v[212:215], v[132:135]
  v_mfma_f32_16x16x32_bf16 v[136:139], a[200:203], v[212:215], v[136:139]
  v_mfma_f32_16x16x32_bf16 v[140:143], a[204:207], v[212:215], v[140:143]
  v_mfma_f32_16x16x32_bf16 v[128:131], a[208:211], v[216:219], v[128:131]
  v_mfma_f32_16x16x32_bf16 v[132:135], a[212:215], v[216:219], v[132:135]
  v_mfma_f32_16x16x32_bf16 v[136:139], a[216:219], v[216:219], v[136:139]
  v_mfma_f32_16x16x32_bf16 v[140:143], a[220:223], v[216:219], v[140:143]
  s_waitcnt lgkmcnt(0)
  s_barrier
  v_mfma_f32_16x16x32_bf16 v[0:3], a[80:83], a[0:3], v[0:3]
  v_mfma_f32_16x16x32_bf16 v[32:35], a[80:83], a[4:7], v[32:35]
  v_mfma_f32_16x16x32_bf16 v[64:67], a[80:83], a[8:11], v[64:67]
  s_waitcnt vmcnt(0)
  s_barrier
  s_cmp_lg_u32 s3, 0
  s_cbranch_scc1 L_nosig
  s_mov_b64 exec, 1
  buffer_store_dword v21, off, s[80:83], s92 sc0 sc1
  s_mov_b64 exec, -1
L_nosig:
  v_mfma_f32_16x16x32_bf16 v[96:99], a[80:83], a[12:15], v[96:99]
  s_add_u32 m0, s96, 0
  s_add_u32 s42, s69, 65536
  v_mfma_f32_16x16x32_bf16 v[128:131], a[80:83], a[16:19], v[128:131]
  buffer_load_dwordx4 v249, s[20:23], s42 offen offset:0 lds
  s_add_u32 s42, s69, 68608
  v_mfma_f32_16x16x32_bf16 v[4:7], a[84:87], a[0:3], v[4:7]
  buffer_load_dwordx4 v250, s[20:23], s42 offen offset:1024 lds
  s_add_u32 s42, s69, 71680
  v_mfma_f32_16x16x32_bf16 v[36:39], a[84:87], a[4:7], v[36:39]
  buffer_load_dwordx4 v249, s[20:23], s42 offen offset:2048 lds
  s_add_u32 s42, s69, 74752
  v_mfma_f32_16x16x32_bf16 v[68:71], a[84:87], a[8:11], v[68:71]
  buffer_load_dwordx4 v250, s[20:23], s42 offen offset:3072 lds
  s_add_u32 m0, s96, 32768
  v_mfma_f32_16x16x32_bf16 v[100:103], a[84:87], a[12:15], v[100:103]
  s_add_u32 s42, s69, 131072
  v_mfma_f32_16x16x32_bf16 v[132:135], a[84:87], a[16:19], v[132:135]
  buffer_load_dwordx4 v249, s[20:23], s42 offen offset:0 lds
  s_add_u32 s42, s69, 134144
  v_mfma_f32_16x16x32_bf16 v[8:11], a[88:91], a[0:3], v[8:11]
  buffer_load_dwordx4 v250, s[20:23], s42 offen offset:1024 lds
  s_add_u32 s42, s69, 137216
  v_mfma_f32_16x16x32_bf16 v[40:43], a[88:91], a[4:7], v[40:43]
  buffer_load_dwordx4 v249, s[20:23], s42 offen offset:2048 lds
  s_add_u32 s42, s69, 140288
  v_mfma_f32_16x16x32_bf16 v[72:75], a[88:91], a[8:11], v[72:75]
  buffer_load_dwordx4 v250, s[20:23], s42 offen offset:3072 lds
  s_add_u32 m0, s96, 49152
  v_mfma_f32_16x16x32_bf16 v[104:107], a[88:91], a[12:15], v[104:107]
  s_add_u32 s42, s69, 196608
  v_mfma_f32_16x16x32_bf16 v[136:139], a[88:91], a[16:19], v[136:139]
  buffer_load_dwordx4 v249, s[20:23], s42 offen offset:0 lds
  s_add_u32 s42, s69, 199680
  v_mfma_f32_16x16x32_bf16 v[12:15], a[92:95], a[0:3], v[12:15]
  buffer_load_dwordx4 v250, s[20:23], s42 offen offset:1024 lds
  s_add_u32 s42, s69, 202752
  v_mfma_f32_16x16x32_bf16 v[44:47], a[92:95], a[4:7], v[44:47]
  buffer_load_dwordx4 v249, s[20:23], s42 offen offset:2048 lds
  s_add_u32 s42, s69, 205824
  v_mfma_f32_16x16x32_bf16 v[76:79], a[92:95], a[8:11], v[76:79]
  buffer_load_dwordx4 v250, s[20:23], s42 offen offset:3072 lds
  v_mfma_f32_16x16x32_bf16 v[108:111], a[92:95], a[12:15], v[108:111]
  v_mfma_f32_16x16x32_bf16 v[140:143], a[92:95], a[16:19], v[140:143]
  v_mfma_f32_16x16x32_bf16 v[0:3], a[96:99], a[20:23], v[0:3]
  buffer_load_dword v20, v24, s[80:83], 0 offen sc0 sc1
  v_mfma_f32_16x16x32_bf16 v[32:35], a[96:99], a[24:27], v[32:35]
  v_mfma_f32_16x16x32_bf16 v[64:67], a[96:99], a[28:31], v[64:67]
  v_mfma_f32_16x16x32_bf16 v[96:99], a[96:99], a[32:35], v[96:99]
  v_mfma_f32_16x16x32_bf16 v[128:131], a[96:99], a[36:39], v[128:131]
  v_mfma_f32_16x16x32_bf16 v[4:7], a[100:103], a[20:23], v[4:7]
  v_mfma_f32_16x16x32_bf16 v[36:39], a[100:103], a[24:27], v[36:39]
  v_mfma_f32_16x16x32_bf16 v[68:71], a[100:103], a[28:31], v[68:71]
  v_mfma_f32_16x16x32_bf16 v[100:103], a[100:103], a[32:35], v[100:103]
  v_mfma_f32_16x16x32_bf16 v[132:135], a[100:103], a[36:39], v[132:135]
  v_mfma_f32_16x16x32_bf16 v[8:11], a[104:107], a[20:23], v[8:11]
  s_waitcnt vmcnt(0)
  v_readlane_b32 s94, v20, 1
  s_nop 0
  s_sub_u32 s94, s94, s73
  s_cmp_eq_u32 s94, 32
  s_cbranch_scc0 L_cstub1
L_cret1:
  v_mfma_f32_16x16x32_bf16 v[40:43], a[104:107], a[24:27], v[40:43]
  s_add_u32 m0, s97, 65536
  s_add_u32 s44, s65, 0
  buffer_load_dwordx4 v254, s[76:79], s44 offen offset:0 sc1 lds
  v_mfma_f32_16x16x32_bf16 v[72:75], a[104:107], a[28:31], v[72:75]
  v_mfma_f32_16x16x32_bf16 v[104:107], a[104:107], a[32:35], v[104:107]
  buffer_load_dwordx4 v254, s[76:79], s44 offen offset:1024 sc1 lds
  v_mfma_f32_16x16x32_bf16 v[136:139], a[104:107], a[36:39], v[136:139]
  v_mfma_f32_16x16x32_bf16 v[12:15], a[108:111], a[20:23], v[12:15]
  buffer_load_dwordx4 v254, s[76:79], s44 offen offset:2048 sc1 lds
  v_mfma_f32_16x16x32_bf16 v[44:47], a[108:111], a[24:27], v[44:47]
  v_mfma_f32_16x16x32_bf16 v[76:79], a[108:111], a[28:31], v[76:79]
  v_mfma_f32_16x16x32_bf16 v[108:111], a[108:111], a[32:35], v[108:111]
  buffer_load_dwordx4 v254, s[76:79], s44 offen offset:3072 sc1 lds
  s_add_u32 m0, s97, 69632
  v_mfma_f32_16x16x32_bf16 v[140:143], a[108:111], a[36:39], v[140:143]
  s_add_u32 s44, s65, 4096
  v_mfma_f32_16x16x32_bf16 v[0:3], a[112:115], a[40:43], v[0:3]
  buffer_load_dwordx4 v254, s[76:79], s44 offen offset:0 sc1 lds
  s_add_u32 m0, s97, 86016
  v_mfma_f32_16x16x32_bf16 v[32:35], a[112:115], a[44:47], v[32:35]
  s_add_u32 s44, s65, 20480
  v_mfma_f32_16x16x32_bf16 v[64:67], a[112:115], a[48:51], v[64:67]
  v_mfma_f32_16x16x32_bf16 v[96:99], a[112:115], a[52:55], v[96:99]
  buffer_load_dwordx4 v254, s[76:79], s44 offen offset:0 sc1 lds
  v_mfma_f32_16x16x32_bf16 v[128:131], a[112:115], a[56:59], v[128:131]
  v_mfma_f32_16x16x32_bf16 v[4:7], a[116:119], a[40:43], v[4:7]
  buffer_load_dwordx4 v254, s[76:79], s44 offen offset:1024 sc1 lds
  v_mfma_f32_16x16x32_bf16 v[36:39], a[116:119], a[44:47], v[36:39]
  v_mfma_f32_16x16x32_bf16 v[68:71], a[116:119], a[48:51], v[68:71]
  v_mfma_f32_16x16x32_bf16 v[100:103], a[116:119], a[52:55], v[100:103]
  buffer_load_dwordx4 v254, s[76:79], s44 offen offset:2048 sc1 lds
  v_mfma_f32_16x16x32_bf16 v[132:135], a[116:119], a[56:59], v[132:135]
  v_mfma_f32_16x16x32_bf16 v[8:11], a[120:123], a[40:43], v[8:11]
  buffer_load_dwordx4 v254, s[76:79], s44 offen offset:3072 sc1 lds
  s_add_u32 m0, s97, 90112
  v_mfma_f32_16x16x32_bf16 v[40:43], a[120:123], a[44:47], v[40:43]
  s_add_u32 s44, s65, 24576
  v_mfma_f32_16x16x32_bf16 v[72:75], a[120:123], a[48:51], v[72:75]
  v_mfma_f32_16x16x32_bf16 v[104:107], a[120:123], a[52:55], v[104:107]
  buffer_load_dwordx4 v254, s[76:79], s44 offen offset:0 sc1 lds
  s_add_u32 m0, s97, 106496
  v_mfma_f32_16x16x32_bf16 v[136:139], a[120:123], a[56:59], v[136:139]
  s_add_u32 s44, s65, 40960
  v_mfma_f32_16x16x32_bf16 v[12:15], a[124:127], a[40:43], v[12:15]
  buffer_load_dwordx4 v254, s[76:79], s44 offen offset:0 sc1 lds
  v_mfma_f32_16x16x32_bf16 v[44:47], a[124:127], a[44:47], v[44:47]
  v_mfma_f32_16x16x32_bf16 v[76:79], a[124:127], a[48:51], v[76:79]
  buffer_load_dwordx4 v254, s[76:79], s44 offen offset:1024 sc1 lds
  v_mfma_f32_16x16x32_bf16 v[108:111], a[124:127], a[52:55], v[108:111]
  v_mfma_f32_16x16x32_bf16 v[140:143], a[124:127], a[56:59], v[140:143]
  v_mfma_f32_16x16x32_bf16 v[0:3], a[128:131], a[60:63], v[0:3]
  buffer_load_dwordx4 v254, s[76:79], s44 offen offset:2048 sc1 lds
  v_mfma_f32_16x16x32_bf16 v[32:35], a[128:131], a[64:67], v[32:35]
  v_mfma_f32_16x16x32_bf16 v[64:67], a[128:131], a[68:71], v[64:67]
  buffer_load_dwordx4 v254, s[76:79], s44 offen offset:3072 sc1 lds
  s_add_u32 m0, s97, 110592
  v_mfma_f32_16x16x32_bf16 v[96:99], a[128:131], a[72:75], v[96:99]
  s_add_u32 s44, s65, 45056
  v_mfma_f32_16x16x32_bf16 v[128:131], a[128:131], a[76:79], v[128:131]
  v_mfma_f32_16x16x32_bf16 v[4:7], a[132:135], a[60:63], v[4:7]
  buffer_load_dwordx4 v254, s[76:79], s44 offen offset:0 sc1 lds
  s_add_u32 m0, s97, 126976
  v_mfma_f32_16x16x32_bf16 v[36:39], a[132:135], a[64:67], v[36:39]
  s_waitcnt vmcnt(10)
  s_barrier
  v_mfma_f32_16x16x32_bf16 v[68:71], a[132:135], a[68:71], v[68:71]
  s_add_u32 s44, s65, 61440
  buffer_load_dwordx4 v254, s[76:79], s44 offen offset:0 sc1 lds
  v_mfma_f32_16x16x32_bf16 v[100:103], a[132:135], a[72:75], v[100:103]
  ds_read_b64_tr_b16 a[160:161], v22 offset:16384
  ds_read_b64_tr_b16 a[162:163], v22 offset:20480
  v_mfma_f32_16x16x32_bf16 v[132:135], a[132:135], a[76:79], v[132:135]
  ds_read_b128 a[176:179], v18 offset:0
  ds_read_b128 a[180:183], v18 offset:1024
  v_mfma_f32_16x16x32_bf16 v[8:11], a[136:139], a[60:63], v[8:11]
  buffer_load_dwordx4 v254, s[76:79], s44 offen offset:1024 sc1 lds
  ds_read_b128 a[184:187], v18 offset:2048
  v_mfma_f32_16x16x32_bf16 v[40:43], a[136:139], a[64:67], v[40:43]
  ds_read_b128 a[188:191], v18 offset:3072
  ds_read_b128 a[192:195], v18 offset:4096
  v_mfma_f32_16x16x32_bf16 v[72:75], a[136:139], a[68:71], v[72:75]
  buffer_load_dwordx4 v254, s[76:79], s44 offen offset:2048 sc1 lds
  ds_read_b64_tr_b16 a[164:165], v23 offset:16384
  v_mfma_f32_16x16x32_bf16 v[104:107], a[136:139], a[72:75], v[104:107]
  ds_read_b64_tr_b16 a[166:167], v23 offset:20480
  ds_read_b64_tr_b16 a[168:169], v22 offset:16640
  v_mfma_f32_16x16x32_bf16 v[136:139], a[136:139], a[76:79], v[136:139]
  ds_read_b64_tr_b16 a[170:171], v22 offset:20736
  ds_read_b64_tr_b16 a[172:173], v23 offset:16640
  v_mfma_f32_16x16x32_bf16 v[12:15], a[140:143], a[60:63], v[12:15]
  buffer_load_dwordx4 v254, s[76:79], s44 offen offset:3072 sc1 lds
  s_add_u32 m0, s97, 131072
  v_mfma_f32_16x16x32_bf16 v[44:47], a[140:143], a[64:67], v[44:47]
  ds_read_b64_tr_b16 a[174:175], v23 offset:20736
  s_add_u32 s44, s65, 65536
  v_mfma_f32_16x16x32_bf16 v[76:79], a[140:143], a[68:71], v[76:79]
  buffer_load_dwordx4 v254, s[76:79], s44 offen offset:0 sc1 lds
  v_mfma_f32_16x16x32_bf16 v[108:111], a[140:143], a[72:75], v[108:111]
  v_mfma_f32_16x16x32_bf16 v[140:143], a[140:143], a[76:79], v[140:143]
  s_waitcnt lgkmcnt(0)
  v_mfma_f32_16x16x32_bf16 v[0:3], a[160:163], a[176:179], v[0:3]
  ds_read_b64_tr_b16 a[196:197], v22 offset:24576
  ds_read_b64_tr_b16 a[198:199], v22 offset:28672
  v_mfma_f32_16x16x32_bf16 v[32:35], a[160:163], a[180:183], v[32:35]
  ds_read_b128 a[212:215], v18 offset:5120
  ds_read_b128 a[216:219], v18 offset:6144
  v_mfma_f32_16x16x32_bf16 v[64:67], a[160:163], a[184:187], v[64:67]
  ds_read_b128 a[220:223], v18 offset:7168
  ds_read_b128 a[224:227], v18 offset:8192
  v_mfma_f32_16x16x32_bf16 v[96:99], a[160:163], a[188:191], v[96:99]
  ds_read_b128 a[228:231], v18 offset:9216
  ds_read_b64_tr_b16 a[200:201], v23 offset:24576
  v_mfma_f32_16x16x32_bf16 v[128:131], a[160:163], a[192:195], v[128:131]
  ds_read_b64_tr_b16 a[202:203], v23 offset:28672
  ds_read_b64_tr_b16 a[204:205], v22 offset:24832
  v_mfma_f32_16x16x32_bf16 v[4:7], a[164:167], a[176:179], v[4:7]
  ds_read_b64_tr_b16 a[206:207], v22 offset:28928
  ds_read_b64_tr_b16 a[208:209], v23 offset:24832
  v_mfma_f32_16x16x32_bf16 v[36:39], a[164:167], a[180:183], v[36:39]
  ds_read_b64_tr_b16 a[210:211], v23 offset:28928
  v_mfma_f32_16x16x32_bf16 v[68:71], a[164:167], a[184:187], v[68:71]
  v_mfma_f32_16x16x32_bf16 v[100:103], a[164:167], a[188:191], v[100:103]
  v_mfma_f32_16x16x32_bf16 v[132:135], a[164:167], a[192:195], v[132:135]
  v_mfma_f32_16x16x32_bf16 v[8:11], a[168:171], a[176:179], v[8:11]
  v_mfma_f32_16x16x32_bf16 v[40:43], a[168:171], a[180:183], v[40:43]
  v_mfma_f32_16x16x32_bf16 v[72:75], a[168:171], a[184:187], v[72:75]
  v_mfma_f32_16x16x32_bf16 v[104:107], a[168:171], a[188:191], v[104:107]
  v_mfma_f32_16x16x32_bf16 v[136:139], a[168:171], a[192:195], v[136:139]
  v_mfma_f32_16x16x32_bf16 v[12:15], a[172:175], a[176:179], v[12:15]
  v_mfma_f32_16x16x32_bf16 v[44:47], a[172:175], a[180:183], v[44:47]
  v_mfma_f32_16x16x32_bf16 v[76:79], a[172:175], a[184:187], v[76:79]
  v_mfma_f32_16x16x32_bf16 v[108:111], a[172:175], a[188:191], v[108:111]
  v_mfma_f32_16x16x32_bf16 v[140:143], a[172:175], a[192:195], v[140:143]
  s_waitcnt vmcnt(10) lgkmcnt(0)
  s_barrier
  v_readlane_b32 s94, v20, 2
  s_nop 0
  s_sub_u32 s94, s94, s74
  s_cmp_eq_u32 s94, 32
  s_cbranch_scc0 L_cstub2
L_cret2:
  v_mfma_f32_16x16x32_bf16 v[0:3], a[196:199], a[212:215], v[0:3]
  s_add_u32 m0, s96, 16384
  s_add_u32 s42, s70, 0
  v_mfma_f32_16x16x32_bf16 v[32:35], a[196:199], a[216:219], v[32:35]
  buffer_load_dwordx4 v249, s[20:23], s42 offen offset:0 lds
  ds_read_b64_tr_b16 a[160:161], v22 offset:0
  v_mfma_f32_16x16x32_bf16 v[64:67], a[196:199], a[220:223], v[64:67]
  s_add_u32 s42, s70, 3072
  ds_read_b64_tr_b16 a[162:163], v22 offset:4096
  v_mfma_f32_16x16x32_bf16 v[96:99], a[196:199], a[224:227], v[96:99]
  ds_read_b128 a[176:179], v18 offset:20480
  ds_read_b128 a[180:183], v18 offset:21504
  v_mfma_f32_16x16x32_bf16 v[128:131], a[196:199], a[228:231], v[128:131]
  ds_read_b128 a[184:187], v18 offset:22528
  ds_read_b128 a[188:191], v18 offset:23552
  v_mfma_f32_16x16x32_bf16 v[4:7], a[200:203], a[212:215], v[4:7]
  buffer_load_dwordx4 v250, s[20:23], s42 offen offset:1024 lds
  ds_read_b128 a[192:195], v18 offset:24576
  v_mfma_f32_16x16x32_bf16 v[36:39], a[200:203], a[216:219], v[36:39]
  ds_read_b64_tr_b16 a[164:165], v23 offset:0
  ds_read_b64_tr_b16 a[166:167], v23 offset:4096
  v_mfma_f32_16x16x32_bf16 v[68:71], a[200:203], a[220:223], v[68:71]
  s_add_u32 s42, s70, 6144
  ds_read_b64_tr_b16 a[168:169], v22 offset:256
  v_mfma_f32_16x16x32_bf16 v[100:103], a[200:203], a[224:227], v[100:103]
  ds_read_b64_tr_b16 a[170:171], v22 offset:4352
  ds_read_b64_tr_b16 a[172:173], v23 offset:256
  v_mfma_f32_16x16x32_bf16 v[132:135], a[200:203], a[228:231], v[132:135]
  ds_read_b64_tr_b16 a[174:175], v23 offset:4352
  v_mfma_f32_16x16x32_bf16 v[8:11], a[204:207], a[212:215], v[8:11]
  buffer_load_dwordx4 v249, s[20:23], s42 offen offset:2048 lds
  v_mfma_f32_16x16x32_bf16 v[40:43], a[204:207], a[216:219], v[40:43]
  s_add_u32 s42, s70, 9216
  v_mfma_f32_16x16x32_bf16 v[72:75], a[204:207], a[220:223], v[72:75]
  v_mfma_f32_16x16x32_bf16 v[104:107], a[204:207], a[224:227], v[104:107]
  v_mfma_f32_16x16x32_bf16 v[136:139], a[204:207], a[228:231], v[136:139]
  buffer_load_dwordx4 v250, s[20:23], s42 offen offset:3072 lds
  v_mfma_f32_16x16x32_bf16 v[12:15], a[208:211], a[212:215], v[12:15]
  v_mfma_f32_16x16x32_bf16 v[44:47], a[208:211], a[216:219], v[44:47]
  v_mfma_f32_16x16x32_bf16 v[76:79], a[208:211], a[220:223], v[76:79]
  v_mfma_f32_16x16x32_bf16 v[108:111], a[208:211], a[224:227], v[108:111]
  v_mfma_f32_16x16x32_bf16 v[140:143], a[208:211], a[228:231], v[140:143]
  s_waitcnt lgkmcnt(0)
  v_mfma_f32_16x16x32_bf16 v[0:3], a[160:163], a[176:179], v[0:3]
  s_add_u32 m0, s97, 65536
  s_add_u32 s44, s66, 0
  v_mfma_f32_16x16x32_bf16 v[32:35], a[160:163], a[180:183], v[32:35]
  buffer_load_dwordx4 v254, s[76:79], s44 offen offset:0 sc1 lds
  ds_read_b64_tr_b16 a[196:197], v22 offset:8192
  v_mfma_f32_16x16x32_bf16 v[64:67], a[160:163], a[184:187], v[64:67]
  ds_read_b64_tr_b16 a[198:199], v22 offset:12288
  ds_read_b128 a[212:215], v18 offset:25600
  v_mfma_f32_16x16x32_bf16 v[96:99], a[160:163], a[188:191], v[96:99]
  ds_read_b128 a[216:219], v18 offset:26624
  ds_read_b128 a[220:223], v18 offset:27648
  v_mfma_f32_16x16x32_bf16 v[128:131], a[160:163], a[192:195], v[128:131]
  buffer_load_dwordx4 v254, s[76:79], s44 offen offset:1024 sc1 lds
  ds_read_b128 a[224:227], v18 offset:28672
  v_mfma_f32_16x16x32_bf16 v[4:7], a[164:167], a[176:179], v[4:7]
  ds_read_b128 a[228:231], v18 offset:29696
  ds_read_b64_tr_b16 a[200:201], v23 offset:8192
  v_mfma_f32_16x16x32_bf16 v[36:39], a[164:167], a[180:183], v[36:39]
  ds_read_b64_tr_b16 a[202:203], v23 offset:12288
  ds_read_b64_tr_b16 a[204:205], v22 offset:8448
  v_mfma_f32_16x16x32_bf16 v[68:71], a[164:167], a[184:187], v[68:71]
  ds_read_b64_tr_b16 a[206:207], v22 offset:12544
  ds_read_b64_tr_b16 a[208:209], v23 offset:8448
  v_mfma_f32_16x16x32_bf16 v[100:103], a[164:167], a[188:191], v[100:103]
  buffer_load_dwordx4 v254, s[76:79], s44 offen offset:2048 sc1 lds
  ds_read_b64_tr_b16 a[210:211], v23 offset:12544
  v_mfma_f32_16x16x32_bf16 v[132:135], a[164:167], a[192:195], v[132:135]
  v_mfma_f32_16x16x32_bf16 v[8:11], a[168:171], a[176:179], v[8:11]
  v_mfma_f32_16x16x32_bf16 v[40:43], a[168:171], a[180:183], v[40:43]
  buffer_load_dwordx4 v254, s[76:79], s44 offen offset:3072 sc1 lds
  v_mfma_f32_16x16x32_bf16 v[72:75], a[168:171], a[184:187], v[72:75]
  s_add_u32 m0, s97, 69632
  s_add_u32 s44, s66, 4096
  v_mfma_f32_16x16x32_bf16 v[104:107], a[168:171], a[188:191], v[104:107]
  v_mfma_f32_16x16x32_bf16 v[136:139], a[168:171], a[192:195], v[136:139]
  v_mfma_f32_16x16x32_bf16 v[12:15], a[172:175], a[176:179], v[12:15]
  buffer_load_dwordx4 v254, s[76:79], s44 offen offset:0 sc1 lds
  v_mfma_f32_16x16x32_bf16 v[44:47], a[172:175], a[180:183], v[44:47]
  v_mfma_f32_16x16x32_bf16 v[76:79], a[172:175], a[184:187], v[76:79]
  v_mfma_f32_16x16x32_bf16 v[108:111], a[172:175], a[188:191], v[108:111]
  v_mfma_f32_16x16x32_bf16 v[140:143], a[172:175], a[192:195], v[140:143]
  s_waitcnt vmcnt(14) lgkmcnt(0)
  s_barrier
  v_mfma_f32_16x16x32_bf16 v[0:3], a[196:199], a[212:215], v[0:3]
  s_add_u32 m0, s96, 0
  s_add_u32 s42, s70, 65536
  v_mfma_f32_16x16x32_bf16 v[32:35], a[196:199], a[216:219], v[32:35]
  buffer_load_dwordx4 v249, s[20:23], s42 offen offset:0 lds
  ds_read_b64_tr_b16 a[160:161], v22 offset:32768
  v_mfma_f32_16x16x32_bf16 v[64:67], a[196:199], a[220:223], v[64:67]
  s_add_u32 s42, s70, 68608
  ds_read_b64_tr_b16 a[162:163], v22 offset:36864
  v_mfma_f32_16x16x32_bf16 v[96:99], a[196:199], a[224:227], v[96:99]
  ds_read_b128 a[176:179], v19 offset:0
  ds_read_b128 a[180:183], v19 offset:1024
  v_mfma_f32_16x16x32_bf16 v[128:131], a[196:199], a[228:231], v[128:131]
  ds_read_b128 a[184:187], v19 offset:2048
  ds_read_b128 a[188:191], v19 offset:3072
  v_mfma_f32_16x16x32_bf16 v[4:7], a[200:203], a[212:215], v[4:7]
  buffer_load_dwordx4 v250, s[20:23], s42 offen offset:1024 lds
  ds_read_b128 a[192:195], v19 offset:4096
  v_mfma_f32_16x16x32_bf16 v[36:39], a[200:203], a[216:219], v[36:39]
  ds_read_b64_tr_b16 a[164:165], v23 offset:32768
  ds_read_b64_tr_b16 a[166:167], v23 offset:36864
  v_mfma_f32_16x16x32_bf16 v[68:71], a[200:203], a[220:223], v[68:71]
  s_add_u32 s42, s70, 71680
  ds_read_b64_tr_b16 a[168:169], v22 offset:33024
  v_mfma_f32_16x16x32_bf16 v[100:103], a[200:203], a[224:227], v[100:103]
  ds_read_b64_tr_b16 a[170:171], v22 offset:37120
  ds_read_b64_tr_b16 a[172:173], v23 offset:33024
  v_mfma_f32_16x16x32_bf16 v[132:135], a[200:203], a[228:231], v[132:135]
  ds_read_b64_tr_b16 a[174:175], v23 offset:37120
  v_mfma_f32_16x16x32_bf16 v[8:11], a[204:207], a[212:215], v[8:11]
  buffer_load_dwordx4 v249, s[20:23], s42 offen offset:2048 lds
  v_mfma_f32_16x16x32_bf16 v[40:43], a[204:207], a[216:219], v[40:43]
  s_add_u32 s42, s70, 74752
  v_mfma_f32_16x16x32_bf16 v[72:75], a[204:207], a[220:223], v[72:75]
  v_mfma_f32_16x16x32_bf16 v[104:107], a[204:207], a[224:227], v[104:107]
  v_mfma_f32_16x16x32_bf16 v[136:139], a[204:207], a[228:231], v[136:139]
  buffer_load_dwordx4 v250, s[20:23], s42 offen offset:3072 lds
  v_mfma_f32_16x16x32_bf16 v[12:15], a[208:211], a[212:215], v[12:15]
  v_mfma_f32_16x16x32_bf16 v[44:47], a[208:211], a[216:219], v[44:47]
  v_mfma_f32_16x16x32_bf16 v[76:79], a[208:211], a[220:223], v[76:79]
  v_mfma_f32_16x16x32_bf16 v[108:111], a[208:211], a[224:227], v[108:111]
  v_mfma_f32_16x16x32_bf16 v[140:143], a[208:211], a[228:231], v[140:143]
  s_waitcnt lgkmcnt(0)
  v_mfma_f32_16x16x32_bf16 v[0:3], a[160:163], a[176:179], v[0:3]
  s_add_u32 m0, s97, 86016
  s_add_u32 s44, s66, 20480
  v_mfma_f32_16x16x32_bf16 v[32:35], a[160:163], a[180:183], v[32:35]
  buffer_load_dwordx4 v254, s[76:79], s44 offen offset:0 sc1 lds
  ds_read_b64_tr_b16 a[196:197], v22 offset:40960
  v_mfma_f32_16x16x32_bf16 v[64:67], a[160:163], a[184:187], v[64:67]
  ds_read_b64_tr_b16 a[198:199], v22 offset:45056
  ds_read_b128 a[212:215], v19 offset:5120
  v_mfma_f32_16x16x32_bf16 v[96:99], a[160:163], a[188:191], v[96:99]
  ds_read_b128 a[216:219], v19 offset:6144
  ds_read_b128 a[220:223], v19 offset:7168
  v_mfma_f32_16x16x32_bf16 v[128:131], a[160:163], a[192:195], v[128:131]
  buffer_load_dwordx4 v254, s[76:79], s44 offen offset:1024 sc1 lds
  ds_read_b128 a[224:227], v19 offset:8192
  v_mfma_f32_16x16x32_bf16 v[4:7], a[164:167], a[176:179], v[4:7]
  ds_read_b128 a[228:231], v19 offset:9216
  ds_read_b64_tr_b16 a[200:201], v23 offset:40960
  v_mfma_f32_16x16x32_bf16 v[36:39], a[164:167], a[180:183], v[36:39]
  ds_read_b64_tr_b16 a[202:203], v23 offset:45056
  ds_read_b64_tr_b16 a[204:205], v22 offset:41216
  v_mfma_f32_16x16x32_bf16 v[68:71], a[164:167], a[184:187], v[68:71]
  ds_read_b64_tr_b16 a[206:207], v22 offset:45312
  ds_read_b64_tr_b16 a[208:209], v23 offset:41216
  v_mfma_f32_16x16x32_bf16 v[100:103], a[164:167], a[188:191], v[100:103]
  buffer_load_dwordx4 v254, s[76:79], s44 offen offset:2048 sc1 lds
  ds_read_b64_tr_b16 a[210:211], v23 offset:45312
  v_mfma_f32_16x16x32_bf16 v[132:135], a[164:167], a[192:195], v[132:135]
  v_mfma_f32_16x16x32_bf16 v[8:11], a[168:171], a[176:179], v[8:11]
  v_mfma_f32_16x16x32_bf16 v[40:43], a[168:171], a[180:183], v[40:43]
  buffer_load_dwordx4 v254, s[76:79], s44 offen offset:3072 sc1 lds
  v_mfma_f32_16x16x32_bf16 v[72:75], a[168:171], a[184:187], v[72:75]
  s_add_u32 m0, s97, 90112
  s_add_u32 s44, s66, 24576
  v_mfma_f32_16x16x32_bf16 v[104:107], a[168:171], a[188:191], v[104:107]
  v_mfma_f32_16x16x32_bf16 v[136:139], a[168:171], a[192:195], v[136:139]
  v_mfma_f32_16x16x32_bf16 v[12:15], a[172:175], a[176:179], v[12:15]
  buffer_load_dwordx4 v254, s[76:79], s44 offen offset:0 sc1 lds
  v_mfma_f32_16x16x32_bf16 v[44:47], a[172:175], a[180:183], v[44:47]
  v_mfma_f32_16x16x32_bf16 v[76:79], a[172:175], a[184:187], v[76:79]
  v_mfma_f32_16x16x32_bf16 v[108:111], a[172:175], a[188:191], v[108:111]
  v_mfma_f32_16x16x32_bf16 v[140:143], a[172:175], a[192:195], v[140:143]
  s_waitcnt vmcnt(18) lgkmcnt(0)
  s_barrier
  v_mfma_f32_16x16x32_bf16 v[0:3], a[196:199], a[212:215], v[0:3]
  s_add_u32 m0, s96, 32768
  s_add_u32 s42, s70, 131072
  v_mfma_f32_16x16x32_bf16 v[32:35], a[196:199], a[216:219], v[32:35]
  buffer_load_dwordx4 v249, s[20:23], s42 offen offset:0 lds
  ds_read_b64_tr_b16 a[160:161], v22 offset:49152
  v_mfma_f32_16x16x32_bf16 v[64:67], a[196:199], a[220:223], v[64:67]
  s_add_u32 s42, s70, 134144
  ds_read_b64_tr_b16 a[162:163], v22 offset:53248
  v_mfma_f32_16x16x32_bf16 v[96:99], a[196:199], a[224:227], v[96:99]
  ds_read_b128 a[176:179], v19 offset:20480
  ds_read_b128 a[180:183], v19 offset:21504
  v_mfma_f32_16x16x32_bf16 v[128:131], a[196:199], a[228:231], v[128:131]
  ds_read_b128 a[184:187], v19 offset:22528
  ds_read_b128 a[188:191], v19 offset:23552
  v_mfma_f32_16x16x32_bf16 v[4:7], a[200:203], a[212:215], v[4:7]
  buffer_load_dwordx4 v250, s[20:23], s42 offen offset:1024 lds
  ds_read_b128 a[192:195], v19 offset:24576
  v_mfma_f32_16x16x32_bf16 v[36:39], a[200:203], a[216:219], v[36:39]
  ds_read_b64_tr_b16 a[164:165], v23 offset:49152
  ds_read_b64_tr_b16 a[166:167], v23 offset:53248
  v_mfma_f32_16x16x32_bf16 v[68:71], a[200:203], a[220:223], v[68:71]
  s_add_u32 s42, s70, 137216
  ds_read_b64_tr_b16 a[168:169], v22 offset:49408
  v_mfma_f32_16x16x32_bf16 v[100:103], a[200:203], a[224:227], v[100:103]
  ds_read_b64_tr_b16 a[170:171], v22 offset:53504
  ds_read_b64_tr_b16 a[172:173], v23 offset:49408
  v_mfma_f32_16x16x32_bf16 v[132:135], a[200:203], a[228:231], v[132:135]
  ds_read_b64_tr_b16 a[174:175], v23 offset:53504
  v_mfma_f32_16x16x32_bf16 v[8:11], a[204:207], a[212:215], v[8:11]
  buffer_load_dwordx4 v249, s[20:23], s42 offen offset:2048 lds
  v_mfma_f32_16x16x32_bf16 v[40:43], a[204:207], a[216:219], v[40:43]
  s_add_u32 s42, s70, 140288
  v_mfma_f32_16x16x32_bf16 v[72:75], a[204:207], a[220:223], v[72:75]
  v_mfma_f32_16x16x32_bf16 v[104:107], a[204:207], a[224:227], v[104:107]
  v_mfma_f32_16x16x32_bf16 v[136:139], a[204:207], a[228:231], v[136:139]
  buffer_load_dwordx4 v250, s[20:23], s42 offen offset:3072 lds
  v_mfma_f32_16x16x32_bf16 v[12:15], a[208:211], a[212:215], v[12:15]
  v_mfma_f32_16x16x32_bf16 v[44:47], a[208:211], a[216:219], v[44:47]
  v_mfma_f32_16x16x32_bf16 v[76:79], a[208:211], a[220:223], v[76:79]
  v_mfma_f32_16x16x32_bf16 v[108:111], a[208:211], a[224:227], v[108:111]
  v_mfma_f32_16x16x32_bf16 v[140:143], a[208:211], a[228:231], v[140:143]
  s_waitcnt lgkmcnt(0)
  v_mfma_f32_16x16x32_bf16 v[0:3], a[160:163], a[176:179], v[0:3]
  s_add_u32 m0, s97, 106496
  s_add_u32 s44, s66, 40960
  v_mfma_f32_16x16x32_bf16 v[32:35], a[160:163], a[180:183], v[32:35]
  buffer_load_dwordx4 v254, s[76:79], s44 offen offset:0 sc1 lds
  ds_read_b64_tr_b16 a[196:197], v22 offset:57344
  v_mfma_f32_16x16x32_bf16 v[64:67], a[160:163], a[184:187], v[64:67]
  ds_read_b64_tr_b16 a[198:199], v22 offset:61440
  ds_read_b128 a[212:215], v19 offset:25600
  v_mfma_f32_16x16x32_bf16 v[96:99], a[160:163], a[188:191], v[96:99]
  ds_read_b128 a[216:219], v19 offset:26624
  ds_read_b128 a[220:223], v19 offset:27648
  v_mfma_f32_16x16x32_bf16 v[128:131], a[160:163], a[192:195], v[128:131]
  buffer_load_dwordx4 v254, s[76:79], s44 offen offset:1024 sc1 lds
  ds_read_b128 a[224:227], v19 offset:28672
  v_mfma_f32_16x16x32_bf16 v[4:7], a[164:167], a[176:179], v[4:7]
  ds_read_b128 a[228:231], v19 offset:29696
  ds_read_b64_tr_b16 a[200:201], v23 offset:57344
  v_mfma_f32_16x16x32_bf16 v[36:39], a[164:167], a[180:183], v[36:39]
  ds_read_b64_tr_b16 a[202:203], v23 offset:61440
  ds_read_b64_tr_b16 a[204:205], v22 offset:57600
  v_mfma_f32_16x16x32_bf16 v[68:71], a[164:167], a[184:187], v[68:71]
  ds_read_b64_tr_b16 a[206:207], v22 offset:61696
  ds_read_b64_tr_b16 a[208:209], v23 offset:57600
  v_mfma_f32_16x16x32_bf16 v[100:103], a[164:167], a[188:191], v[100:103]
  buffer_load_dwordx4 v254, s[76:79], s44 offen offset:2048 sc1 lds
  ds_read_b64_tr_b16 a[210:211], v23 offset:61696
  v_mfma_f32_16x16x32_bf16 v[132:135], a[164:167], a[192:195], v[132:135]
  v_mfma_f32_16x16x32_bf16 v[8:11], a[168:171], a[176:179], v[8:11]
  v_mfma_f32_16x16x32_bf16 v[40:43], a[168:171], a[180:183], v[40:43]
  buffer_load_dwordx4 v254, s[76:79], s44 offen offset:3072 sc1 lds
  v_mfma_f32_16x16x32_bf16 v[72:75], a[168:171], a[184:187], v[72:75]
  s_add_u32 m0, s97, 110592
  s_add_u32 s44, s66, 45056
  v_mfma_f32_16x16x32_bf16 v[104:107], a[168:171], a[188:191], v[104:107]
  v_mfma_f32_16x16x32_bf16 v[136:139], a[168:171], a[192:195], v[136:139]
  v_mfma_f32_16x16x32_bf16 v[12:15], a[172:175], a[176:179], v[12:15]
  buffer_load_dwordx4 v254, s[76:79], s44 offen offset:0 sc1 lds
  v_mfma_f32_16x16x32_bf16 v[44:47], a[172:175], a[180:183], v[44:47]
  v_mfma_f32_16x16x32_bf16 v[76:79], a[172:175], a[184:187], v[76:79]
  v_mfma_f32_16x16x32_bf16 v[108:111], a[172:175], a[188:191], v[108:111]
  v_mfma_f32_16x16x32_bf16 v[140:143], a[172:175], a[192:195], v[140:143]
  s_waitcnt vmcnt(18) lgkmcnt(0)
  s_barrier
  v_mfma_f32_16x16x32_bf16 v[0:3], a[196:199], a[212:215], v[0:3]
  s_add_u32 m0, s96, 49152
  s_add_u32 s42, s70, 196608
  v_mfma_f32_16x16x32_bf16 v[32:35], a[196:199], a[216:219], v[32:35]
  buffer_load_dwordx4 v249, s[20:23], s42 offen offset:0 lds
  ds_read_b64_tr_b16 a[160:161], v22 offset:16384
  v_mfma_f32_16x16x32_bf16 v[64:67], a[196:199], a[220:223], v[64:67]
  s_add_u32 s42, s70, 199680
  ds_read_b64_tr_b16 a[162:163], v22 offset:20480
  v_mfma_f32_16x16x32_bf16 v[96:99], a[196:199], a[224:227], v[96:99]
  ds_read_b128 a[176:179], v18 offset:0
  ds_read_b128 a[180:183], v18 offset:1024
  v_mfma_f32_16x16x32_bf16 v[128:131], a[196:199], a[228:231], v[128:131]
  ds_read_b128 a[184:187], v18 offset:2048
  ds_read_b128 a[188:191], v18 offset:3072
  v_mfma_f32_16x16x32_bf16 v[4:7], a[200:203], a[212:215], v[4:7]
  buffer_load_dwordx4 v250, s[20:23], s42 offen offset:1024 lds
  ds_read_b128 a[192:195], v18 offset:4096
  v_mfma_f32_16x16x32_bf16 v[36:39], a[200:203], a[216:219], v[36:39]
  ds_read_b64_tr_b16 a[164:165], v23 offset:16384
  ds_read_b64_tr_b16 a[166:167], v23 offset:20480
  v_mfma_f32_16x16x32_bf16 v[68:71], a[200:203], a[220:223], v[68:71]
  s_add_u32 s42, s70, 202752
  ds_read_b64_tr_b16 a[168:169], v22 offset:16640
  v_mfma_f32_16x16x32_bf16 v[100:103], a[200:203], a[224:227], v[100:103]
  ds_read_b64_tr_b16 a[170:171], v22 offset:20736
  ds_read_b64_tr_b16 a[172:173], v23 offset:16640
  v_mfma_f32_16x16x32_bf16 v[132:135], a[200:203], a[228:231], v[132:135]
  ds_read_b64_tr_b16 a[174:175], v23 offset:20736
  v_mfma_f32_16x16x32_bf16 v[8:11], a[204:207], a[212:215], v[8:11]
  buffer_load_dwordx4 v249, s[20:23], s42 offen offset:2048 lds
  v_mfma_f32_16x16x32_bf16 v[40:43], a[204:207], a[216:219], v[40:43]
  s_add_u32 s42, s70, 205824
  v_mfma_f32_16x16x32_bf16 v[72:75], a[204:207], a[220:223], v[72:75]
  v_mfma_f32_16x16x32_bf16 v[104:107], a[204:207], a[224:227], v[104:107]
  v_mfma_f32_16x16x32_bf16 v[136:139], a[204:207], a[228:231], v[136:139]
  buffer_load_dwordx4 v250, s[20:23], s42 offen offset:3072 lds
  v_mfma_f32_16x16x32_bf16 v[12:15], a[208:211], a[212:215], v[12:15]
  v_mfma_f32_16x16x32_bf16 v[44:47], a[208:211], a[216:219], v[44:47]
  v_mfma_f32_16x16x32_bf16 v[76:79], a[208:211], a[220:223], v[76:79]
  v_mfma_f32_16x16x32_bf16 v[108:111], a[208:211], a[224:227], v[108:111]
  v_mfma_f32_16x16x32_bf16 v[140:143], a[208:211], a[228:231], v[140:143]
  s_waitcnt lgkmcnt(0)
  v_mfma_f32_16x16x32_bf16 v[0:3], a[160:163], a[176:179], v[0:3]
  s_add_u32 m0, s97, 126976
  s_add_u32 s44, s66, 61440
  v_mfma_f32_16x16x32_bf16 v[32:35], a[160:163], a[180:183], v[32:35]
  buffer_load_dwordx4 v254, s[76:79], s44 offen offset:0 sc1 lds
  ds_read_b64_tr_b16 a[196:197], v22 offset:24576
  v_mfma_f32_16x16x32_bf16 v[64:67], a[160:163], a[184:187], v[64:67]
  ds_read_b64_tr_b16 a[198:199], v22 offset:28672
  ds_read_b128 a[212:215], v18 offset:5120
  v_mfma_f32_16x16x32_bf16 v[96:99], a[160:163], a[188:191], v[96:99]
  ds_read_b128 a[216:219], v18 offset:6144
  ds_read_b128 a[220:223], v18 offset:7168
  v_mfma_f32_16x16x32_bf16 v[128:131], a[160:163], a[192:195], v[128:131]
  buffer_load_dwordx4 v254, s[76:79], s44 offen offset:1024 sc1 lds
  ds_read_b128 a[224:227], v18 offset:8192
  v_mfma_f32_16x16x32_bf16 v[4:7], a[164:167], a[176:179], v[4:7]
  ds_read_b128 a[228:231], v18 offset:9216
  ds_read_b64_tr_b16 a[200:201], v23 offset:24576
  v_mfma_f32_16x16x32_bf16 v[36:39], a[164:167], a[180:183], v[36:39]
  ds_read_b64_tr_b16 a[202:203], v23 offset:28672
  ds_read_b64_tr_b16 a[204:205], v22 offset:24832
  v_mfma_f32_16x16x32_bf16 v[68:71], a[164:167], a[184:187], v[68:71]
  ds_read_b64_tr_b16 a[206:207], v22 offset:28928
  ds_read_b64_tr_b16 a[208:209], v23 offset:24832
  v_mfma_f32_16x16x32_bf16 v[100:103], a[164:167], a[188:191], v[100:103]
  buffer_load_dwordx4 v254, s[76:79], s44 offen offset:2048 sc1 lds
  ds_read_b64_tr_b16 a[210:211], v23 offset:28928
  v_mfma_f32_16x16x32_bf16 v[132:135], a[164:167], a[192:195], v[132:135]
  v_mfma_f32_16x16x32_bf16 v[8:11], a[168:171], a[176:179], v[8:11]
  v_mfma_f32_16x16x32_bf16 v[40:43], a[168:171], a[180:183], v[40:43]
  buffer_load_dwordx4 v254, s[76:79], s44 offen offset:3072 sc1 lds
  v_mfma_f32_16x16x32_bf16 v[72:75], a[168:171], a[184:187], v[72:75]
  s_add_u32 m0, s97, 131072
  s_add_u32 s44, s66, 65536
  v_mfma_f32_16x16x32_bf16 v[104:107], a[168:171], a[188:191], v[104:107]
  v_mfma_f32_16x16x32_bf16 v[136:139], a[168:171], a[192:195], v[136:139]
  v_mfma_f32_16x16x32_bf16 v[12:15], a[172:175], a[176:179], v[12:15]
  buffer_load_dwordx4 v254, s[76:79], s44 offen offset:0 sc1 lds
  v_mfma_f32_16x16x32_bf16 v[44:47], a[172:175], a[180:183], v[44:47]
  v_mfma_f32_16x16x32_bf16 v[76:79], a[172:175], a[184:187], v[76:79]
  v_mfma_f32_16x16x32_bf16 v[108:111], a[172:175], a[188:191], v[108:111]
  v_mfma_f32_16x16x32_bf16 v[140:143], a[172:175], a[192:195], v[140:143]
  s_waitcnt vmcnt(18) lgkmcnt(0)
  s_barrier
  v_readlane_b32 s94, v20, 3
  s_nop 0
  s_sub_u32 s94, s94, s75
  s_cmp_eq_u32 s94, 32
  s_cbranch_scc0 L_cstub3
L_cret3:
  v_mfma_f32_16x16x32_bf16 v[0:3], a[196:199], a[212:215], v[0:3]
  s_add_u32 m0, s96, 16384
  s_add_u32 s42, s71, 0
  v_mfma_f32_16x16x32_bf16 v[32:35], a[196:199], a[216:219], v[32:35]
  buffer_load_dwordx4 v249, s[20:23], s42 offen offset:0 lds
  ds_read_b64_tr_b16 a[160:161], v22 offset:0
  v_mfma_f32_16x16x32_bf16 v[64:67], a[196:199], a[220:223], v[64:67]
  s_add_u32 s42, s71, 3072
  ds_read_b64_tr_b16 a[162:163], v22 offset:4096
  v_mfma_f32_16x16x32_bf16 v[96:99], a[196:199], a[224:227], v[96:99]
  ds_read_b128 a[176:179], v18 offset:20480
  ds_read_b128 a[180:183], v18 offset:21504
  v_mfma_f32_16x16x32_bf16 v[128:131], a[196:199], a[228:231], v[128:131]
  ds_read_b128 a[184:187], v18 offset:22528
  ds_read_b128 a[188:191], v18 offset:23552
  v_mfma_f32_16x16x32_bf16 v[4:7], a[200:203], a[212:215], v[4:7]
  buffer_load_dwordx4 v250, s[20:23], s42 offen offset:1024 lds
  ds_read_b128 a[192:195], v18 offset:24576
  v_mfma_f32_16x16x32_bf16 v[36:39], a[200:203], a[216:219], v[36:39]
  ds_read_b64_tr_b16 a[164:165], v23 offset:0
  ds_read_b64_tr_b16 a[166:167], v23 offset:4096
  v_mfma_f32_16x16x32_bf16 v[68:71], a[200:203], a[220:223], v[68:71]
  s_add_u32 s42, s71, 6144
  ds_read_b64_tr_b16 a[168:169], v22 offset:256
  v_mfma_f32_16x16x32_bf16 v[100:103], a[200:203], a[224:227], v[100:103]
  ds_read_b64_tr_b16 a[170:171], v22 offset:4352
  ds_read_b64_tr_b16 a[172:173], v23 offset:256
  v_mfma_f32_16x16x32_bf16 v[132:135], a[200:203], a[228:231], v[132:135]
  ds_read_b64_tr_b16 a[174:175], v23 offset:4352
  v_mfma_f32_16x16x32_bf16 v[8:11], a[204:207], a[212:215], v[8:11]
  buffer_load_dwordx4 v249, s[20:23], s42 offen offset:2048 lds
  v_mfma_f32_16x16x32_bf16 v[40:43], a[204:207], a[216:219], v[40:43]
  s_add_u32 s42, s71, 9216
  v_mfma_f32_16x16x32_bf16 v[72:75], a[204:207], a[220:223], v[72:75]
  v_mfma_f32_16x16x32_bf16 v[104:107], a[204:207], a[224:227], v[104:107]
  v_mfma_f32_16x16x32_bf16 v[136:139], a[204:207], a[228:231], v[136:139]
  buffer_load_dwordx4 v250, s[20:23], s42 offen offset:3072 lds
  v_mfma_f32_16x16x32_bf16 v[12:15], a[208:211], a[212:215], v[12:15]
  v_mfma_f32_16x16x32_bf16 v[44:47], a[208:211], a[216:219], v[44:47]
  v_mfma_f32_16x16x32_bf16 v[76:79], a[208:211], a[220:223], v[76:79]
  v_mfma_f32_16x16x32_bf16 v[108:111], a[208:211], a[224:227], v[108:111]
  v_mfma_f32_16x16x32_bf16 v[140:143], a[208:211], a[228:231], v[140:143]
  s_waitcnt lgkmcnt(0)
  v_mfma_f32_16x16x32_bf16 v[0:3], a[160:163], a[176:179], v[0:3]
  s_add_u32 m0, s97, 65536
  s_add_u32 s44, s67, 0
  v_mfma_f32_16x16x32_bf16 v[32:35], a[160:163], a[180:183], v[32:35]
  buffer_load_dwordx4 v254, s[76:79], s44 offen offset:0 sc1 lds
  ds_read_b64_tr_b16 a[196:197], v22 offset:8192
  v_mfma_f32_16x16x32_bf16 v[64:67], a[160:163], a[184:187], v[64:67]
  ds_read_b64_tr_b16 a[198:199], v22 offset:12288
  ds_read_b128 a[212:215], v18 offset:25600
  v_mfma_f32_16x16x32_bf16 v[96:99], a[160:163], a[188:191], v[96:99]
  ds_read_b128 a[216:219], v18 offset:26624
  ds_read_b128 a[220:223], v18 offset:27648
  v_mfma_f32_16x16x32_bf16 v[128:131], a[160:163], a[192:195], v[128:131]
  buffer_load_dwordx4 v254, s[76:79], s44 offen offset:1024 sc1 lds
  ds_read_b128 a[224:227], v18 offset:28672
  v_mfma_f32_16x16x32_bf16 v[4:7], a[164:167], a[176:179], v[4:7]
  ds_read_b128 a[228:231], v18 offset:29696
  ds_read_b64_tr_b16 a[200:201], v23 offset:8192
  v_mfma_f32_16x16x32_bf16 v[36:39], a[164:167], a[180:183], v[36:39]
  ds_read_b64_tr_b16 a[202:203], v23 offset:12288
  ds_read_b64_tr_b16 a[204:205], v22 offset:8448
  v_mfma_f32_16x16x32_bf16 v[68:71], a[164:167], a[184:187], v[68:71]
  ds_read_b64_tr_b16 a[206:207], v22 offset:12544
  ds_read_b64_tr_b16 a[208:209], v23 offset:8448
  v_mfma_f32_16x16x32_bf16 v[100:103], a[164:167], a[188:191], v[100:103]
  buffer_load_dwordx4 v254, s[76:79], s44 offen offset:2048 sc1 lds
  ds_read_b64_tr_b16 a[210:211], v23 offset:12544
  v_mfma_f32_16x16x32_bf16 v[132:135], a[164:167], a[192:195], v[132:135]
  v_mfma_f32_16x16x32_bf16 v[8:11], a[168:171], a[176:179], v[8:11]
  v_mfma_f32_16x16x32_bf16 v[40:43], a[168:171], a[180:183], v[40:43]
  buffer_load_dwordx4 v254, s[76:79], s44 offen offset:3072 sc1 lds
  v_mfma_f32_16x16x32_bf16 v[72:75], a[168:171], a[184:187], v[72:75]
  s_add_u32 m0, s97, 69632
  s_add_u32 s44, s67, 4096
  v_mfma_f32_16x16x32_bf16 v[104:107], a[168:171], a[188:191], v[104:107]
  v_mfma_f32_16x16x32_bf16 v[136:139], a[168:171], a[192:195], v[136:139]
  v_mfma_f32_16x16x32_bf16 v[12:15], a[172:175], a[176:179], v[12:15]
  buffer_load_dwordx4 v254, s[76:79], s44 offen offset:0 sc1 lds
  v_mfma_f32_16x16x32_bf16 v[44:47], a[172:175], a[180:183], v[44:47]
  v_mfma_f32_16x16x32_bf16 v[76:79], a[172:175], a[184:187], v[76:79]
  v_mfma_f32_16x16x32_bf16 v[108:111], a[172:175], a[188:191], v[108:111]
  v_mfma_f32_16x16x32_bf16 v[140:143], a[172:175], a[192:195], v[140:143]
  s_waitcnt vmcnt(18) lgkmcnt(0)
  s_barrier
  v_mfma_f32_16x16x32_bf16 v[0:3], a[196:199], a[212:215], v[0:3]
  s_add_u32 m0, s96, 0
  s_add_u32 s42, s71, 65536
  v_mfma_f32_16x16x32_bf16 v[32:35], a[196:199], a[216:219], v[32:35]
  buffer_load_dwordx4 v249, s[20:23], s42 offen offset:0 lds
  ds_read_b64_tr_b16 a[160:161], v22 offset:32768
  v_mfma_f32_16x16x32_bf16 v[64:67], a[196:199], a[220:223], v[64:67]
  s_add_u32 s42, s71, 68608
  ds_read_b64_tr_b16 a[162:163], v22 offset:36864
  v_mfma_f32_16x16x32_bf16 v[96:99], a[196:199], a[224:227], v[96:99]
  ds_read_b128 a[176:179], v19 offset:0
  ds_read_b128 a[180:183], v19 offset:1024
  v_mfma_f32_16x16x32_bf16 v[128:131], a[196:199], a[228:231], v[128:131]
  ds_read_b128 a[184:187], v19 offset:2048
  ds_read_b128 a[188:191], v19 offset:3072
  v_mfma_f32_16x16x32_bf16 v[4:7], a[200:203], a[212:215], v[4:7]
  buffer_load_dwordx4 v250, s[20:23], s42 offen offset:1024 lds
  ds_read_b128 a[192:195], v19 offset:4096
  v_mfma_f32_16x16x32_bf16 v[36:39], a[200:203], a[216:219], v[36:39]
  ds_read_b64_tr_b16 a[164:165], v23 offset:32768
  ds_read_b64_tr_b16 a[166:167], v23 offset:36864
  v_mfma_f32_16x16x32_bf16 v[68:71], a[200:203], a[220:223], v[68:71]
  s_add_u32 s42, s71, 71680
  ds_read_b64_tr_b16 a[168:169], v22 offset:33024
  v_mfma_f32_16x16x32_bf16 v[100:103], a[200:203], a[224:227], v[100:103]
  ds_read_b64_tr_b16 a[170:171], v22 offset:37120
  ds_read_b64_tr_b16 a[172:173], v23 offset:33024
  v_mfma_f32_16x16x32_bf16 v[132:135], a[200:203], a[228:231], v[132:135]
  ds_read_b64_tr_b16 a[174:175], v23 offset:37120
  v_mfma_f32_16x16x32_bf16 v[8:11], a[204:207], a[212:215], v[8:11]
  buffer_load_dwordx4 v249, s[20:23], s42 offen offset:2048 lds
  v_mfma_f32_16x16x32_bf16 v[40:43], a[204:207], a[216:219], v[40:43]
  s_add_u32 s42, s71, 74752
  v_mfma_f32_16x16x32_bf16 v[72:75], a[204:207], a[220:223], v[72:75]
  v_mfma_f32_16x16x32_bf16 v[104:107], a[204:207], a[224:227], v[104:107]
  v_mfma_f32_16x16x32_bf16 v[136:139], a[204:207], a[228:231], v[136:139]
  buffer_load_dwordx4 v250, s[20:23], s42 offen offset:3072 lds
  v_mfma_f32_16x16x32_bf16 v[12:15], a[208:211], a[212:215], v[12:15]
  v_mfma_f32_16x16x32_bf16 v[44:47], a[208:211], a[216:219], v[44:47]
  v_mfma_f32_16x16x32_bf16 v[76:79], a[208:211], a[220:223], v[76:79]
  v_mfma_f32_16x16x32_bf16 v[108:111], a[208:211], a[224:227], v[108:111]
  v_mfma_f32_16x16x32_bf16 v[140:143], a[208:211], a[228:231], v[140:143]
  s_waitcnt lgkmcnt(0)
  v_mfma_f32_16x16x32_bf16 v[0:3], a[160:163], a[176:179], v[0:3]
  s_add_u32 m0, s97, 86016
  s_add_u32 s44, s67, 20480
  v_mfma_f32_16x16x32_bf16 v[32:35], a[160:163], a[180:183], v[32:35]
  buffer_load_dwordx4 v254, s[76:79], s44 offen offset:0 sc1 lds
  ds_read_b64_tr_b16 a[196:197], v22 offset:40960
  v_mfma_f32_16x16x32_bf16 v[64:67], a[160:163], a[184:187], v[64:67]
  ds_read_b64_tr_b16 a[198:199], v22 offset:45056
  ds_read_b128 a[212:215], v19 offset:5120
  v_mfma_f32_16x16x32_bf16 v[96:99], a[160:163], a[188:191], v[96:99]
  ds_read_b128 a[216:219], v19 offset:6144
  ds_read_b128 a[220:223], v19 offset:7168
  v_mfma_f32_16x16x32_bf16 v[128:131], a[160:163], a[192:195], v[128:131]
  buffer_load_dwordx4 v254, s[76:79], s44 offen offset:1024 sc1 lds
  ds_read_b128 a[224:227], v19 offset:8192
  v_mfma_f32_16x16x32_bf16 v[4:7], a[164:167], a[176:179], v[4:7]
  ds_read_b128 a[228:231], v19 offset:9216
  ds_read_b64_tr_b16 a[200:201], v23 offset:40960
  v_mfma_f32_16x16x32_bf16 v[36:39], a[164:167], a[180:183], v[36:39]
  ds_read_b64_tr_b16 a[202:203], v23 offset:45056
  ds_read_b64_tr_b16 a[204:205], v22 offset:41216
  v_mfma_f32_16x16x32_bf16 v[68:71], a[164:167], a[184:187], v[68:71]
  ds_read_b64_tr_b16 a[206:207], v22 offset:45312
  ds_read_b64_tr_b16 a[208:209], v23 offset:41216
  v_mfma_f32_16x16x32_bf16 v[100:103], a[164:167], a[188:191], v[100:103]
  buffer_load_dwordx4 v254, s[76:79], s44 offen offset:2048 sc1 lds
  ds_read_b64_tr_b16 a[210:211], v23 offset:45312
  v_mfma_f32_16x16x32_bf16 v[132:135], a[164:167], a[192:195], v[132:135]
  s_mov_b32 s14, 2621440
  s_mov_b64 s[12:13], s[16:17]
  v_mfma_f32_16x16x32_bf16 v[8:11], a[168:171], a[176:179], v[8:11]
  s_mul_i32 s37, s39, 2560
  s_add_u32 s37, s37, s38
  v_mfma_f32_16x16x32_bf16 v[40:43], a[168:171], a[180:183], v[40:43]
  buffer_load_dwordx4 v254, s[76:79], s44 offen offset:3072 sc1 lds
  s_lshr_b32 s54, s58, 2
  v_mfma_f32_16x16x32_bf16 v[72:75], a[168:171], a[184:187], v[72:75]
  s_add_u32 m0, s97, 90112
  s_add_u32 s44, s67, 24576
  v_mfma_f32_16x16x32_bf16 v[104:107], a[168:171], a[188:191], v[104:107]
  s_and_b32 s54, s54, 7
  s_mul_i32 s54, s54, 160
  v_mfma_f32_16x16x32_bf16 v[136:139], a[168:171], a[192:195], v[136:139]
  s_mul_i32 s55, s29, 80
  v_mfma_f32_16x16x32_bf16 v[12:15], a[172:175], a[176:179], v[12:15]
  buffer_load_dwordx4 v254, s[76:79], s44 offen offset:0 sc1 lds
  v_mfma_f32_16x16x32_bf16 v[44:47], a[172:175], a[180:183], v[44:47]
  v_mfma_f32_16x16x32_bf16 v[76:79], a[172:175], a[184:187], v[76:79]
  v_mfma_f32_16x16x32_bf16 v[108:111], a[172:175], a[188:191], v[108:111]
  v_mfma_f32_16x16x32_bf16 v[140:143], a[172:175], a[192:195], v[140:143]
  s_waitcnt vmcnt(18) lgkmcnt(0)
  s_barrier
  v_mfma_f32_16x16x32_bf16 v[0:3], a[196:199], a[212:215], v[0:3]
  s_add_u32 m0, s96, 32768
  s_add_u32 s42, s71, 131072
  v_mfma_f32_16x16x32_bf16 v[32:35], a[196:199], a[216:219], v[32:35]
  buffer_load_dwordx4 v249, s[20:23], s42 offen offset:0 lds
  ds_read_b64_tr_b16 a[160:161], v22 offset:49152
  v_mfma_f32_16x16x32_bf16 v[64:67], a[196:199], a[220:223], v[64:67]
  s_add_u32 s42, s71, 134144
  ds_read_b64_tr_b16 a[162:163], v22 offset:53248
  v_mfma_f32_16x16x32_bf16 v[96:99], a[196:199], a[224:227], v[96:99]
  ds_read_b128 a[176:179], v19 offset:20480
  ds_read_b128 a[180:183], v19 offset:21504
  v_mfma_f32_16x16x32_bf16 v[128:131], a[196:199], a[228:231], v[128:131]
  ds_read_b128 a[184:187], v19 offset:22528
  ds_read_b128 a[188:191], v19 offset:23552
  v_mfma_f32_16x16x32_bf16 v[4:7], a[200:203], a[212:215], v[4:7]
  buffer_load_dwordx4 v250, s[20:23], s42 offen offset:1024 lds
  ds_read_b128 a[192:195], v19 offset:24576
  v_mfma_f32_16x16x32_bf16 v[36:39], a[200:203], a[216:219], v[36:39]
  ds_read_b64_tr_b16 a[164:165], v23 offset:49152
  ds_read_b64_tr_b16 a[166:167], v23 offset:53248
  v_mfma_f32_16x16x32_bf16 v[68:71], a[200:203], a[220:223], v[68:71]
  s_add_u32 s42, s71, 137216
  ds_read_b64_tr_b16 a[168:169], v22 offset:49408
  v_mfma_f32_16x16x32_bf16 v[100:103], a[200:203], a[224:227], v[100:103]
  ds_read_b64_tr_b16 a[170:171], v22 offset:53504
  ds_read_b64_tr_b16 a[172:173], v23 offset:49408
  v_mfma_f32_16x16x32_bf16 v[132:135], a[200:203], a[228:231], v[132:135]
  ds_read_b64_tr_b16 a[174:175], v23 offset:53504
  s_add_u32 s54, s54, s55
  v_mfma_f32_16x16x32_bf16 v[8:11], a[204:207], a[212:215], v[8:11]
  buffer_load_dwordx4 v249, s[20:23], s42 offen offset:2048 lds
  s_lshl_b32 s54, s54, 11
  v_mfma_f32_16x16x32_bf16 v[40:43], a[204:207], a[216:219], v[40:43]
  s_add_u32 s42, s71, 140288
  s_lshr_b32 s55, s58, 5
  v_mfma_f32_16x16x32_bf16 v[72:75], a[204:207], a[220:223], v[72:75]
  s_lshl_b32 s55, s55, 10
  s_add_u32 s54, s54, s55
  v_mfma_f32_16x16x32_bf16 v[104:107], a[204:207], a[224:227], v[104:107]
  s_lshl_b32 s55, s49, 8
  s_add_u32 s54, s54, s55
  v_mfma_f32_16x16x32_bf16 v[136:139], a[204:207], a[228:231], v[136:139]
  buffer_load_dwordx4 v250, s[20:23], s42 offen offset:3072 lds
  s_lshl_b32 s55, s28, 7
  v_mfma_f32_16x16x32_bf16 v[12:15], a[208:211], a[212:215], v[12:15]
  v_mfma_f32_16x16x32_bf16 v[44:47], a[208:211], a[216:219], v[44:47]
  v_mfma_f32_16x16x32_bf16 v[76:79], a[208:211], a[220:223], v[76:79]
  v_mfma_f32_16x16x32_bf16 v[108:111], a[208:211], a[224:227], v[108:111]
  v_mfma_f32_16x16x32_bf16 v[140:143], a[208:211], a[228:231], v[140:143]
  s_waitcnt lgkmcnt(0)
  v_mfma_f32_16x16x32_bf16 v[0:3], a[160:163], a[176:179], v[0:3]
  s_add_u32 m0, s97, 106496
  s_add_u32 s44, s67, 40960
  v_mfma_f32_16x16x32_bf16 v[32:35], a[160:163], a[180:183], v[32:35]
  buffer_load_dwordx4 v254, s[76:79], s44 offen offset:0 sc1 lds
  ds_read_b64_tr_b16 a[196:197], v22 offset:57344
  v_mfma_f32_16x16x32_bf16 v[64:67], a[160:163], a[184:187], v[64:67]
  ds_read_b64_tr_b16 a[198:199], v22 offset:61440
  ds_read_b128 a[212:215], v19 offset:25600
  v_mfma_f32_16x16x32_bf16 v[96:99], a[160:163], a[188:191], v[96:99]
  ds_read_b128 a[216:219], v19 offset:26624
  ds_read_b128 a[220:223], v19 offset:27648
  v_mfma_f32_16x16x32_bf16 v[128:131], a[160:163], a[192:195], v[128:131]
  buffer_load_dwordx4 v254, s[76:79], s44 offen offset:1024 sc1 lds
  ds_read_b128 a[224:227], v19 offset:28672
  v_mfma_f32_16x16x32_bf16 v[4:7], a[164:167], a[176:179], v[4:7]
  ds_read_b128 a[228:231], v19 offset:29696
  ds_read_b64_tr_b16 a[200:201], v23 offset:57344
  v_mfma_f32_16x16x32_bf16 v[36:39], a[164:167], a[180:183], v[36:39]
  ds_read_b64_tr_b16 a[202:203], v23 offset:61440
  ds_read_b64_tr_b16 a[204:205], v22 offset:57600
  v_mfma_f32_16x16x32_bf16 v[68:71], a[164:167], a[184:187], v[68:71]
  ds_read_b64_tr_b16 a[206:207], v22 offset:61696
  ds_read_b64_tr_b16 a[208:209], v23 offset:57600
  v_mfma_f32_16x16x32_bf16 v[100:103], a[164:167], a[188:191], v[100:103]
  buffer_load_dwordx4 v254, s[76:79], s44 offen offset:2048 sc1 lds
  s_add_u32 s54, s54, s55
  v_mfma_f32_16x16x32_bf16 v[132:135], a[164:167], a[192:195], v[132:135]
  ds_read_b64_tr_b16 a[210:211], v23 offset:61696
  v_mfma_f32_16x16x32_bf16 v[8:11], a[168:171], a[176:179], v[8:11]
  s_cmp_eq_u32 s39, 0
  s_cselect_b32 s55, s0, s55
  v_mfma_f32_16x16x32_bf16 v[40:43], a[168:171], a[180:183], v[40:43]
  buffer_load_dwordx4 v254, s[76:79], s44 offen offset:3072 sc1 lds
  v_mfma_f32_16x16x32_bf16 v[72:75], a[168:171], a[184:187], v[72:75]
  s_add_u32 m0, s97, 110592
  s_add_u32 s44, s67, 45056
  v_mfma_f32_16x16x32_bf16 v[104:107], a[168:171], a[188:191], v[104:107]
  s_cmp_eq_u32 s39, 1
  s_cselect_b32 s55, s1, s55
  v_mfma_f32_16x16x32_bf16 v[136:139], a[168:171], a[192:195], v[136:139]
  s_cmp_eq_u32 s39, 2
  s_cselect_b32 s55, s93, s55
  v_mfma_f32_16x16x32_bf16 v[12:15], a[172:175], a[176:179], v[12:15]
  buffer_load_dwordx4 v254, s[76:79], s44 offen offset:0 sc1 lds
  v_mfma_f32_16x16x32_bf16 v[44:47], a[172:175], a[180:183], v[44:47]
  s_cmp_eq_u32 s39, 3
  s_cselect_b32 s55, s36, s55
  v_mfma_f32_16x16x32_bf16 v[76:79], a[172:175], a[184:187], v[76:79]
  s_add_u32 s55, s55, 1
  v_mov_b32 v21, s55
  v_mfma_f32_16x16x32_bf16 v[108:111], a[172:175], a[188:191], v[108:111]
  s_add_u32 s55, s55, 1
  v_mfma_f32_16x16x32_bf16 v[140:143], a[172:175], a[192:195], v[140:143]
  s_waitcnt vmcnt(18) lgkmcnt(0)
  s_barrier
  v_mfma_f32_16x16x32_bf16 v[0:3], a[196:199], a[212:215], v[0:3]
  s_add_u32 m0, s96, 49152
  s_add_u32 s42, s71, 196608
  v_mfma_f32_16x16x32_bf16 v[32:35], a[196:199], a[216:219], v[32:35]
  buffer_load_dwordx4 v249, s[20:23], s42 offen offset:0 lds
  ds_read_b64_tr_b16 a[160:161], v22 offset:16384
  v_mfma_f32_16x16x32_bf16 v[64:67], a[196:199], a[220:223], v[64:67]
  s_add_u32 s42, s71, 199680
  ds_read_b64_tr_b16 a[162:163], v22 offset:20480
  v_mfma_f32_16x16x32_bf16 v[96:99], a[196:199], a[224:227], v[96:99]
  ds_read_b128 a[176:179], v18 offset:0
  ds_read_b128 a[180:183], v18 offset:1024
  v_mfma_f32_16x16x32_bf16 v[128:131], a[196:199], a[228:231], v[128:131]
  ds_read_b128 a[184:187], v18 offset:2048
  ds_read_b128 a[188:191], v18 offset:3072
  v_mfma_f32_16x16x32_bf16 v[4:7], a[200:203], a[212:215], v[4:7]
  buffer_load_dwordx4 v250, s[20:23], s42 offen offset:1024 lds
  ds_read_b128 a[192:195], v18 offset:4096
  v_mfma_f32_16x16x32_bf16 v[36:39], a[200:203], a[216:219], v[36:39]
  ds_read_b64_tr_b16 a[164:165], v23 offset:16384
  ds_read_b64_tr_b16 a[166:167], v23 offset:20480
  v_mfma_f32_16x16x32_bf16 v[68:71], a[200:203], a[220:223], v[68:71]
  s_add_u32 s42, s71, 202752
  ds_read_b64_tr_b16 a[168:169], v22 offset:16640
  v_mfma_f32_16x16x32_bf16 v[100:103], a[200:203], a[224:227], v[100:103]
  ds_read_b64_tr_b16 a[170:171], v22 offset:20736
  ds_read_b64_tr_b16 a[172:173], v23 offset:16640
  v_mfma_f32_16x16x32_bf16 v[132:135], a[200:203], a[228:231], v[132:135]
  s_cmp_eq_u32 s39, 0
  s_cselect_b32 s0, s55, s0
  v_mfma_f32_16x16x32_bf16 v[8:11], a[204:207], a[212:215], v[8:11]
  buffer_load_dwordx4 v249, s[20:23], s42 offen offset:2048 lds
  ds_read_b64_tr_b16 a[174:175], v23 offset:20736
  v_mfma_f32_16x16x32_bf16 v[40:43], a[204:207], a[216:219], v[40:43]
  s_add_u32 s42, s71, 205824
  v_mfma_f32_16x16x32_bf16 v[72:75], a[204:207], a[220:223], v[72:75]
  s_cmp_eq_u32 s39, 1
  s_cselect_b32 s1, s55, s1
  v_mfma_f32_16x16x32_bf16 v[104:107], a[204:207], a[224:227], v[104:107]
  s_cmp_eq_u32 s39, 2
  s_cselect_b32 s93, s55, s93
  v_mfma_f32_16x16x32_bf16 v[136:139], a[204:207], a[228:231], v[136:139]
  buffer_load_dwordx4 v250, s[20:23], s42 offen offset:3072 lds
  v_mfma_f32_16x16x32_bf16 v[12:15], a[208:211], a[212:215], v[12:15]
  s_cmp_eq_u32 s39, 3
  s_cselect_b32 s36, s55, s36
  v_mfma_f32_16x16x32_bf16 v[44:47], a[208:211], a[216:219], v[44:47]
  s_lshl_b32 s92, s3, 2
  s_lshl_b32 s59, s59, 2
  v_mfma_f32_16x16x32_bf16 v[76:79], a[208:211], a[220:223], v[76:79]
  s_mul_i32 s55, s39, 160
  v_lshlrev_b32 v48, 4, v251
  v_mfma_f32_16x16x32_bf16 v[108:111], a[208:211], a[224:227], v[108:111]
  v_mfma_f32_16x16x32_bf16 v[140:143], a[208:211], a[228:231], v[140:143]
  s_waitcnt lgkmcnt(0)
  v_mfma_f32_16x16x32_bf16 v[0:3], a[160:163], a[176:179], v[0:3]
  s_add_u32 m0, s97, 126976
  s_add_u32 s44, s67, 61440
  v_mfma_f32_16x16x32_bf16 v[32:35], a[160:163], a[180:183], v[32:35]
  buffer_load_dwordx4 v254, s[76:79], s44 offen offset:0 sc1 lds
  ds_read_b64_tr_b16 a[196:197], v22 offset:24576
  v_mfma_f32_16x16x32_bf16 v[64:67], a[160:163], a[184:187], v[64:67]
  ds_read_b64_tr_b16 a[198:199], v22 offset:28672
  ds_read_b128 a[212:215], v18 offset:5120
  v_mfma_f32_16x16x32_bf16 v[96:99], a[160:163], a[188:191], v[96:99]
  ds_read_b128 a[216:219], v18 offset:6144
  ds_read_b128 a[220:223], v18 offset:7168
  v_mfma_f32_16x16x32_bf16 v[128:131], a[160:163], a[192:195], v[128:131]
  buffer_load_dwordx4 v254, s[76:79], s44 offen offset:1024 sc1 lds
  ds_read_b128 a[224:227], v18 offset:8192
  v_mfma_f32_16x16x32_bf16 v[4:7], a[164:167], a[176:179], v[4:7]
  ds_read_b128 a[228:231], v18 offset:9216
  ds_read_b64_tr_b16 a[200:201], v23 offset:24576
  v_mfma_f32_16x16x32_bf16 v[36:39], a[164:167], a[180:183], v[36:39]
  ds_read_b64_tr_b16 a[202:203], v23 offset:28672
  ds_read_b64_tr_b16 a[204:205], v22 offset:24832
  v_mfma_f32_16x16x32_bf16 v[68:71], a[164:167], a[184:187], v[68:71]
  ds_read_b64_tr_b16 a[206:207], v22 offset:28928
  ds_read_b64_tr_b16 a[208:209], v23 offset:24832
  v_mfma_f32_16x16x32_bf16 v[100:103], a[164:167], a[188:191], v[100:103]
  buffer_load_dwordx4 v254, s[76:79], s44 offen offset:2048 sc1 lds
  ds_read_b64_tr_b16 a[210:211], v23 offset:28928
  v_mfma_f32_16x16x32_bf16 v[132:135], a[164:167], a[192:195], v[132:135]
  v_mov_b32 v49, 0x3f80
  v_mov_b32 v50, 0x3f800000
  v_mfma_f32_16x16x32_bf16 v[8:11], a[168:171], a[176:179], v[8:11]
  v_add_u32 v26, s55, v251
  v_add_u32 v26, 0, v26
  v_mfma_f32_16x16x32_bf16 v[40:43], a[168:171], a[180:183], v[40:43]
  buffer_load_dwordx4 v254, s[76:79], s44 offen offset:3072 sc1 lds
  v_lshrrev_b32 v27, 7, v26
  v_mfma_f32_16x16x32_bf16 v[72:75], a[168:171], a[184:187], v[72:75]
  s_add_u32 m0, s97, 131072
  s_add_u32 s44, s67, 65536
  v_mfma_f32_16x16x32_bf16 v[104:107], a[168:171], a[188:191], v[104:107]
  v_lshlrev_b32 v28, 15, v27
  v_bfe_u32 v27, v26, 6, 1
  v_mfma_f32_16x16x32_bf16 v[136:139], a[168:171], a[192:195], v[136:139]
  v_lshl_add_u32 v28, v27, 6, v28
  v_mfma_f32_16x16x32_bf16 v[12:15], a[172:175], a[176:179], v[12:15]
  buffer_load_dwordx4 v254, s[76:79], s44 offen offset:0 sc1 lds
  v_mfma_f32_16x16x32_bf16 v[44:47], a[172:175], a[180:183], v[44:47]
  v_mfma_f32_16x16x32_bf16 v[76:79], a[172:175], a[184:187], v[76:79]
  v_mfma_f32_16x16x32_bf16 v[108:111], a[172:175], a[188:191], v[108:111]
  v_mfma_f32_16x16x32_bf16 v[140:143], a[172:175], a[192:195], v[140:143]
  s_waitcnt vmcnt(18) lgkmcnt(0)
  s_barrier
  v_mfma_f32_16x16x32_bf16 v[0:3], a[196:199], a[212:215], v[0:3]
  ds_read_b64_tr_b16 a[160:161], v22 offset:0
  ds_read_b64_tr_b16 a[162:163], v22 offset:4096
  v_mfma_f32_16x16x32_bf16 v[32:35], a[196:199], a[216:219], v[32:35]
  ds_read_b128 a[176:179], v18 offset:20480
  ds_read_b128 a[180:183], v18 offset:21504
  v_mfma_f32_16x16x32_bf16 v[64:67], a[196:199], a[220:223], v[64:67]
  ds_read_b128 a[184:187], v18 offset:22528
  ds_read_b128 a[188:191], v18 offset:23552
  v_mfma_f32_16x16x32_bf16 v[96:99], a[196:199], a[224:227], v[96:99]
  ds_read_b128 a[192:195], v18 offset:24576
  ds_read_b64_tr_b16 a[164:165], v23 offset:0
  v_mfma_f32_16x16x32_bf16 v[128:131], a[196:199], a[228:231], v[128:131]
  ds_read_b64_tr_b16 a[166:167], v23 offset:4096
  ds_read_b64_tr_b16 a[168:169], v22 offset:256
  v_mfma_f32_16x16x32_bf16 v[4:7], a[200:203], a[212:215], v[4:7]
  ds_read_b64_tr_b16 a[170:171], v22 offset:4352
  ds_read_b64_tr_b16 a[172:173], v23 offset:256
  v_mfma_f32_16x16x32_bf16 v[36:39], a[200:203], a[216:219], v[36:39]
  ds_read_b64_tr_b16 a[174:175], v23 offset:4352
  v_mfma_f32_16x16x32_bf16 v[68:71], a[200:203], a[220:223], v[68:71]
  v_mfma_f32_16x16x32_bf16 v[100:103], a[200:203], a[224:227], v[100:103]
  v_and_b32 v27, 15, v26
  v_lshl_add_u32 v28, v27, 11, v28
  v_mfma_f32_16x16x32_bf16 v[132:135], a[200:203], a[228:231], v[132:135]
  v_bfe_u32 v27, v26, 4, 2
  v_lshl_add_u32 v28, v27, 3, v28
  v_mfma_f32_16x16x32_bf16 v[8:11], a[204:207], a[212:215], v[8:11]
  v_add_u32 v26, s55, v251
  v_add_u32 v26, 64, v26
  v_mfma_f32_16x16x32_bf16 v[40:43], a[204:207], a[216:219], v[40:43]
  v_lshrrev_b32 v27, 7, v26
  v_lshlrev_b32 v29, 15, v27
  v_mfma_f32_16x16x32_bf16 v[72:75], a[204:207], a[220:223], v[72:75]
  v_mfma_f32_16x16x32_bf16 v[104:107], a[204:207], a[224:227], v[104:107]
  v_mfma_f32_16x16x32_bf16 v[136:139], a[204:207], a[228:231], v[136:139]
  v_mfma_f32_16x16x32_bf16 v[12:15], a[208:211], a[212:215], v[12:15]
  v_mfma_f32_16x16x32_bf16 v[44:47], a[208:211], a[216:219], v[44:47]
  v_mfma_f32_16x16x32_bf16 v[76:79], a[208:211], a[220:223], v[76:79]
  v_mfma_f32_16x16x32_bf16 v[108:111], a[208:211], a[224:227], v[108:111]
  v_mfma_f32_16x16x32_bf16 v[140:143], a[208:211], a[228:231], v[140:143]
  s_waitcnt lgkmcnt(0)
  v_mfma_f32_16x16x32_bf16 v[0:3], a[160:163], a[176:179], v[0:3]
  ds_read_b64_tr_b16 a[196:197], v22 offset:8192
  ds_read_b64_tr_b16 a[198:199], v22 offset:12288
  v_mfma_f32_16x16x32_bf16 v[32:35], a[160:163], a[180:183], v[32:35]
  ds_read_b128 a[212:215], v18 offset:25600
  ds_read_b128 a[216:219], v18 offset:26624
  v_mfma_f32_16x16x32_bf16 v[64:67], a[160:163], a[184:187], v[64:67]
  ds_read_b128 a[220:223], v18 offset:27648
  ds_read_b128 a[224:227], v18 offset:28672
  v_mfma_f32_16x16x32_bf16 v[96:99], a[160:163], a[188:191], v[96:99]
  ds_read_b128 a[228:231], v18 offset:29696
  ds_read_b64_tr_b16 a[200:201], v23 offset:8192
  v_mfma_f32_16x16x32_bf16 v[128:131], a[160:163], a[192:195], v[128:131]
  ds_read_b64_tr_b16 a[202:203], v23 offset:12288
  ds_read_b64_tr_b16 a[204:205], v22 offset:8448
  v_mfma_f32_16x16x32_bf16 v[4:7], a[164:167], a[176:179], v[4:7]
  ds_read_b64_tr_b16 a[206:207], v22 offset:12544
  ds_read_b64_tr_b16 a[208:209], v23 offset:8448
  v_mfma_f32_16x16x32_bf16 v[36:39], a[164:167], a[180:183], v[36:39]
  ds_read_b64_tr_b16 a[210:211], v23 offset:12544
  v_mfma_f32_16x16x32_bf16 v[68:71], a[164:167], a[184:187], v[68:71]
  v_mfma_f32_16x16x32_bf16 v[100:103], a[164:167], a[188:191], v[100:103]
  v_bfe_u32 v27, v26, 6, 1
  v_lshl_add_u32 v29, v27, 6, v29
  v_mfma_f32_16x16x32_bf16 v[132:135], a[164:167], a[192:195], v[132:135]
  v_and_b32 v27, 15, v26
  v_lshl_add_u32 v29, v27, 11, v29
  v_mfma_f32_16x16x32_bf16 v[8:11], a[168:171], a[176:179], v[8:11]
  v_bfe_u32 v27, v26, 4, 2
  v_lshl_add_u32 v29, v27, 3, v29
  v_mfma_f32_16x16x32_bf16 v[40:43], a[168:171], a[180:183], v[40:43]
  v_add_u32 v26, s55, v251
  v_add_u32 v26, 128, v26
  v_mfma_f32_16x16x32_bf16 v[72:75], a[168:171], a[184:187], v[72:75]
  v_mfma_f32_16x16x32_bf16 v[104:107], a[168:171], a[188:191], v[104:107]
  v_mfma_f32_16x16x32_bf16 v[136:139], a[168:171], a[192:195], v[136:139]
  v_mfma_f32_16x16x32_bf16 v[12:15], a[172:175], a[176:179], v[12:15]
  v_mfma_f32_16x16x32_bf16 v[44:47], a[172:175], a[180:183], v[44:47]
  v_mfma_f32_16x16x32_bf16 v[76:79], a[172:175], a[184:187], v[76:79]
  v_mfma_f32_16x16x32_bf16 v[108:111], a[172:175], a[188:191], v[108:111]
  v_mfma_f32_16x16x32_bf16 v[140:143], a[172:175], a[192:195], v[140:143]
  s_waitcnt vmcnt(9) lgkmcnt(0)
  s_barrier
  v_mfma_f32_16x16x32_bf16 v[0:3], a[196:199], a[212:215], v[0:3]
  ds_read_b64_tr_b16 a[160:161], v22 offset:32768
  ds_read_b64_tr_b16 a[162:163], v22 offset:36864
  v_mfma_f32_16x16x32_bf16 v[32:35], a[196:199], a[216:219], v[32:35]
  ds_read_b128 a[176:179], v19 offset:0
  ds_read_b128 a[180:183], v19 offset:1024
  v_mfma_f32_16x16x32_bf16 v[64:67], a[196:199], a[220:223], v[64:67]
  ds_read_b128 a[184:187], v19 offset:2048
  ds_read_b128 a[188:191], v19 offset:3072
  v_mfma_f32_16x16x32_bf16 v[96:99], a[196:199], a[224:227], v[96:99]
  ds_read_b128 a[192:195], v19 offset:4096
  ds_read_b64_tr_b16 a[164:165], v23 offset:32768
  v_mfma_f32_16x16x32_bf16 v[128:131], a[196:199], a[228:231], v[128:131]
  ds_read_b64_tr_b16 a[166:167], v23 offset:36864
  ds_read_b64_tr_b16 a[168:169], v22 offset:33024
  v_mfma_f32_16x16x32_bf16 v[4:7], a[200:203], a[212:215], v[4:7]
  ds_read_b64_tr_b16 a[170:171], v22 offset:37120
  ds_read_b64_tr_b16 a[172:173], v23 offset:33024
  v_mfma_f32_16x16x32_bf16 v[36:39], a[200:203], a[216:219], v[36:39]
  ds_read_b64_tr_b16 a[174:175], v23 offset:37120
  v_mfma_f32_16x16x32_bf16 v[68:71], a[200:203], a[220:223], v[68:71]
  v_mfma_f32_16x16x32_bf16 v[100:103], a[200:203], a[224:227], v[100:103]
  v_lshrrev_b32 v27, 7, v26
  v_lshlrev_b32 v30, 15, v27
  v_mfma_f32_16x16x32_bf16 v[132:135], a[200:203], a[228:231], v[132:135]
  v_bfe_u32 v27, v26, 6, 1
  v_lshl_add_u32 v30, v27, 6, v30
  v_mfma_f32_16x16x32_bf16 v[8:11], a[204:207], a[212:215], v[8:11]
  v_and_b32 v27, 15, v26
  v_lshl_add_u32 v30, v27, 11, v30
  v_mfma_f32_16x16x32_bf16 v[40:43], a[204:207], a[216:219], v[40:43]
  v_bfe_u32 v27, v26, 4, 2
  v_lshl_add_u32 v30, v27, 3, v30
  v_mfma_f32_16x16x32_bf16 v[72:75], a[204:207], a[220:223], v[72:75]
  v_mfma_f32_16x16x32_bf16 v[104:107], a[204:207], a[224:227], v[104:107]
  v_mfma_f32_16x16x32_bf16 v[136:139], a[204:207], a[228:231], v[136:139]
  v_mfma_f32_16x16x32_bf16 v[12:15], a[208:211], a[212:215], v[12:15]
  v_mfma_f32_16x16x32_bf16 v[44:47], a[208:211], a[216:219], v[44:47]
  v_mfma_f32_16x16x32_bf16 v[76:79], a[208:211], a[220:223], v[76:79]
  v_mfma_f32_16x16x32_bf16 v[108:111], a[208:211], a[224:227], v[108:111]
  v_mfma_f32_16x16x32_bf16 v[140:143], a[208:211], a[228:231], v[140:143]
  s_waitcnt lgkmcnt(0)
  v_mfma_f32_16x16x32_bf16 v[0:3], a[160:163], a[176:179], v[0:3]
  ds_read_b64_tr_b16 a[196:197], v22 offset:40960
  ds_read_b64_tr_b16 a[198:199], v22 offset:45056
  v_mfma_f32_16x16x32_bf16 v[32:35], a[160:163], a[180:183], v[32:35]
  ds_read_b128 a[212:215], v19 offset:5120
  ds_read_b128 a[216:219], v19 offset:6144
  v_mfma_f32_16x16x32_bf16 v[64:67], a[160:163], a[184:187], v[64:67]
  ds_read_b128 a[220:223], v19 offset:7168
  ds_read_b128 a[224:227], v19 offset:8192
  v_mfma_f32_16x16x32_bf16 v[96:99], a[160:163], a[188:191], v[96:99]
  ds_read_b128 a[228:231], v19 offset:9216
  ds_read_b64_tr_b16 a[200:201], v23 offset:40960
  v_mfma_f32_16x16x32_bf16 v[128:131], a[160:163], a[192:195], v[128:131]
  ds_read_b64_tr_b16 a[202:203], v23 offset:45056
  ds_read_b64_tr_b16 a[204:205], v22 offset:41216
  v_mfma_f32_16x16x32_bf16 v[4:7], a[164:167], a[176:179], v[4:7]
  ds_read_b64_tr_b16 a[206:207], v22 offset:45312
  ds_read_b64_tr_b16 a[208:209], v23 offset:41216
  v_mfma_f32_16x16x32_bf16 v[36:39], a[164:167], a[180:183], v[36:39]
  ds_read_b64_tr_b16 a[210:211], v23 offset:45312
  v_mfma_f32_16x16x32_bf16 v[68:71], a[164:167], a[184:187], v[68:71]
  v_mfma_f32_16x16x32_bf16 v[100:103], a[164:167], a[188:191], v[100:103]
  v_mfma_f32_16x16x32_bf16 v[132:135], a[164:167], a[192:195], v[132:135]
  v_mfma_f32_16x16x32_bf16 v[8:11], a[168:171], a[176:179], v[8:11]
  v_mfma_f32_16x16x32_bf16 v[40:43], a[168:171], a[180:183], v[40:43]
  v_mfma_f32_16x16x32_bf16 v[72:75], a[168:171], a[184:187], v[72:75]
  v_mfma_f32_16x16x32_bf16 v[104:107], a[168:171], a[188:191], v[104:107]
  v_mfma_f32_16x16x32_bf16 v[136:139], a[168:171], a[192:195], v[136:139]
  v_mfma_f32_16x16x32_bf16 v[12:15], a[172:175], a[176:179], v[12:15]
  v_mfma_f32_16x16x32_bf16 v[44:47], a[172:175], a[180:183], v[44:47]
  v_mfma_f32_16x16x32_bf16 v[76:79], a[172:175], a[184:187], v[76:79]
  v_mfma_f32_16x16x32_bf16 v[108:111], a[172:175], a[188:191], v[108:111]
  v_mfma_f32_16x16x32_bf16 v[140:143], a[172:175], a[192:195], v[140:143]
  s_waitcnt vmcnt(0) lgkmcnt(0)
  s_barrier
  v_mfma_f32_16x16x32_bf16 v[0:3], a[196:199], a[212:215], v[0:3]
  ds_read_b64_tr_b16 a[0:1], v22 offset:49152
  ds_read_b64_tr_b16 a[2:3], v22 offset:53248
  ds_read_b128 a[16:19], v19 offset:20480
  v_mfma_f32_16x16x32_bf16 v[32:35], a[196:199], a[216:219], v[32:35]
  ds_read_b128 a[20:23], v19 offset:21504
  ds_read_b128 a[24:27], v19 offset:22528
  ds_read_b128 a[28:31], v19 offset:23552
  v_mfma_f32_16x16x32_bf16 v[64:67], a[196:199], a[220:223], v[64:67]
  ds_read_b128 a[32:35], v19 offset:24576
  ds_read_b64_tr_b16 a[4:5], v23 offset:49152
  ds_read_b64_tr_b16 a[6:7], v23 offset:53248
  v_mfma_f32_16x16x32_bf16 v[96:99], a[196:199], a[224:227], v[96:99]
  ds_read_b64_tr_b16 a[8:9], v22 offset:49408
  ds_read_b64_tr_b16 a[10:11], v22 offset:53504
  ds_read_b64_tr_b16 a[12:13], v23 offset:49408
  v_mfma_f32_16x16x32_bf16 v[128:131], a[196:199], a[228:231], v[128:131]
  ds_read_b64_tr_b16 a[14:15], v23 offset:53504
  ds_read_b64_tr_b16 a[40:41], v22 offset:57344
  ds_read_b64_tr_b16 a[42:43], v22 offset:61440
  v_mfma_f32_16x16x32_bf16 v[4:7], a[200:203], a[212:215], v[4:7]
  s_waitcnt lgkmcnt(11)
  ds_read_b128 a[56:59], v19 offset:25600
  ds_read_b128 a[60:63], v19 offset:26624
  ds_read_b128 a[64:67], v19 offset:27648
  v_mfma_f32_16x16x32_bf16 v[36:39], a[200:203], a[216:219], v[36:39]
  ds_read_b128 a[68:71], v19 offset:28672
  s_waitcnt lgkmcnt(11)
  ds_read_b128 a[72:75], v19 offset:29696
  ds_read_b64_tr_b16 a[44:45], v23 offset:57344
  v_mfma_f32_16x16x32_bf16 v[68:71], a[200:203], a[220:223], v[68:71]
  ds_read_b64_tr_b16 a[46:47], v23 offset:61440
  ds_read_b64_tr_b16 a[48:49], v22 offset:57600
  s_waitcnt lgkmcnt(11)
  ds_read_b64_tr_b16 a[50:51], v22 offset:61696
  v_mfma_f32_16x16x32_bf16 v[100:103], a[200:203], a[224:227], v[100:103]
  ds_read_b64_tr_b16 a[52:53], v23 offset:57600
  ds_read_b64_tr_b16 a[54:55], v23 offset:61696
  v_mfma_f32_16x16x32_bf16 v[132:135], a[200:203], a[228:231], v[132:135]
  v_mfma_f32_16x16x32_bf16 v[8:11], a[204:207], a[212:215], v[8:11]
  v_mfma_f32_16x16x32_bf16 v[40:43], a[204:207], a[216:219], v[40:43]
  v_mfma_f32_16x16x32_bf16 v[72:75], a[204:207], a[220:223], v[72:75]
  v_mfma_f32_16x16x32_bf16 v[104:107], a[204:207], a[224:227], v[104:107]
  v_mfma_f32_16x16x32_bf16 v[136:139], a[204:207], a[228:231], v[136:139]
  v_mfma_f32_16x16x32_bf16 v[12:15], a[208:211], a[212:215], v[12:15]
  v_mfma_f32_16x16x32_bf16 v[44:47], a[208:211], a[216:219], v[44:47]
  v_mfma_f32_16x16x32_bf16 v[76:79], a[208:211], a[220:223], v[76:79]
  v_mfma_f32_16x16x32_bf16 v[108:111], a[208:211], a[224:227], v[108:111]
  v_mfma_f32_16x16x32_bf16 v[140:143], a[208:211], a[228:231], v[140:143]
  s_waitcnt lgkmcnt(0)
  v_mfma_f32_16x16x32_bf16 v[0:3], a[0:3], a[16:19], v[0:3]
  v_mfma_f32_16x16x32_bf16 v[4:7], a[4:7], a[16:19], v[4:7]
  v_mfma_f32_16x16x32_bf16 v[8:11], a[8:11], a[16:19], v[8:11]
  v_mfma_f32_16x16x32_bf16 v[12:15], a[12:15], a[16:19], v[12:15]
  v_mfma_f32_16x16x32_bf16 v[0:3], a[40:43], a[56:59], v[0:3]
  v_mfma_f32_16x16x32_bf16 v[4:7], a[44:47], a[56:59], v[4:7]
  v_mfma_f32_16x16x32_bf16 v[8:11], a[48:51], a[56:59], v[8:11]
  v_mfma_f32_16x16x32_bf16 v[12:15], a[52:55], a[56:59], v[12:15]
  v_mfma_f32_16x16x32_bf16 v[32:35], a[0:3], a[20:23], v[32:35]
  v_mfma_f32_16x16x32_bf16 v[36:39], a[4:7], a[20:23], v[36:39]
  s_nop 2
  v_cvt_pk_bf16_f32 v0, v0, v1
  v_cvt_pk_bf16_f32 v1, v2, v3
  v_cvt_pk_bf16_f32 v2, v4, v5
  v_mfma_f32_16x16x32_bf16 v[40:43], a[8:11], a[20:23], v[40:43]
  v_cvt_pk_bf16_f32 v3, v6, v7
  s_add_u32 s43, s38, 0
  buffer_store_dwordx4 v[0:3], v254, s[24:27], s43 offen sc1
  v_mfma_f32_16x16x32_bf16 v[44:47], a[12:15], a[20:23], v[44:47]
  v_cvt_pk_bf16_f32 v8, v8, v9
  v_cvt_pk_bf16_f32 v9, v10, v11
  v_cvt_pk_bf16_f32 v10, v12, v13
  v_mfma_f32_16x16x32_bf16 v[32:35], a[40:43], a[60:63], v[32:35]
  v_cvt_pk_bf16_f32 v11, v14, v15
  s_add_u32 s43, s38, 1024
  buffer_store_dwordx4 v[8:11], v254, s[24:27], s43 offen sc1
  v_mfma_f32_16x16x32_bf16 v[36:39], a[44:47], a[60:63], v[36:39]
  v_mfma_f32_16x16x32_bf16 v[40:43], a[48:51], a[60:63], v[40:43]
  v_mfma_f32_16x16x32_bf16 v[44:47], a[52:55], a[60:63], v[44:47]
  v_mfma_f32_16x16x32_bf16 v[64:67], a[0:3], a[24:27], v[64:67]
  v_mfma_f32_16x16x32_bf16 v[68:71], a[4:7], a[24:27], v[68:71]
  v_cvt_pk_bf16_f32 v32, v32, v33
  v_cvt_pk_bf16_f32 v33, v34, v35
  s_nop 1
  v_cvt_pk_bf16_f32 v34, v36, v37
  v_mfma_f32_16x16x32_bf16 v[72:75], a[8:11], a[24:27], v[72:75]
  v_cvt_pk_bf16_f32 v35, v38, v39
  s_add_u32 s43, s38, 2048
  buffer_store_dwordx4 v[32:35], v254, s[24:27], s43 offen sc1
  v_mfma_f32_16x16x32_bf16 v[76:79], a[12:15], a[24:27], v[76:79]
  v_cvt_pk_bf16_f32 v40, v40, v41
  v_cvt_pk_bf16_f32 v41, v42, v43
  v_cvt_pk_bf16_f32 v42, v44, v45
  v_mfma_f32_16x16x32_bf16 v[64:67], a[40:43], a[64:67], v[64:67]
  v_cvt_pk_bf16_f32 v43, v46, v47
  s_add_u32 s43, s38, 3072
  buffer_store_dwordx4 v[40:43], v254, s[24:27], s43 offen sc1
  v_mfma_f32_16x16x32_bf16 v[68:71], a[44:47], a[64:67], v[68:71]
  v_mfma_f32_16x16x32_bf16 v[72:75], a[48:51], a[64:67], v[72:75]
  v_mfma_f32_16x16x32_bf16 v[76:79], a[52:55], a[64:67], v[76:79]
  v_mfma_f32_16x16x32_bf16 v[96:99], a[0:3], a[28:31], v[96:99]
  v_mfma_f32_16x16x32_bf16 v[100:103], a[4:7], a[28:31], v[100:103]
  v_cvt_pk_bf16_f32 v64, v64, v65
  v_cvt_pk_bf16_f32 v65, v66, v67
  s_nop 1
  v_cvt_pk_bf16_f32 v66, v68, v69
  v_mfma_f32_16x16x32_bf16 v[104:107], a[8:11], a[28:31], v[104:107]
  v_cvt_pk_bf16_f32 v67, v70, v71
  s_add_u32 s43, s38, 4096
  buffer_store_dwordx4 v[64:67], v254, s[24:27], s43 offen sc1
  v_mfma_f32_16x16x32_bf16 v[108:111], a[12:15], a[28:31], v[108:111]
  v_cvt_pk_bf16_f32 v72, v72, v73
  v_cvt_pk_bf16_f32 v73, v74, v75
  v_cvt_pk_bf16_f32 v74, v76, v77
  v_mfma_f32_16x16x32_bf16 v[96:99], a[40:43], a[68:71], v[96:99]
  v_cvt_pk_bf16_f32 v75, v78, v79
  s_add_u32 s43, s38, 5120
  buffer_store_dwordx4 v[72:75], v254, s[24:27], s43 offen sc1
  v_mfma_f32_16x16x32_bf16 v[100:103], a[44:47], a[68:71], v[100:103]
  v_mfma_f32_16x16x32_bf16 v[104:107], a[48:51], a[68:71], v[104:107]
  v_mfma_f32_16x16x32_bf16 v[108:111], a[52:55], a[68:71], v[108:111]
  v_mfma_f32_16x16x32_bf16 v[128:131], a[0:3], a[32:35], v[128:131]
  v_mfma_f32_16x16x32_bf16 v[132:135], a[4:7], a[32:35], v[132:135]
  v_cvt_pk_bf16_f32 v96, v96, v97
  v_cvt_pk_bf16_f32 v97, v98, v99
  s_nop 1
  v_cvt_pk_bf16_f32 v98, v100, v101
  v_mfma_f32_16x16x32_bf16 v[136:139], a[8:11], a[32:35], v[136:139]
  v_cvt_pk_bf16_f32 v99, v102, v103
  s_add_u32 s43, s38, 6144
  buffer_store_dwordx4 v[96:99], v254, s[24:27], s43 offen sc1
  v_mfma_f32_16x16x32_bf16 v[140:143], a[12:15], a[32:35], v[140:143]
  v_cvt_pk_bf16_f32 v104, v104, v105
  v_cvt_pk_bf16_f32 v105, v106, v107
  v_cvt_pk_bf16_f32 v106, v108, v109
  v_mfma_f32_16x16x32_bf16 v[128:131], a[40:43], a[72:75], v[128:131]
  v_cvt_pk_bf16_f32 v107, v110, v111
  s_add_u32 s43, s38, 7168
  buffer_store_dwordx4 v[104:107], v254, s[24:27], s43 offen sc1
  v_mfma_f32_16x16x32_bf16 v[132:135], a[44:47], a[72:75], v[132:135]
  v_mfma_f32_16x16x32_bf16 v[136:139], a[48:51], a[72:75], v[136:139]
  v_mfma_f32_16x16x32_bf16 v[140:143], a[52:55], a[72:75], v[140:143]
  s_nop 1
  v_cvt_pk_bf16_f32 v128, v128, v129
  v_cvt_pk_bf16_f32 v129, v130, v131
  s_nop 1
  v_cvt_pk_bf16_f32 v130, v132, v133
  v_cvt_pk_bf16_f32 v131, v134, v135
  s_add_u32 s43, s38, 8192
  buffer_store_dwordx4 v[128:131], v254, s[24:27], s43 offen sc1
  v_cvt_pk_bf16_f32 v136, v136, v137
  v_cvt_pk_bf16_f32 v137, v138, v139
  v_cvt_pk_bf16_f32 v138, v140, v141
  v_cvt_pk_bf16_f32 v139, v142, v143
  s_add_u32 s43, s38, 9216
  buffer_store_dwordx4 v[136:139], v254, s[24:27], s43 offen sc1
  s_mul_i32 s42, s39, 40960
  s_sub_u32 s24, s24, s42
  s_subb_u32 s25, s25, 0
  s_mov_b32 s26, 163840
  s_waitcnt vmcnt(0)
  s_mov_b64 exec, 1
  buffer_store_dword v21, off, s[84:87], s59 sc0 sc1
  s_mov_b64 exec, -1
  s_mov_b32 s99, 200000
  s_branch L_fpoll
L_floop:
L_fpoll:
  buffer_load_dword v20, v48, s[84:87], s92 offen sc0 sc1
  s_waitcnt vmcnt(0)
  s_mov_b32 s98, 0
  v_readlane_b32 s94, v20, 0
  s_nop 0
  s_cmp_lg_u32 s94, s0
  s_addc_u32 s98, s98, 0
  v_readlane_b32 s94, v20, 1
  s_nop 0
  s_cmp_lg_u32 s94, s1
  s_addc_u32 s98, s98, 0
  v_readlane_b32 s94, v20, 2
  s_nop 0
  s_cmp_lg_u32 s94, s93
  s_addc_u32 s98, s98, 0
  v_readlane_b32 s94, v20, 3
  s_nop 0
  s_cmp_lg_u32 s94, s36
  s_addc_u32 s98, s98, 0
  s_sub_u32 s99, s99, 1
  s_cmp_eq_u32 s99, 0
  s_cbranch_scc1 L_fgo
  s_cmp_lg_u32 s98, 4
  s_cbranch_scc1 L_floop
L_fgo:
  s_add_u32 s43, s37, 0
  buffer_load_dwordx4 v[160:163], v254, s[24:27], s43 offen offset:0 sc1
  s_add_u32 s43, s37, 40960
  buffer_load_dwordx4 v[164:167], v254, s[24:27], s43 offen offset:0 sc1
  s_add_u32 s43, s37, 81920
  buffer_load_dwordx4 v[168:171], v254, s[24:27], s43 offen offset:0 sc1
  s_add_u32 s43, s37, 122880
  buffer_load_dwordx4 v[172:175], v254, s[24:27], s43 offen offset:0 sc1
  s_add_u32 s43, s37, 0
  buffer_load_dwordx4 v[176:179], v254, s[24:27], s43 offen offset:1024 sc1
  s_add_u32 s43, s37, 40960
  buffer_load_dwordx4 v[180:183], v254, s[24:27], s43 offen offset:1024 sc1
  s_add_u32 s43, s37, 81920
  buffer_load_dwordx4 v[184:187], v254, s[24:27], s43 offen offset:1024 sc1
  s_add_u32 s43, s37, 122880
  buffer_load_dwordx4 v[188:191], v254, s[24:27], s43 offen offset:1024 sc1
  s_add_u32 s43, s37, 0
  buffer_load_dwordx4 v[192:195], v254, s[24:27], s43 offen offset:2048 sc1
  s_add_u32 s43, s37, 40960
  buffer_load_dwordx4 v[196:199], v254, s[24:27], s43 offen offset:2048 sc1
  s_add_u32 s43, s37, 81920
  buffer_load_dwordx4 v[200:203], v254, s[24:27], s43 offen offset:2048 sc1
  s_add_u32 s43, s37, 122880
  buffer_load_dwordx4 v[204:207], v254, s[24:27], s43 offen offset:2048 sc1
  s_waitcnt vmcnt(11)
  v_lshlrev_b32 v96, 16, v160
  v_and_b32 v97, 0xffff0000, v160
  v_lshlrev_b32 v98, 16, v161
  v_and_b32 v99, 0xffff0000, v161
  v_lshlrev_b32 v100, 16, v162
  v_and_b32 v101, 0xffff0000, v162
  v_lshlrev_b32 v102, 16, v163
  v_and_b32 v103, 0xffff0000, v163
  s_waitcnt vmcnt(10)
  v_lshlrev_b32 v26, 16, v164
  v_and_b32 v27, 0xffff0000, v164
  v_add_f32 v96, v96, v26
  v_add_f32 v97, v97, v27
  v_lshlrev_b32 v26, 16, v165
  v_and_b32 v27, 0xffff0000, v165
  v_add_f32 v98, v98, v26
  v_add_f32 v99, v99, v27
  v_lshlrev_b32 v26, 16, v166
  v_and_b32 v27, 0xffff0000, v166
  v_add_f32 v100, v100, v26
  v_add_f32 v101, v101, v27
  v_lshlrev_b32 v26, 16, v167
  v_and_b32 v27, 0xffff0000, v167
  v_add_f32 v102, v102, v26
  v_add_f32 v103, v103, v27
  s_waitcnt vmcnt(9)
  v_lshlrev_b32 v26, 16, v168
  v_and_b32 v27, 0xffff0000, v168
  v_add_f32 v96, v96, v26
  v_add_f32 v97, v97, v27
  v_lshlrev_b32 v26, 16, v169
  v_and_b32 v27, 0xffff0000, v169
  v_add_f32 v98, v98, v26
  v_add_f32 v99, v99, v27
  v_lshlrev_b32 v26, 16, v170
  v_and_b32 v27, 0xffff0000, v170
  v_add_f32 v100, v100, v26
  v_add_f32 v101, v101, v27
  v_lshlrev_b32 v26, 16, v171
  v_and_b32 v27, 0xffff0000, v171
  v_add_f32 v102, v102, v26
  v_add_f32 v103, v103, v27
  s_waitcnt vmcnt(8)
  v_lshlrev_b32 v26, 16, v172
  v_and_b32 v27, 0xffff0000, v172
  v_add_f32 v96, v96, v26
  v_add_f32 v97, v97, v27
  v_lshlrev_b32 v26, 16, v173
  v_and_b32 v27, 0xffff0000, v173
  v_add_f32 v98, v98, v26
  v_add_f32 v99, v99, v27
  v_lshlrev_b32 v26, 16, v174
  v_and_b32 v27, 0xffff0000, v174
  v_add_f32 v100, v100, v26
  v_add_f32 v101, v101, v27
  v_lshlrev_b32 v26, 16, v175
  v_and_b32 v27, 0xffff0000, v175
  v_add_f32 v102, v102, v26
  v_add_f32 v103, v103, v27
  v_cvt_pk_bf16_f32 v104, v96, v97
  v_cvt_pk_bf16_f32 v105, v98, v99
  v_cvt_pk_bf16_f32 v106, v100, v101
  v_cvt_pk_bf16_f32 v107, v102, v103
  buffer_store_dwordx2 v[104:105], v28, s[12:15], s54 offen
  buffer_store_dwordx2 v[106:107], v28, s[12:15], s54 offen offset:32
  s_waitcnt vmcnt(9)
  v_lshlrev_b32 v96, 16, v176
  v_and_b32 v97, 0xffff0000, v176
  v_lshlrev_b32 v98, 16, v177
  v_and_b32 v99, 0xffff0000, v177
  v_lshlrev_b32 v100, 16, v178
  v_and_b32 v101, 0xffff0000, v178
  v_lshlrev_b32 v102, 16, v179
  v_and_b32 v103, 0xffff0000, v179
  s_waitcnt vmcnt(8)
  v_lshlrev_b32 v26, 16, v180
  v_and_b32 v27, 0xffff0000, v180
  v_add_f32 v96, v96, v26
  v_add_f32 v97, v97, v27
  v_lshlrev_b32 v26, 16, v181
  v_and_b32 v27, 0xffff0000, v181
  v_add_f32 v98, v98, v26
  v_add_f32 v99, v99, v27
  v_lshlrev_b32 v26, 16, v182
  v_and_b32 v27, 0xffff0000, v182
  v_add_f32 v100, v100, v26
  v_add_f32 v101, v101, v27
  v_lshlrev_b32 v26, 16, v183
  v_and_b32 v27, 0xffff0000, v183
  v_add_f32 v102, v102, v26
  v_add_f32 v103, v103, v27
  s_waitcnt vmcnt(7)
  v_lshlrev_b32 v26, 16, v184
  v_and_b32 v27, 0xffff0000, v184
  v_add_f32 v96, v96, v26
  v_add_f32 v97, v97, v27
  v_lshlrev_b32 v26, 16, v185
  v_and_b32 v27, 0xffff0000, v185
  v_add_f32 v98, v98, v26
  v_add_f32 v99, v99, v27
  v_lshlrev_b32 v26, 16, v186
  v_and_b32 v27, 0xffff0000, v186
  v_add_f32 v100, v100, v26
  v_add_f32 v101, v101, v27
  v_lshlrev_b32 v26, 16, v187
  v_and_b32 v27, 0xffff0000, v187
  v_add_f32 v102, v102, v26
  v_add_f32 v103, v103, v27
  s_waitcnt vmcnt(6)
  v_lshlrev_b32 v26, 16, v188
  v_and_b32 v27, 0xffff0000, v188
  v_add_f32 v96, v96, v26
  v_add_f32 v97, v97, v27
  v_lshlrev_b32 v26, 16, v189
  v_and_b32 v27, 0xffff0000, v189
  v_add_f32 v98, v98, v26
  v_add_f32 v99, v99, v27
  v_lshlrev_b32 v26, 16, v190
  v_and_b32 v27, 0xffff0000, v190
  v_add_f32 v100, v100, v26
  v_add_f32 v101, v101, v27
  v_lshlrev_b32 v26, 16, v191
  v_and_b32 v27, 0xffff0000, v191
  v_add_f32 v102, v102, v26
  v_add_f32 v103, v103, v27
  v_cvt_pk_bf16_f32 v108, v96, v97
  v_cvt_pk_bf16_f32 v109, v98, v99
  v_cvt_pk_bf16_f32 v110, v100, v101
  v_cvt_pk_bf16_f32 v111, v102, v103
  buffer_store_dwordx2 v[108:109], v29, s[12:15], s54 offen
  buffer_store_dwordx2 v[110:111], v29, s[12:15], s54 offen offset:32
  s_waitcnt vmcnt(7)
  v_lshlrev_b32 v96, 16, v192
  v_and_b32 v97, 0xffff0000, v192
  v_lshlrev_b32 v98, 16, v193
  v_and_b32 v99, 0xffff0000, v193
  v_lshlrev_b32 v100, 16, v194
  v_and_b32 v101, 0xffff0000, v194
  v_lshlrev_b32 v102, 16, v195
  v_and_b32 v103, 0xffff0000, v195
  s_waitcnt vmcnt(6)
  v_lshlrev_b32 v26, 16, v196
  v_and_b32 v27, 0xffff0000, v196
  v_add_f32 v96, v96, v26
  v_add_f32 v97, v97, v27
  v_lshlrev_b32 v26, 16, v197
  v_and_b32 v27, 0xffff0000, v197
  v_add_f32 v98, v98, v26
  v_add_f32 v99, v99, v27
  v_lshlrev_b32 v26, 16, v198
  v_and_b32 v27, 0xffff0000, v198
  v_add_f32 v100, v100, v26
  v_add_f32 v101, v101, v27
  v_lshlrev_b32 v26, 16, v199
  v_and_b32 v27, 0xffff0000, v199
  v_add_f32 v102, v102, v26
  v_add_f32 v103, v103, v27
  s_waitcnt vmcnt(5)
  v_lshlrev_b32 v26, 16, v200
  v_and_b32 v27, 0xffff0000, v200
  v_add_f32 v96, v96, v26
  v_add_f32 v97, v97, v27
  v_lshlrev_b32 v26, 16, v201
  v_and_b32 v27, 0xffff0000, v201
  v_add_f32 v98, v98, v26
  v_add_f32 v99, v99, v27
  v_lshlrev_b32 v26, 16, v202
  v_and_b32 v27, 0xffff0000, v202
  v_add_f32 v100, v100, v26
  v_add_f32 v101, v101, v27
  v_lshlrev_b32 v26, 16, v203
  v_and_b32 v27, 0xffff0000, v203
  v_add_f32 v102, v102, v26
  v_add_f32 v103, v103, v27
  s_waitcnt vmcnt(4)
  v_lshlrev_b32 v26, 16, v204
  v_and_b32 v27, 0xffff0000, v204
  v_add_f32 v96, v96, v26
  v_add_f32 v97, v97, v27
  v_lshlrev_b32 v26, 16, v205
  v_and_b32 v27, 0xffff0000, v205
  v_add_f32 v98, v98, v26
  v_add_f32 v99, v99, v27
  v_lshlrev_b32 v26, 16, v206
  v_and_b32 v27, 0xffff0000, v206
  v_add_f32 v100, v100, v26
  v_add_f32 v101, v101, v27
  v_lshlrev_b32 v26, 16, v207
  v_and_b32 v27, 0xffff0000, v207
  v_add_f32 v102, v102, v26
  v_add_f32 v103, v103, v27
  v_cvt_pk_bf16_f32 v112, v96, v97
  v_cvt_pk_bf16_f32 v113, v98, v99
  v_cvt_pk_bf16_f32 v114, v100, v101
  v_cvt_pk_bf16_f32 v115, v102, v103
  s_mov_b32 exec_hi, 0
  buffer_store_dwordx2 v[112:113], v30, s[12:15], s54 offen
  buffer_store_dwordx2 v[114:115], v30, s[12:15], s54 offen offset:32
  s_mov_b64 exec, -1
L_end:
  s_endpgm
L_stub1:
  s_call_b64 s[60:61], L_rare
  s_branch L_ret1
L_stub2:
  s_call_b64 s[60:61], L_rare
  s_branch L_ret2
L_stub3:
  s_call_b64 s[60:61], L_rare
  s_branch L_ret3
L_stub4:
  s_call_b64 s[60:61], L_rare
  s_branch L_ret4
L_stub11:
  s_call_b64 s[60:61], L_rare
  s_branch L_ret11
L_stub12:
  s_call_b64 s[60:61], L_rare
  s_branch L_ret12
L_stub13:
  s_call_b64 s[60:61], L_rare
  s_branch L_ret13
L_stub14:
  s_call_b64 s[60:61], L_rare
  s_branch L_ret14
L_stub15:
  s_call_b64 s[60:61], L_rare
  s_branch L_ret15
L_rare:
  s_nop 7
  s_nop 1
  v_max3_f32 v240, v160, v161, v162
  v_max3_f32 v241, v163, v164, v165
  v_max3_f32 v240, v240, v166, v167
  v_max_f32 v240, v240, v241
  v_mov_b32 v241, v240
  s_nop 1
  v_permlane32_swap_b32 v240, v241
  v_max_f32 v240, v240, v241
  v_mov_b32 v241, v240
  s_nop 1
  v_permlane16_swap_b32 v240, v241
  v_max_f32 v240, v240, v241
  v_max_f32 v240, 0, v240
  v_sub_f32 v220, v220, v240
  v_sub_f32 v221, v221, v240
  v_sub_f32 v222, v222, v240
  v_sub_f32 v223, v223, v240
  v_sub_f32 v160, v160, v240
  v_sub_f32 v161, v161, v240
  v_sub_f32 v162, v162, v240
  v_sub_f32 v163, v163, v240
  v_sub_f32 v164, v164, v240
  v_sub_f32 v165, v165, v240
  v_sub_f32 v166, v166, v240
  v_sub_f32 v167, v167, v240
  v_sub_f32 v242, 0, v240
  v_exp_f32 v242, v242
  s_nop 0
  v_mul_f32 v0, v0, v242
  v_mul_f32 v1, v1, v242
  v_mul_f32 v2, v2, v242
  v_mul_f32 v3, v3, v242
  v_mul_f32 v4, v4, v242
  v_mul_f32 v5, v5, v242
  v_mul_f32 v6, v6, v242
  v_mul_f32 v7, v7, v242
  v_mul_f32 v8, v8, v242
  v_mul_f32 v9, v9, v242
  v_mul_f32 v10, v10, v242
  v_mul_f32 v11, v11, v242
  v_mul_f32 v12, v12, v242
  v_mul_f32 v13, v13, v242
  v_mul_f32 v14, v14, v242
  v_mul_f32 v15, v15, v242
  v_mul_f32 v16, v16, v242
  v_mul_f32 v17, v17, v242
  v_mul_f32 v18, v18, v242
  v_mul_f32 v19, v19, v242
  v_mul_f32 v20, v20, v242
  v_mul_f32 v21, v21, v242
  v_mul_f32 v22, v22, v242
  v_mul_f32 v23, v23, v242
  v_mul_f32 v24, v24, v242
  v_mul_f32 v25, v25, v242
  v_mul_f32 v26, v26, v242
  v_mul_f32 v27, v27, v242
  v_mul_f32 v28, v28, v242
  v_mul_f32 v29, v29, v242
  v_mul_f32 v30, v30, v242
  v_mul_f32 v31, v31, v242
  v_accvgpr_read_b32 v243, a136
  v_mul_f32 v243, v243, v242
  v_accvgpr_write_b32 a136, v243
  v_accvgpr_read_b32 v243, a137
  v_mul_f32 v243, v243, v242
  v_accvgpr_write_b32 a137, v243
  v_accvgpr_read_b32 v243, a138
  v_mul_f32 v243, v243, v242
  v_accvgpr_write_b32 a138, v243
  v_accvgpr_read_b32 v243, a139
  v_mul_f32 v243, v243, v242
  v_accvgpr_write_b32 a139, v243
  v_lshlrev_b32 v243, 16, v200
  v_and_b32 v241, 0xffff0000, v200
  v_mul_f32 v243, v243, v242
  v_mul_f32 v241, v241, v242
  v_cvt_pk_bf16_f32 v200, v243, v241
  v_lshlrev_b32 v243, 16, v201
  v_and_b32 v241, 0xffff0000, v201
  v_mul_f32 v243, v243, v242
  v_mul_f32 v241, v241, v242
  v_cvt_pk_bf16_f32 v201, v243, v241
  v_lshlrev_b32 v243, 16, v202
  v_and_b32 v241, 0xffff0000, v202
  v_mul_f32 v243, v243, v242
  v_mul_f32 v241, v241, v242
  v_cvt_pk_bf16_f32 v202, v243, v241
  v_lshlrev_b32 v243, 16, v203
  v_and_b32 v241, 0xffff0000, v203
  v_mul_f32 v243, v243, v242
  v_mul_f32 v241, v241, v242
  v_cvt_pk_bf16_f32 v203, v243, v241
  v_max3_f32 v240, v168, v169, v170
  v_max3_f32 v241, v171, v172, v173
  v_max3_f32 v240, v240, v174, v175
  v_max_f32 v240, v240, v241
  v_mov_b32 v241, v240
  s_nop 1
  v_permlane32_swap_b32 v240, v241
  v_max_f32 v240, v240, v241
  v_mov_b32 v241, v240
  s_nop 1
  v_permlane16_swap_b32 v240, v241
  v_max_f32 v240, v240, v241
  v_max_f32 v240, 0, v240
  v_sub_f32 v224, v224, v240
  v_sub_f32 v225, v225, v240
  v_sub_f32 v226, v226, v240
  v_sub_f32 v227, v227, v240
  v_sub_f32 v168, v168, v240
  v_sub_f32 v169, v169, v240
  v_sub_f32 v170, v170, v240
  v_sub_f32 v171, v171, v240
  v_sub_f32 v172, v172, v240
  v_sub_f32 v173, v173, v240
  v_sub_f32 v174, v174, v240
  v_sub_f32 v175, v175, v240
  v_sub_f32 v242, 0, v240
  v_exp_f32 v242, v242
  s_nop 0
  v_mul_f32 v32, v32, v242
  v_mul_f32 v33, v33, v242
  v_mul_f32 v34, v34, v242
  v_mul_f32 v35, v35, v242
  v_mul_f32 v36, v36, v242
  v_mul_f32 v37, v37, v242
  v_mul_f32 v38, v38, v242
  v_mul_f32 v39, v39, v242
  v_mul_f32 v40, v40, v242
  v_mul_f32 v41, v41, v242
  v_mul_f32 v42, v42, v242
  v_mul_f32 v43, v43, v242
  v_mul_f32 v44, v44, v242
  v_mul_f32 v45, v45, v242
  v_mul_f32 v46, v46, v242
  v_mul_f32 v47, v47, v242
  v_mul_f32 v48, v48, v242
  v_mul_f32 v49, v49, v242
  v_mul_f32 v50, v50, v242
  v_mul_f32 v51, v51, v242
  v_mul_f32 v52, v52, v242
  v_mul_f32 v53, v53, v242
  v_mul_f32 v54, v54, v242
  v_mul_f32 v55, v55, v242
  v_mul_f32 v56, v56, v242
  v_mul_f32 v57, v57, v242
  v_mul_f32 v58, v58, v242
  v_mul_f32 v59, v59, v242
  v_mul_f32 v60, v60, v242
  v_mul_f32 v61, v61, v242
  v_mul_f32 v62, v62, v242
  v_mul_f32 v63, v63, v242
  v_accvgpr_read_b32 v243, a140
  v_mul_f32 v243, v243, v242
  v_accvgpr_write_b32 a140, v243
  v_accvgpr_read_b32 v243, a141
  v_mul_f32 v243, v243, v242
  v_accvgpr_write_b32 a141, v243
  v_accvgpr_read_b32 v243, a142
  v_mul_f32 v243, v243, v242
  v_accvgpr_write_b32 a142, v243
  v_accvgpr_read_b32 v243, a143
  v_mul_f32 v243, v243, v242
  v_accvgpr_write_b32 a143, v243
  v_lshlrev_b32 v243, 16, v204
  v_and_b32 v241, 0xffff0000, v204
  v_mul_f32 v243, v243, v242
  v_mul_f32 v241, v241, v242
  v_cvt_pk_bf16_f32 v204, v243, v241
  v_lshlrev_b32 v243, 16, v205
  v_and_b32 v241, 0xffff0000, v205
  v_mul_f32 v243, v243, v242
  v_mul_f32 v241, v241, v242
  v_cvt_pk_bf16_f32 v205, v243, v241
  v_lshlrev_b32 v243, 16, v206
  v_and_b32 v241, 0xffff0000, v206
  v_mul_f32 v243, v243, v242
  v_mul_f32 v241, v241, v242
  v_cvt_pk_bf16_f32 v206, v243, v241
  v_lshlrev_b32 v243, 16, v207
  v_and_b32 v241, 0xffff0000, v207
  v_mul_f32 v243, v243, v242
  v_mul_f32 v241, v241, v242
  v_cvt_pk_bf16_f32 v207, v243, v241
  v_max3_f32 v240, v176, v177, v178
  v_max3_f32 v241, v179, v180, v181
  v_max3_f32 v240, v240, v182, v183
  v_max_f32 v240, v240, v241
  v_mov_b32 v241, v240
  s_nop 1
  v_permlane32_swap_b32 v240, v241
  v_max_f32 v240, v240, v241
  v_mov_b32 v241, v240
  s_nop 1
  v_permlane16_swap_b32 v240, v241
  v_max_f32 v240, v240, v241
  v_max_f32 v240, 0, v240
  v_sub_f32 v228, v228, v240
  v_sub_f32 v229, v229, v240
  v_sub_f32 v230, v230, v240
  v_sub_f32 v231, v231, v240
  v_sub_f32 v176, v176, v240
  v_sub_f32 v177, v177, v240
  v_sub_f32 v178, v178, v240
  v_sub_f32 v179, v179, v240
  v_sub_f32 v180, v180, v240
  v_sub_f32 v181, v181, v240
  v_sub_f32 v182, v182, v240
  v_sub_f32 v183, v183, v240
  v_sub_f32 v242, 0, v240
  v_exp_f32 v242, v242
  s_nop 0
  v_mul_f32 v64, v64, v242
  v_mul_f32 v65, v65, v242
  v_mul_f32 v66, v66, v242
  v_mul_f32 v67, v67, v242
  v_mul_f32 v68, v68, v242
  v_mul_f32 v69, v69, v242
  v_mul_f32 v70, v70, v242
  v_mul_f32 v71, v71, v242
  v_mul_f32 v72, v72, v242
  v_mul_f32 v73, v73, v242
  v_mul_f32 v74, v74, v242
  v_mul_f32 v75, v75, v242
  v_mul_f32 v76, v76, v242
  v_mul_f32 v77, v77, v242
  v_mul_f32 v78, v78, v242
  v_mul_f32 v79, v79, v242
  v_mul_f32 v80, v80, v242
  v_mul_f32 v81, v81, v242
  v_mul_f32 v82, v82, v242
  v_mul_f32 v83, v83, v242
  v_mul_f32 v84, v84, v242
  v_mul_f32 v85, v85, v242
  v_mul_f32 v86, v86, v242
  v_mul_f32 v87, v87, v242
  v_mul_f32 v88, v88, v242
  v_mul_f32 v89, v89, v242
  v_mul_f32 v90, v90, v242
  v_mul_f32 v91, v91, v242
  v_mul_f32 v92, v92, v242
  v_mul_f32 v93, v93, v242
  v_mul_f32 v94, v94, v242
  v_mul_f32 v95, v95, v242
  v_accvgpr_read_b32 v243, a144
  v_mul_f32 v243, v243, v242
  v_accvgpr_write_b32 a144, v243
  v_accvgpr_read_b32 v243, a145
  v_mul_f32 v243, v243, v242
  v_accvgpr_write_b32 a145, v243
  v_accvgpr_read_b32 v243, a146
  v_mul_f32 v243, v243, v242
  v_accvgpr_write_b32 a146, v243
  v_accvgpr_read_b32 v243, a147
  v_mul_f32 v243, v243, v242
  v_accvgpr_write_b32 a147, v243
  v_lshlrev_b32 v243, 16, v208
  v_and_b32 v241, 0xffff0000, v208
  v_mul_f32 v243, v243, v242
  v_mul_f32 v241, v241, v242
  v_cvt_pk_bf16_f32 v208, v243, v241
  v_lshlrev_b32 v243, 16, v209
  v_and_b32 v241, 0xffff0000, v209
  v_mul_f32 v243, v243, v242
  v_mul_f32 v241, v241, v242
  v_cvt_pk_bf16_f32 v209, v243, v241
  v_lshlrev_b32 v243, 16, v210
  v_and_b32 v241, 0xffff0000, v210
  v_mul_f32 v243, v243, v242
  v_mul_f32 v241, v241, v242
  v_cvt_pk_bf16_f32 v210, v243, v241
  v_lshlrev_b32 v243, 16, v211
  v_and_b32 v241, 0xffff0000, v211
  v_mul_f32 v243, v243, v242
  v_mul_f32 v241, v241, v242
  v_cvt_pk_bf16_f32 v211, v243, v241
  v_max3_f32 v240, v184, v185, v186
  v_max3_f32 v241, v187, v188, v189
  v_max3_f32 v240, v240, v190, v191
  v_max_f32 v240, v240, v241
  v_mov_b32 v241, v240
  s_nop 1
  v_permlane32_swap_b32 v240, v241
  v_max_f32 v240, v240, v241
  v_mov_b32 v241, v240
  s_nop 1
  v_permlane16_swap_b32 v240, v241
  v_max_f32 v240, v240, v241
  v_max_f32 v240, 0, v240
  v_sub_f32 v232, v232, v240
  v_sub_f32 v233, v233, v240
  v_sub_f32 v234, v234, v240
  v_sub_f32 v235, v235, v240
  v_sub_f32 v184, v184, v240
  v_sub_f32 v185, v185, v240
  v_sub_f32 v186, v186, v240
  v_sub_f32 v187, v187, v240
  v_sub_f32 v188, v188, v240
  v_sub_f32 v189, v189, v240
  v_sub_f32 v190, v190, v240
  v_sub_f32 v191, v191, v240
  v_sub_f32 v242, 0, v240
  v_exp_f32 v242, v242
  s_nop 0
  v_mul_f32 v96, v96, v242
  v_mul_f32 v97, v97, v242
  v_mul_f32 v98, v98, v242
  v_mul_f32 v99, v99, v242
  v_mul_f32 v100, v100, v242
  v_mul_f32 v101, v101, v242
  v_mul_f32 v102, v102, v242
  v_mul_f32 v103, v103, v242
  v_mul_f32 v104, v104, v242
  v_mul_f32 v105, v105, v242
  v_mul_f32 v106, v106, v242
  v_mul_f32 v107, v107, v242
  v_mul_f32 v108, v108, v242
  v_mul_f32 v109, v109, v242
  v_mul_f32 v110, v110, v242
  v_mul_f32 v111, v111, v242
  v_mul_f32 v112, v112, v242
  v_mul_f32 v113, v113, v242
  v_mul_f32 v114, v114, v242
  v_mul_f32 v115, v115, v242
  v_mul_f32 v116, v116, v242
  v_mul_f32 v117, v117, v242
  v_mul_f32 v118, v118, v242
  v_mul_f32 v119, v119, v242
  v_mul_f32 v120, v120, v242
  v_mul_f32 v121, v121, v242
  v_mul_f32 v122, v122, v242
  v_mul_f32 v123, v123, v242
  v_mul_f32 v124, v124, v242
  v_mul_f32 v125, v125, v242
  v_mul_f32 v126, v126, v242
  v_mul_f32 v127, v127, v242
  v_accvgpr_read_b32 v243, a148
  v_mul_f32 v243, v243, v242
  v_accvgpr_write_b32 a148, v243
  v_accvgpr_read_b32 v243, a149
  v_mul_f32 v243, v243, v242
  v_accvgpr_write_b32 a149, v243
  v_accvgpr_read_b32 v243, a150
  v_mul_f32 v243, v243, v242
  v_accvgpr_write_b32 a150, v243
  v_accvgpr_read_b32 v243, a151
  v_mul_f32 v243, v243, v242
  v_accvgpr_write_b32 a151, v243
  v_lshlrev_b32 v243, 16, v212
  v_and_b32 v241, 0xffff0000, v212
  v_mul_f32 v243, v243, v242
  v_mul_f32 v241, v241, v242
  v_cvt_pk_bf16_f32 v212, v243, v241
  v_lshlrev_b32 v243, 16, v213
  v_and_b32 v241, 0xffff0000, v213
  v_mul_f32 v243, v243, v242
  v_mul_f32 v241, v241, v242
  v_cvt_pk_bf16_f32 v213, v243, v241
  v_lshlrev_b32 v243, 16, v214
  v_and_b32 v241, 0xffff0000, v214
  v_mul_f32 v243, v243, v242
  v_mul_f32 v241, v241, v242
  v_cvt_pk_bf16_f32 v214, v243, v241
  v_lshlrev_b32 v243, 16, v215
  v_and_b32 v241, 0xffff0000, v215
  v_mul_f32 v243, v243, v242
  v_mul_f32 v241, v241, v242
  v_cvt_pk_bf16_f32 v215, v243, v241
  v_max3_f32 v240, v192, v193, v194
  v_max3_f32 v241, v195, v196, v197
  v_max3_f32 v240, v240, v198, v199
  v_max_f32 v240, v240, v241
  v_mov_b32 v241, v240
  s_nop 1
  v_permlane32_swap_b32 v240, v241
  v_max_f32 v240, v240, v241
  v_mov_b32 v241, v240
  s_nop 1
  v_permlane16_swap_b32 v240, v241
  v_max_f32 v240, v240, v241
  v_max_f32 v240, 0, v240
  v_sub_f32 v236, v236, v240
  v_sub_f32 v237, v237, v240
  v_sub_f32 v238, v238, v240
  v_sub_f32 v239, v239, v240
  v_sub_f32 v192, v192, v240
  v_sub_f32 v193, v193, v240
  v_sub_f32 v194, v194, v240
  v_sub_f32 v195, v195, v240
  v_sub_f32 v196, v196, v240
  v_sub_f32 v197, v197, v240
  v_sub_f32 v198, v198, v240
  v_sub_f32 v199, v199, v240
  v_sub_f32 v242, 0, v240
  v_exp_f32 v242, v242
  s_nop 0
  v_mul_f32 v128, v128, v242
  v_mul_f32 v129, v129, v242
  v_mul_f32 v130, v130, v242
  v_mul_f32 v131, v131, v242
  v_mul_f32 v132, v132, v242
  v_mul_f32 v133, v133, v242
  v_mul_f32 v134, v134, v242
  v_mul_f32 v135, v135, v242
  v_mul_f32 v136, v136, v242
  v_mul_f32 v137, v137, v242
  v_mul_f32 v138, v138, v242
  v_mul_f32 v139, v139, v242
  v_mul_f32 v140, v140, v242
  v_mul_f32 v141, v141, v242
  v_mul_f32 v142, v142, v242
  v_mul_f32 v143, v143, v242
  v_mul_f32 v144, v144, v242
  v_mul_f32 v145, v145, v242
  v_mul_f32 v146, v146, v242
  v_mul_f32 v147, v147, v242
  v_mul_f32 v148, v148, v242
  v_mul_f32 v149, v149, v242
  v_mul_f32 v150, v150, v242
  v_mul_f32 v151, v151, v242
  v_mul_f32 v152, v152, v242
  v_mul_f32 v153, v153, v242
  v_mul_f32 v154, v154, v242
  v_mul_f32 v155, v155, v242
  v_mul_f32 v156, v156, v242
  v_mul_f32 v157, v157, v242
  v_mul_f32 v158, v158, v242
  v_mul_f32 v159, v159, v242
  v_accvgpr_read_b32 v243, a152
  v_mul_f32 v243, v243, v242
  v_accvgpr_write_b32 a152, v243
  v_accvgpr_read_b32 v243, a153
  v_mul_f32 v243, v243, v242
  v_accvgpr_write_b32 a153, v243
  v_accvgpr_read_b32 v243, a154
  v_mul_f32 v243, v243, v242
  v_accvgpr_write_b32 a154, v243
  v_accvgpr_read_b32 v243, a155
  v_mul_f32 v243, v243, v242
  v_accvgpr_write_b32 a155, v243
  v_lshlrev_b32 v243, 16, v216
  v_and_b32 v241, 0xffff0000, v216
  v_mul_f32 v243, v243, v242
  v_mul_f32 v241, v241, v242
  v_cvt_pk_bf16_f32 v216, v243, v241
  v_lshlrev_b32 v243, 16, v217
  v_and_b32 v241, 0xffff0000, v217
  v_mul_f32 v243, v243, v242
  v_mul_f32 v241, v241, v242
  v_cvt_pk_bf16_f32 v217, v243, v241
  v_lshlrev_b32 v243, 16, v218
  v_and_b32 v241, 0xffff0000, v218
  v_mul_f32 v243, v243, v242
  v_mul_f32 v241, v241, v242
  v_cvt_pk_bf16_f32 v218, v243, v241
  v_lshlrev_b32 v243, 16, v219
  v_and_b32 v241, 0xffff0000, v219
  v_mul_f32 v243, v243, v242
  v_mul_f32 v241, v241, v242
  v_cvt_pk_bf16_f32 v219, v243, v241
  s_nop 1
  s_setpc_b64 s[60:61]
L_cstub1:
  s_mov_b32 s98, 200000
L_cloop1:
  buffer_load_dword v20, v24, s[80:83], 0 offen sc0 sc1
  s_waitcnt vmcnt(0)
  v_readlane_b32 s94, v20, 1
  s_sub_u32 s98, s98, 1
  s_cmp_eq_u32 s98, 0
  s_cbranch_scc1 L_cret1
  s_sub_u32 s94, s94, s73
  s_cmp_eq_u32 s94, 0
  s_cbranch_scc1 L_cloop1
  s_branch L_cret1
L_cstub2:
  s_mov_b32 s98, 200000
L_cloop2:
  buffer_load_dword v20, v24, s[80:83], 0 offen sc0 sc1
  s_waitcnt vmcnt(0)
  v_readlane_b32 s94, v20, 2
  s_sub_u32 s98, s98, 1
  s_cmp_eq_u32 s98, 0
  s_cbranch_scc1 L_cret2
  s_sub_u32 s94, s94, s74
  s_cmp_eq_u32 s94, 0
  s_cbranch_scc1 L_cloop2
  s_branch L_cret2
L_cstub3:
  s_mov_b32 s98, 200000
L_cloop3:
  buffer_load_dword v20, v24, s[80:83], 0 offen sc0 sc1
  s_waitcnt vmcnt(0)
  v_readlane_b32 s94, v20, 3
  s_sub_u32 s98, s98, 1
  s_cmp_eq_u32 s98, 0
  s_cbranch_scc1 L_cret3
  s_sub_u32 s94, s94, s75
  s_cmp_eq_u32 s94, 0
  s_cbranch_scc1 L_cloop3
  s_branch L_cret3
L_codeend:
.section .rodata,"a"
.p2align 6
.amdhsa_kernel concat_heads__gqa_block_cached__mha_block_cached__near_ridge_kernel
  .amdhsa_next_free_vgpr 512
  .amdhsa_next_free_sgpr 102
  .amdhsa_accum_offset 256
  .amdhsa_group_segment_fixed_size 0
  .amdhsa_kernarg_size 104
  .amdhsa_user_sgpr_count 2
  .amdhsa_user_sgpr_kernarg_segment_ptr 1
  .amdhsa_system_sgpr_workgroup_id_x 1
.end_amdhsa_kernel
```
